```python
import torch

def _softmax(x, axis=-1):
    return torch.softmax(x, dim=axis)

def _gelu(x):
    return torch.nn.functional.gelu(x, approximate='tanh')

def _silu(x):
    return torch.nn.functional.silu(x)

def _sigmoid(x):
    return torch.sigmoid(x)

def _layernorm(x, axis=-1, eps=1e-05):
    m = x.mean(dim=axis, keepdim=True)
    v = x.var(dim=axis, keepdim=True, unbiased=False)
    return (x - m) / torch.sqrt(v + eps)

def _scatter_add(tgt, idx, src, axis=0):
    return tgt.clone().index_add_(axis, idx, src)

def _segment_sum(src, seg, n):
    out = torch.zeros((n,) + src.shape[1:], dtype=src.dtype)
    return out.index_add_(0, seg, src)

def _pad(x, pw):
    flat = tuple((v for pair in reversed(pw) for v in pair))
    return torch.nn.functional.pad(x, flat)
kernel_name = 'gated_mix__ssm_conv_h3__memory_aug_recurrent_mem_tr__prompt'

def setup_inputs():

    _w = lambda a: (lambda t: t.to(torch.bfloat16) if t.is_floating_point() else t)(torch.as_tensor(a))

    def _A_setup():
        B, S, D = (1, 2048, 512)
        ks = 4
        return {'q': _w((lambda *s: torch.randn(*s, dtype=torch.bfloat16) * 0.05)(B, S, D)), 'k': _w((lambda *s: torch.randn(*s, dtype=torch.bfloat16) * 1.6)(B, S, D)), 'v': _w((lambda *s: torch.randn(*s, dtype=torch.bfloat16) * 1.6)(B, S, D)), 'shift_k': _w((lambda *s: torch.randn(*s, dtype=torch.bfloat16) * 1.6)(D, ks) * 0.5), 'ssm_k': _w((lambda *s: torch.randn(*s, dtype=torch.bfloat16) * 1.6)(D, S) * (1.0 / S ** 0.5)), 'ssm_D': _w((lambda *s: torch.randn(*s, dtype=torch.bfloat16) * 1.6)(D))}
    _A_in = _A_setup()

    def _B_setup():
        B, S, Dm = (1, 2048, 512)
        H, Dh = (32, 128)
        M, seg = (8, 32)
        seg = min(seg, S)
        S = S // seg * seg
        return {'x': _w((lambda *s: torch.randn(*s, dtype=torch.bfloat16) * 0.05)(B, S, Dm)), 'mem0': _w((lambda *s: torch.randn(*s, dtype=torch.bfloat16) * 1.6)(B, M, Dm)), 'Wq': _w((lambda *s: torch.randn(*s, dtype=torch.bfloat16) * 0.8)(Dm, H, Dh) * Dm ** (-0.5)), 'Wk': _w((lambda *s: torch.randn(*s, dtype=torch.bfloat16) * 0.8)(Dm, H, Dh) * Dm ** (-0.5)), 'Wv': _w((lambda *s: torch.randn(*s, dtype=torch.bfloat16) * 1.6)(Dm, H, Dh) * Dm ** (-0.5)), 'Wo': _w((lambda *s: torch.randn(*s, dtype=torch.bfloat16) * 1.6)(H, Dh, Dm) * (H * Dh) ** (-0.5)), 'seg_len': seg}
    _B_in = _B_setup()
    return {'A_q': _A_in['q'], 'A_k': _A_in['k'], 'A_v': _A_in['v'], 'A_shift_k': _A_in['shift_k'], 'A_ssm_k': _A_in['ssm_k'], 'A_ssm_D': _A_in['ssm_D'], 'B_x': _B_in['x'], 'B_mem0': _B_in['mem0'], 'B_Wq': _B_in['Wq'], 'B_Wk': _B_in['Wk'], 'B_Wv': _B_in['Wv'], 'B_Wo': _B_in['Wo'], 'B_seg_len': _B_in['seg_len'], 'gate_w': _w((lambda *s: torch.randn(*s, dtype=torch.bfloat16) * 0.05)(512) * 16.0)}

def reference(A_q, A_k, A_v, A_shift_k, A_ssm_k, A_ssm_D, B_x, B_mem0, B_Wq, B_Wk, B_Wv, B_Wo, B_seg_len, gate_w):

    def _A_ref(q, k, v, shift_k, ssm_k, ssm_D):
        B, S, D = q.shape
        ks = shift_k.shape[-1]
        k_pad = _pad(k, ((0, 0), (ks - 1, 0), (0, 0)))
        k_shift = torch.zeros_like(k)
        for t in range(ks):
            k_shift = k_shift + k_pad[:, t:t + S, :] * shift_k[:, ks - 1 - t][None, None, :]
        kv = k_shift * v
        L = 2 * S
        kv_pad = _pad(kv, ((0, 0), (0, S), (0, 0)))
        kf_pad = _pad(ssm_k, ((0, 0), (0, S)))
        kv_f = (lambda x, axes=(-2, -1): torch.fft.rfft2(x.float(), dim=axes))(kv_pad[:, None, :, :], axes=(1, 2))
        kf_f = (lambda x, axes=(-2, -1): torch.fft.rfft2(x.float(), dim=axes))(kf_pad[:, None, :], axes=(1, 2))
        kf_f = (lambda x, *d: x.permute(*d))(kf_f, 1, 2, 0)
        y_f = kv_f * kf_f[None, :, :, :]
        y = (lambda x, s, axes=(-2, -1): torch.fft.irfft2(x, s=s, dim=axes).to(torch.bfloat16))(y_f, (1, L), axes=(1, 2))[:, 0, :S, :]
        y = y + kv * ssm_D[None, None, :]
        return q * y

    def _B_ref(x, mem0, Wq, Wk, Wv, Wo, seg_len):
        B, S, Dm = x.shape
        H, Dh = (Wq.shape[1], Wq.shape[2])
        M = mem0.shape[1]
        scale = Dh ** (-0.5)
        n_seg = S // seg_len
        L = M + seg_len
        idx = torch.arange(L)
        mask = (idx[:, None] < M) | (idx[:, None] >= idx[None, :])
        mem = mem0
        outs = []
        for s in range(n_seg):
            xs = x[:, s * seg_len:(s + 1) * seg_len, :].clone()
            h = torch.concatenate([mem, xs], axis=1)
            q = torch.einsum('btd,dhe->bhte', h, Wq)
            k = torch.einsum('btd,dhe->bhte', h, Wk)
            v = torch.einsum('btd,dhe->bhte', h, Wv)
            scores = torch.einsum('bhqe,bhke->bhqk', q, k) * scale
            scores = torch.where(mask[None, None], scores, -1000000000.0)
            p = _softmax(scores, axis=-1)
            o = torch.einsum('bhqk,bhke->bhqe', p, v)
            o = torch.einsum('bhte,hed->btd', o, Wo)
            mem = o[:, :M, :].clone()
            outs.append(o[:, M:, :])
        return torch.concatenate(outs, axis=1)
    x = A_q
    g = _sigmoid((x * gate_w).sum(-1, keepdims=True))
    a = _A_ref(x, A_k, A_v, A_shift_k, A_ssm_k, A_ssm_D)
    b = _B_ref(x, B_mem0, B_Wq, B_Wk, B_Wv, B_Wo, B_seg_len)
    return g * a + (1 - g) * b
```

```asm
; @launch grid=(256,1,1) block=(256,1,1) lds=163840
.amdgcn_target "amdgcn-amd-amdhsa--gfx950"
.text
.globl gated_mix__ssm_conv_h3__memory_aug_recurrent_mem_tr__prompt_kernel
.p2align 8
.type gated_mix__ssm_conv_h3__memory_aug_recurrent_mem_tr__prompt_kernel,@function
gated_mix__ssm_conv_h3__memory_aug_recurrent_mem_tr__prompt_kernel:
  s_cmp_ge_u32 s2, 256
  s_cbranch_scc1 L_end
  s_load_dwordx2 s[4:5], s[0:1], 128
  s_load_dwordx2 s[48:49], s[0:1], 120
  s_mov_b32 s6, 0x10000000
  s_mov_b32 s7, 0x20000
  s_mov_b32 s50, 256
  s_mov_b32 s51, 0x20000
  v_lshrrev_b32 v1, 6, v0
  v_mov_b32 v2, 1
  v_readfirstlane_b32 s13, v1
  s_getreg_b32 s84, hwreg(HW_REG_XCC_ID, 0, 3)
  s_sub_u32 s84, s84, 3
  s_and_b32 s84, s84, 7
  s_cmp_eq_u32 s84, 7
  s_cselect_b32 s85, 4, s84
  s_cmp_eq_u32 s84, 4
  s_cselect_b32 s84, 7, s85
  s_load_dwordx2 s[60:61], s[0:1], 64
  s_mov_b32 s62, 0x400000
  s_mov_b32 s63, 0x20000
  s_load_dwordx2 s[64:65], s[0:1], 72
  s_mov_b32 s66, 0x400000
  s_mov_b32 s67, 0x20000
  s_load_dwordx2 s[68:69], s[0:1], 88
  s_mov_b32 s70, 0x400000
  s_mov_b32 s71, 0x20000
  s_load_dwordx2 s[72:73], s[0:1], 80
  s_mov_b32 s74, 0x400000
  s_mov_b32 s75, 0x20000
  s_load_dwordx2 s[8:9], s[0:1], 56
  s_mov_b32 s10, 8192
  s_mov_b32 s11, 0x20000
  s_waitcnt lgkmcnt(0)
  s_cmp_lg_u32 s13, 0
  s_cbranch_scc1 L_noat
  s_lshl_b32 s86, s84, 5
  s_add_u32 s86, s86, 32
  s_cmp_eq_u32 s84, 0
  s_cselect_b32 s86, 0, s86
  s_cmp_eq_u32 s84, 7
  s_cselect_b32 s86, 72, s86
  s_mov_b64 exec, 1
  buffer_atomic_add v2, off, s[48:51], s86 sc0
  s_mov_b64 exec, -1
L_noat:
  s_cmp_lg_u32 s13, 0
  s_cbranch_scc1 L_role
  s_waitcnt vmcnt(0)
L_gotat:
  s_mov_b64 exec, 1
  v_readfirstlane_b32 s85, v2
  s_lshl_b32 s87, s84, 5
  s_add_u32 s87, s87, s85
  s_cmp_lt_u32 s85, 32
  s_cbranch_scc1 L_gotrole
  v_mov_b32 v2, 1
  buffer_atomic_add v2, off, s[48:51], 0 offset:80 sc0
  s_mov_b32 s15, 0
L_ovf_w:
  buffer_load_dword v8, off, s[48:51], 0 offset:0 sc1
  buffer_load_dword v9, off, s[48:51], 0 offset:64 sc1
  buffer_load_dword v10, off, s[48:51], 0 offset:96 sc1
  buffer_load_dword v11, off, s[48:51], 0 offset:128 sc1
  buffer_load_dword v12, off, s[48:51], 0 offset:160 sc1
  buffer_load_dword v13, off, s[48:51], 0 offset:192 sc1
  buffer_load_dword v14, off, s[48:51], 0 offset:224 sc1
  buffer_load_dword v15, off, s[48:51], 0 offset:72 sc1
  s_waitcnt vmcnt(0)
  v_add3_u32 v3, v8, v9, v10
  v_add3_u32 v3, v3, v11, v12
  v_add3_u32 v3, v3, v13, v14
  v_add_u32 v3, v3, v15
  v_cmp_le_u32 vcc, 0x100, v3
  s_cbranch_vccnz L_ovf_ok
  s_sleep 4
  s_add_u32 s15, s15, 1
  s_cmp_lt_u32 s15, 0x80000
  s_cbranch_scc1 L_ovf_w
  s_branch L_ovf_ok
L_ovf_ok:
  v_readfirstlane_b32 s85, v2
  v_readfirstlane_b32 s86, v8
  s_min_u32 s86, s86, 32
  s_add_u32 s87, s86, s85
  s_cmp_lt_u32 s87, 32
  s_cbranch_scc0 L_ovf_n0
  s_add_u32 s87, s87, 0
  s_branch L_gotrole
L_ovf_n0:
  s_sub_u32 s85, s87, 32
  v_readfirstlane_b32 s86, v9
  s_min_u32 s86, s86, 32
  s_add_u32 s87, s86, s85
  s_cmp_lt_u32 s87, 32
  s_cbranch_scc0 L_ovf_n1
  s_add_u32 s87, s87, 32
  s_branch L_gotrole
L_ovf_n1:
  s_sub_u32 s85, s87, 32
  v_readfirstlane_b32 s86, v10
  s_min_u32 s86, s86, 32
  s_add_u32 s87, s86, s85
  s_cmp_lt_u32 s87, 32
  s_cbranch_scc0 L_ovf_n2
  s_add_u32 s87, s87, 64
  s_branch L_gotrole
L_ovf_n2:
  s_sub_u32 s85, s87, 32
  v_readfirstlane_b32 s86, v11
  s_min_u32 s86, s86, 32
  s_add_u32 s87, s86, s85
  s_cmp_lt_u32 s87, 32
  s_cbranch_scc0 L_ovf_n3
  s_add_u32 s87, s87, 96
  s_branch L_gotrole
L_ovf_n3:
  s_sub_u32 s85, s87, 32
  v_readfirstlane_b32 s86, v12
  s_min_u32 s86, s86, 32
  s_add_u32 s87, s86, s85
  s_cmp_lt_u32 s87, 32
  s_cbranch_scc0 L_ovf_n4
  s_add_u32 s87, s87, 128
  s_branch L_gotrole
L_ovf_n4:
  s_sub_u32 s85, s87, 32
  v_readfirstlane_b32 s86, v13
  s_min_u32 s86, s86, 32
  s_add_u32 s87, s86, s85
  s_cmp_lt_u32 s87, 32
  s_cbranch_scc0 L_ovf_n5
  s_add_u32 s87, s87, 160
  s_branch L_gotrole
L_ovf_n5:
  s_sub_u32 s85, s87, 32
  v_readfirstlane_b32 s86, v14
  s_min_u32 s86, s86, 32
  s_add_u32 s87, s86, s85
  s_cmp_lt_u32 s87, 32
  s_cbranch_scc0 L_ovf_n6
  s_add_u32 s87, s87, 192
  s_branch L_gotrole
L_ovf_n6:
  s_sub_u32 s85, s87, 32
  v_readfirstlane_b32 s86, v15
  s_min_u32 s86, s86, 32
  s_add_u32 s87, s86, s85
  s_cmp_lt_u32 s87, 32
  s_cbranch_scc0 L_ovf_n7
  s_add_u32 s87, s87, 224
  s_branch L_gotrole
L_ovf_n7:
  s_sub_u32 s85, s87, 32
  s_mov_b32 s87, 256
L_gotrole:
  v_mov_b32 v2, s87
  v_mov_b32 v3, 0
  ds_write_b32 v3, v2
  s_mov_b64 exec, -1
  s_waitcnt lgkmcnt(0)
L_role:
  s_barrier
  v_mov_b32 v3, 0
  ds_read_b32 v2, v3
  s_waitcnt lgkmcnt(0)
  v_readfirstlane_b32 s12, v2
  s_cmp_lt_u32 s12, 32
  s_cbranch_scc1 L_role2
  s_waitcnt vmcnt(0)
L_role2:
  s_barrier
  s_cmp_ge_u32 s12, 256
  s_cbranch_scc1 L_end
  s_mov_b32 s80, 0
  s_cmp_lt_u32 s12, 32
  s_cbranch_scc1 L_rec
  s_sub_u32 s81, s12, 32
  s_mov_b32 s88, 0
  s_mov_b32 s85, s81
  s_cmp_lt_u32 s85, 192
  s_cbranch_scc1 L_worker
  s_sub_u32 s12, s85, 192
  s_mov_b32 s80, 1
  s_branch L_rec
  s_branch L_conv
L_rec:
  s_mov_b32 s98, 0
  s_cmp_lg_u32 s80, 0
  s_cselect_b32 s26, -1, -2
  s_cselect_b32 s28, -1, -1
  v_mov_b32 v88, s26
  v_mov_b32 v89, s26
  v_mov_b32 v90, s26
  v_mov_b32 v91, s26
  v_mov_b32 v92, s28
  v_mov_b32 v93, 0
  v_and_b32 v24, 63, v0
  v_lshlrev_b32 v25, 4, v24
  v_lshlrev_b32 v26, 2, v24
  s_lshl_b32 s27, s12, 13
  s_lshl_b32 s26, s13, 11
  s_add_u32 s27, s27, s26
  s_lshl_b32 s26, s80, 19
  s_add_u32 s27, s27, s26
  buffer_store_dwordx4 v[88:91], v25, s[4:7], s27 offen offset:0 sc1
  buffer_store_dwordx4 v[88:91], v25, s[4:7], s27 offen offset:1024 sc1
  s_cmp_lg_u32 s13, 0
  s_cbranch_scc1 L_fi_done
  s_lshl_b32 s27, s12, 8
  s_lshl_b32 s26, s80, 14
  s_add_u32 s27, s27, s26
  s_add_u32 s27, s27, 0x100000
  buffer_store_dword v92, v26, s[4:7], s27 offen sc1
  s_cmp_lg_u32 s80, 0
  s_cbranch_scc1 L_fi_done
  s_mov_b64 exec, 0xff
  s_lshl_b32 s27, s12, 7
  s_add_u32 s27, s27, 0x110000
  buffer_store_dword v93, v25, s[4:7], s27 offen sc1
  s_lshl_b32 s27, s12, 4
  s_add_u32 s27, s27, 0x111000
  buffer_store_dword v93, off, s[4:7], s27 sc1
  s_lshl_b32 s27, s12, 2
  s_add_u32 s27, s27, 0x111400
  buffer_store_dword v93, off, s[4:7], s27 offset:0 sc1
  buffer_store_dword v93, off, s[4:7], s27 offset:128 sc1
  buffer_store_dword v93, off, s[4:7], s27 offset:256 sc1
  s_mov_b64 exec, -1
L_fi_done:
  s_cmp_lg_u32 s80, 0
  s_cbranch_scc1 L_early
  s_cmp_lg_u32 s13, 0
  s_cbranch_scc1 L_wa1
  v_and_b32 v72, 63, v0
  v_lshrrev_b32 v75, 4, v72
  v_and_b32 v76, 1, v75
  v_lshlrev_b32 v76, 1, v76
  v_and_b32 v77, 15, v72
  v_xor_b32 v76, v76, v77
  v_xor_b32 v78, 0, v76
  v_lshlrev_b32 v78, 4, v78
  v_lshl_add_u32 v78, v75, 17, v78
  s_lshl_b32 s76, s12, 8
  s_mov_b32 m0, 0x8000
  s_add_u32 s79, s76, 0x0
  buffer_load_dwordx4 v78, s[72:75], s79 offen nt lds
  s_mov_b32 m0, 0x9000
  s_add_u32 s79, s76, 0x80000
  buffer_load_dwordx4 v78, s[72:75], s79 offen nt lds
  s_mov_b32 m0, 0xa000
  s_add_u32 s79, s76, 0x8000
  buffer_load_dwordx4 v78, s[72:75], s79 offen nt lds
  s_mov_b32 m0, 0xb000
  s_add_u32 s79, s76, 0x88000
  buffer_load_dwordx4 v78, s[72:75], s79 offen nt lds
  s_mov_b32 m0, 0xc000
  s_add_u32 s79, s76, 0x10000
  buffer_load_dwordx4 v78, s[72:75], s79 offen nt lds
  s_mov_b32 m0, 0xd000
  s_add_u32 s79, s76, 0x90000
  buffer_load_dwordx4 v78, s[72:75], s79 offen nt lds
  s_mov_b32 m0, 0xe000
  s_add_u32 s79, s76, 0x18000
  buffer_load_dwordx4 v78, s[72:75], s79 offen nt lds
  s_mov_b32 m0, 0xf000
  s_add_u32 s79, s76, 0x98000
  buffer_load_dwordx4 v78, s[72:75], s79 offen nt lds
  s_mov_b32 m0, 0x10000
  s_add_u32 s79, s76, 0x100000
  buffer_load_dwordx4 v78, s[72:75], s79 offen nt lds
  s_mov_b32 m0, 0x11000
  s_add_u32 s79, s76, 0x180000
  buffer_load_dwordx4 v78, s[72:75], s79 offen nt lds
  s_mov_b32 m0, 0x12000
  s_add_u32 s79, s76, 0x108000
  buffer_load_dwordx4 v78, s[72:75], s79 offen nt lds
  s_mov_b32 m0, 0x13000
  s_add_u32 s79, s76, 0x188000
  buffer_load_dwordx4 v78, s[72:75], s79 offen nt lds
  s_mov_b32 m0, 0x14000
  s_add_u32 s79, s76, 0x110000
  buffer_load_dwordx4 v78, s[72:75], s79 offen nt lds
  s_mov_b32 m0, 0x15000
  s_add_u32 s79, s76, 0x190000
  buffer_load_dwordx4 v78, s[72:75], s79 offen nt lds
  s_mov_b32 m0, 0x16000
  s_add_u32 s79, s76, 0x118000
  buffer_load_dwordx4 v78, s[72:75], s79 offen nt lds
  s_mov_b32 m0, 0x17000
  s_add_u32 s79, s76, 0x198000
  buffer_load_dwordx4 v78, s[72:75], s79 offen nt lds
  s_branch L_wadone
L_wa1:
  s_cmp_lg_u32 s13, 1
  s_cbranch_scc1 L_wa2
  v_and_b32 v72, 63, v0
  v_lshrrev_b32 v75, 4, v72
  v_and_b32 v76, 1, v75
  v_lshlrev_b32 v76, 1, v76
  v_and_b32 v77, 15, v72
  v_xor_b32 v76, v76, v77
  v_xor_b32 v78, 4, v76
  v_lshlrev_b32 v78, 4, v78
  v_lshl_add_u32 v78, v75, 17, v78
  s_lshl_b32 s76, s12, 8
  s_mov_b32 m0, 0x8400
  s_add_u32 s79, s76, 0x2000
  buffer_load_dwordx4 v78, s[72:75], s79 offen nt lds
  s_mov_b32 m0, 0x9400
  s_add_u32 s79, s76, 0x82000
  buffer_load_dwordx4 v78, s[72:75], s79 offen nt lds
  s_mov_b32 m0, 0xa400
  s_add_u32 s79, s76, 0xa000
  buffer_load_dwordx4 v78, s[72:75], s79 offen nt lds
  s_mov_b32 m0, 0xb400
  s_add_u32 s79, s76, 0x8a000
  buffer_load_dwordx4 v78, s[72:75], s79 offen nt lds
  s_mov_b32 m0, 0xc400
  s_add_u32 s79, s76, 0x12000
  buffer_load_dwordx4 v78, s[72:75], s79 offen nt lds
  s_mov_b32 m0, 0xd400
  s_add_u32 s79, s76, 0x92000
  buffer_load_dwordx4 v78, s[72:75], s79 offen nt lds
  s_mov_b32 m0, 0xe400
  s_add_u32 s79, s76, 0x1a000
  buffer_load_dwordx4 v78, s[72:75], s79 offen nt lds
  s_mov_b32 m0, 0xf400
  s_add_u32 s79, s76, 0x9a000
  buffer_load_dwordx4 v78, s[72:75], s79 offen nt lds
  s_mov_b32 m0, 0x10400
  s_add_u32 s79, s76, 0x102000
  buffer_load_dwordx4 v78, s[72:75], s79 offen nt lds
  s_mov_b32 m0, 0x11400
  s_add_u32 s79, s76, 0x182000
  buffer_load_dwordx4 v78, s[72:75], s79 offen nt lds
  s_mov_b32 m0, 0x12400
  s_add_u32 s79, s76, 0x10a000
  buffer_load_dwordx4 v78, s[72:75], s79 offen nt lds
  s_mov_b32 m0, 0x13400
  s_add_u32 s79, s76, 0x18a000
  buffer_load_dwordx4 v78, s[72:75], s79 offen nt lds
  s_mov_b32 m0, 0x14400
  s_add_u32 s79, s76, 0x112000
  buffer_load_dwordx4 v78, s[72:75], s79 offen nt lds
  s_mov_b32 m0, 0x15400
  s_add_u32 s79, s76, 0x192000
  buffer_load_dwordx4 v78, s[72:75], s79 offen nt lds
  s_mov_b32 m0, 0x16400
  s_add_u32 s79, s76, 0x11a000
  buffer_load_dwordx4 v78, s[72:75], s79 offen nt lds
  s_mov_b32 m0, 0x17400
  s_add_u32 s79, s76, 0x19a000
  buffer_load_dwordx4 v78, s[72:75], s79 offen nt lds
  s_branch L_wadone
L_wa2:
  s_cmp_lg_u32 s13, 2
  s_cbranch_scc1 L_wa3
  v_and_b32 v72, 63, v0
  v_lshrrev_b32 v75, 4, v72
  v_and_b32 v76, 1, v75
  v_lshlrev_b32 v76, 1, v76
  v_and_b32 v77, 15, v72
  v_xor_b32 v76, v76, v77
  v_xor_b32 v78, 8, v76
  v_lshlrev_b32 v78, 4, v78
  v_lshl_add_u32 v78, v75, 17, v78
  s_lshl_b32 s76, s12, 8
  s_mov_b32 m0, 0x8800
  s_add_u32 s79, s76, 0x4000
  buffer_load_dwordx4 v78, s[72:75], s79 offen nt lds
  s_mov_b32 m0, 0x9800
  s_add_u32 s79, s76, 0x84000
  buffer_load_dwordx4 v78, s[72:75], s79 offen nt lds
  s_mov_b32 m0, 0xa800
  s_add_u32 s79, s76, 0xc000
  buffer_load_dwordx4 v78, s[72:75], s79 offen nt lds
  s_mov_b32 m0, 0xb800
  s_add_u32 s79, s76, 0x8c000
  buffer_load_dwordx4 v78, s[72:75], s79 offen nt lds
  s_mov_b32 m0, 0xc800
  s_add_u32 s79, s76, 0x14000
  buffer_load_dwordx4 v78, s[72:75], s79 offen nt lds
  s_mov_b32 m0, 0xd800
  s_add_u32 s79, s76, 0x94000
  buffer_load_dwordx4 v78, s[72:75], s79 offen nt lds
  s_mov_b32 m0, 0xe800
  s_add_u32 s79, s76, 0x1c000
  buffer_load_dwordx4 v78, s[72:75], s79 offen nt lds
  s_mov_b32 m0, 0xf800
  s_add_u32 s79, s76, 0x9c000
  buffer_load_dwordx4 v78, s[72:75], s79 offen nt lds
  s_mov_b32 m0, 0x10800
  s_add_u32 s79, s76, 0x104000
  buffer_load_dwordx4 v78, s[72:75], s79 offen nt lds
  s_mov_b32 m0, 0x11800
  s_add_u32 s79, s76, 0x184000
  buffer_load_dwordx4 v78, s[72:75], s79 offen nt lds
  s_mov_b32 m0, 0x12800
  s_add_u32 s79, s76, 0x10c000
  buffer_load_dwordx4 v78, s[72:75], s79 offen nt lds
  s_mov_b32 m0, 0x13800
  s_add_u32 s79, s76, 0x18c000
  buffer_load_dwordx4 v78, s[72:75], s79 offen nt lds
  s_mov_b32 m0, 0x14800
  s_add_u32 s79, s76, 0x114000
  buffer_load_dwordx4 v78, s[72:75], s79 offen nt lds
  s_mov_b32 m0, 0x15800
  s_add_u32 s79, s76, 0x194000
  buffer_load_dwordx4 v78, s[72:75], s79 offen nt lds
  s_mov_b32 m0, 0x16800
  s_add_u32 s79, s76, 0x11c000
  buffer_load_dwordx4 v78, s[72:75], s79 offen nt lds
  s_mov_b32 m0, 0x17800
  s_add_u32 s79, s76, 0x19c000
  buffer_load_dwordx4 v78, s[72:75], s79 offen nt lds
  s_branch L_wadone
L_wa3:
  v_and_b32 v72, 63, v0
  v_lshrrev_b32 v75, 4, v72
  v_and_b32 v76, 1, v75
  v_lshlrev_b32 v76, 1, v76
  v_and_b32 v77, 15, v72
  v_xor_b32 v76, v76, v77
  v_xor_b32 v78, 12, v76
  v_lshlrev_b32 v78, 4, v78
  v_lshl_add_u32 v78, v75, 17, v78
  s_lshl_b32 s76, s12, 8
  s_mov_b32 m0, 0x8c00
  s_add_u32 s79, s76, 0x6000
  buffer_load_dwordx4 v78, s[72:75], s79 offen nt lds
  s_mov_b32 m0, 0x9c00
  s_add_u32 s79, s76, 0x86000
  buffer_load_dwordx4 v78, s[72:75], s79 offen nt lds
  s_mov_b32 m0, 0xac00
  s_add_u32 s79, s76, 0xe000
  buffer_load_dwordx4 v78, s[72:75], s79 offen nt lds
  s_mov_b32 m0, 0xbc00
  s_add_u32 s79, s76, 0x8e000
  buffer_load_dwordx4 v78, s[72:75], s79 offen nt lds
  s_mov_b32 m0, 0xcc00
  s_add_u32 s79, s76, 0x16000
  buffer_load_dwordx4 v78, s[72:75], s79 offen nt lds
  s_mov_b32 m0, 0xdc00
  s_add_u32 s79, s76, 0x96000
  buffer_load_dwordx4 v78, s[72:75], s79 offen nt lds
  s_mov_b32 m0, 0xec00
  s_add_u32 s79, s76, 0x1e000
  buffer_load_dwordx4 v78, s[72:75], s79 offen nt lds
  s_mov_b32 m0, 0xfc00
  s_add_u32 s79, s76, 0x9e000
  buffer_load_dwordx4 v78, s[72:75], s79 offen nt lds
  s_mov_b32 m0, 0x10c00
  s_add_u32 s79, s76, 0x106000
  buffer_load_dwordx4 v78, s[72:75], s79 offen nt lds
  s_mov_b32 m0, 0x11c00
  s_add_u32 s79, s76, 0x186000
  buffer_load_dwordx4 v78, s[72:75], s79 offen nt lds
  s_mov_b32 m0, 0x12c00
  s_add_u32 s79, s76, 0x10e000
  buffer_load_dwordx4 v78, s[72:75], s79 offen nt lds
  s_mov_b32 m0, 0x13c00
  s_add_u32 s79, s76, 0x18e000
  buffer_load_dwordx4 v78, s[72:75], s79 offen nt lds
  s_mov_b32 m0, 0x14c00
  s_add_u32 s79, s76, 0x116000
  buffer_load_dwordx4 v78, s[72:75], s79 offen nt lds
  s_mov_b32 m0, 0x15c00
  s_add_u32 s79, s76, 0x196000
  buffer_load_dwordx4 v78, s[72:75], s79 offen nt lds
  s_mov_b32 m0, 0x16c00
  s_add_u32 s79, s76, 0x11e000
  buffer_load_dwordx4 v78, s[72:75], s79 offen nt lds
  s_mov_b32 m0, 0x17c00
  s_add_u32 s79, s76, 0x19e000
  buffer_load_dwordx4 v78, s[72:75], s79 offen nt lds
L_wadone:
L_early:
  v_lshrrev_b32 v24, 6, v0
  v_and_b32 v25, 63, v0
  v_readfirstlane_b32 s13, v24
  v_and_b32 v26, 15, v25
  v_lshrrev_b32 v27, 4, v25
  v_and_b32 v28, 3, v25
  v_bfe_u32 v29, v25, 2, 2
  v_lshlrev_b32 v0, 4, v25
  s_lshl_b32 s26, s13, 11
  v_add_u32 v1, s26, v0
  v_mov_b32 v2, 0
  v_mov_b32 v3, 0
  s_mul_i32 s27, s13, 24576
  s_add_u32 s27, s27, 0x10000
  v_add_u32 v4, s27, v0
  s_mov_b32 s2, 0x55555555
  s_mov_b32 s3, 0x55555555
  s_mov_b32 s32, 0xcccccccc
  s_mov_b32 s33, 0xcccccccc
  s_mov_b32 s30, 0xff00ff
  s_mov_b32 s31, 0xff00ff
  s_mov_b32 s44, 0xf000f
  s_mov_b32 s45, 0xf000f
  s_mov_b32 s46, 0xf000f0
  s_mov_b32 s47, 0xf000f0
  s_mov_b32 s36, 0x11111111
  s_mov_b32 s37, 0x11111111
  s_mov_b32 s38, 0x22222222
  s_mov_b32 s39, 0x22222222
  s_mov_b32 s40, 0x44444444
  s_mov_b32 s41, 0x44444444
  s_mov_b32 s42, 0x88888888
  s_mov_b32 s43, 0x88888888
  v_lshlrev_b32 v30, 7, v27
  v_lshl_add_u32 v30, v29, 4, v30
  v_and_b32 v31, 1, v28
  v_lshl_add_u32 v5, v31, 3, v30
  s_add_u32 s27, s26, 0x4000
  v_mov_b32 v30, 0x2040
  v_mov_b32 v31, s27
  v_cndmask_b32 v30, v30, v31, s[32:33]
  v_add_u32 v5, v5, v30
  v_lshlrev_b32 v30, 8, v27
  v_lshl_add_u32 v30, v29, 5, v30
  v_lshl_add_u32 v30, v28, 3, v30
  v_add_u32 v7, 0x3000, v30
  s_lshl_b32 s27, s13, 9
  v_lshlrev_b32 v30, 4, v26
  v_lshl_add_u32 v30, v27, 2, v30
  v_add_u32 v30, s27, v30
  v_add_u32 v8, 0x2040, v30
  v_lshlrev_b32 v30, 6, v29
  v_and_b32 v31, 1, v26
  v_lshl_add_u32 v30, v31, 5, v30
  v_lshl_add_u32 v30, v27, 3, v30
  v_bfe_u32 v31, v26, 1, 1
  v_lshl_add_u32 v30, v31, 2, v30
  v_add_u32 v30, s27, v30
  v_add_u32 v9, 0x3000, v30
  v_bfe_u32 v30, v26, 1, 2
  v_lshlrev_b32 v30, 2, v30
  v_and_b32 v31, 1, v26
  v_add_u32 v30, v30, v31
  v_and_b32 v31, 1, v27
  v_lshl_add_u32 v30, v31, 1, v30
  v_lshrrev_b32 v31, 1, v27
  v_lshl_add_u32 v30, v31, 4, v30
  v_lshlrev_b32 v30, 4, v30
  v_add_u32 v30, s27, v30
  v_xor_b32 v31, 512, v30
  v_cndmask_b32 v14, v30, v31, s[30:31]
  v_lshlrev_b32 v30, 14, v29
  v_lshl_add_u32 v30, v27, 11, v30
  v_lshl_add_u32 v12, v28, 4, v30
  v_lshrrev_b32 v30, 1, v27
  v_lshl_add_u32 v30, v29, 1, v30
  s_lshr_b32 s27, s12, 1
  v_lshl_add_u32 v30, v30, 1, s27
  v_and_b32 v30, 15, v30
  v_lshl_add_u32 v12, v30, 6, v12
  v_xor_b32 v30, s12, v27
  v_and_b32 v30, 1, v30
  v_lshl_add_u32 v12, v30, 10, v12
  v_and_b32 v30, 2, v28
  v_add_u32 v30, v30, v27
  v_lshlrev_b32 v30, 4, v30
  v_and_b32 v31, 1, v28
  v_lshl_add_u32 v30, v31, 3, v30
  v_and_b32 v31, 0x2c, v25
  v_cmp_eq_u32 vcc, 0, v31
  v_mov_b32 v31, 0x80000000
  s_nop 0
  v_cndmask_b32 v13, v31, v30, vcc
  v_and_b32 v30, 2, v25
  v_cmp_eq_u32 vcc, 0, v30
  v_mov_b32 v30, 0xeeee
  v_mov_b32 v31, 0x4444
  v_cndmask_b32 v15, v30, v31, vcc
  s_lshl_b32 s27, s13, 3
  v_add_u32 v30, s27, v26
  v_subrev_u32 v30, 8, v30
  v_mov_b32 v32, 0x2900
  v_lshlrev_b32 v31, 3, v27
  v_sub_u32 v30, v31, v30
  v_add_u32 v30, 32, v30
  v_cndmask_b32 v30, v30, 0, s[30:31]
  v_and_b32 v31, 3, v30
  v_and_b32 v30, 0xfc, v30
  v_lshlrev_b32 v30, 2, v30
  v_mul_u32_u24 v31, 272, v31
  v_add3_u32 v10, v30, v31, v32
  s_add_u32 s16, s26, 0x100000
  s_lshl_b32 s27, s12, 8
  s_lshl_b32 s28, s13, 6
  s_add_u32 s17, s27, s28
  s_add_u32 s17, s17, 0x100000
  s_and_b32 s29, s12, 1
  s_xor_b32 s18, s29, 0
  s_lshl_b32 s18, s18, 13
  s_lshl_b32 s26, s13, 16
  s_add_u32 s18, s18, s26
  s_xor_b32 s20, s29, 0
  s_xor_b32 s20, s20, s13
  s_and_b32 s20, s20, 1
  s_lshl_b32 s20, s20, 10
  s_lshl_b32 s26, s13, 11
  s_add_u32 s20, s20, s26
  s_lshl_b32 s26, s12, 13
  s_add_u32 s20, s20, s26
  s_xor_b32 s19, s29, 1
  s_lshl_b32 s19, s19, 13
  s_lshl_b32 s26, s13, 16
  s_add_u32 s19, s19, s26
  s_xor_b32 s21, s29, 1
  s_xor_b32 s21, s21, s13
  s_and_b32 s21, s21, 1
  s_lshl_b32 s21, s21, 10
  s_lshl_b32 s26, s13, 11
  s_add_u32 s21, s21, s26
  s_lshl_b32 s26, s12, 13
  s_add_u32 s21, s21, s26
  s_lshl_b32 s26, s80, 19
  s_add_u32 s18, s18, s26
  s_add_u32 s19, s19, s26
  s_add_u32 s20, s20, s26
  s_add_u32 s21, s21, s26
  s_lshl_b32 s26, s80, 14
  s_add_u32 s16, s16, s26
  s_add_u32 s17, s17, s26
  s_mul_i32 s22, s12, 1572864
  s_mul_i32 s27, s13, 6144
  s_add_u32 s22, s22, s27
  s_add_u32 s22, s22, 0x1000000
  s_add_u32 s23, s27, 0x4000
  s_lshl_b32 s25, s27, 1
  s_add_u32 s25, s25, 0xe000
  s_lshl_b32 s24, s13, 11
  s_lshl_b32 s27, s12, 19
  s_add_u32 s24, s24, s27
  s_add_u32 s24, s24, 0x5000000
  s_lshl_b32 s58, s12, 7
  s_add_u32 s58, s58, 0x110000
  s_lshl_b32 s59, s12, 4
  s_add_u32 s59, s59, 0x111000
  s_cmp_eq_u32 s13, 0
  s_cselect_b32 s82, 0x01010100, 0
  s_cselect_b32 s83, 0xfd110101, 0
  s_cselect_b32 s97, 1, 0
  s_mov_b32 s34, 0x3e0293ee
  s_mov_b32 s35, 0x3e0293ee
  s_cmp_eq_u32 s80, 0
  s_cbranch_scc1 L_main
  v_lshrrev_b32 v72, 4, v0
  v_lshrrev_b32 v75, 4, v72
  v_and_b32 v76, 1, v75
  v_lshlrev_b32 v76, 1, v76
  v_and_b32 v77, 15, v72
  v_xor_b32 v76, v76, v77
  v_lshlrev_b32 v76, 4, v76
  v_lshl_add_u32 v32, v75, 10, v76
  v_xor_b32 v33, 64, v32
  v_xor_b32 v34, 128, v32
  v_xor_b32 v35, 192, v32
  s_lshl_b32 s27, s12, 17
  s_lshl_b32 s26, s13, 8
  s_add_u32 s27, s27, s26
  s_lshl_b32 s28, s13, 15
  s_add_u32 m0, s28, 0
  s_add_u32 s26, s27, 0
  buffer_load_dwordx4 v32, s[68:71], s26 offen lds
  s_add_u32 m0, s28, 1024
  s_add_u32 s26, s27, 4096
  buffer_load_dwordx4 v33, s[68:71], s26 offen lds
  s_add_u32 m0, s28, 2048
  s_add_u32 s26, s27, 8192
  buffer_load_dwordx4 v32, s[68:71], s26 offen lds
  s_add_u32 m0, s28, 3072
  s_add_u32 s26, s27, 12288
  buffer_load_dwordx4 v33, s[68:71], s26 offen lds
  s_add_u32 m0, s28, 4096
  s_add_u32 s26, s27, 16384
  buffer_load_dwordx4 v34, s[68:71], s26 offen lds
  s_add_u32 m0, s28, 5120
  s_add_u32 s26, s27, 20480
  buffer_load_dwordx4 v35, s[68:71], s26 offen lds
  s_add_u32 m0, s28, 6144
  s_add_u32 s26, s27, 24576
  buffer_load_dwordx4 v34, s[68:71], s26 offen lds
  s_add_u32 m0, s28, 7168
  s_add_u32 s26, s27, 28672
  buffer_load_dwordx4 v35, s[68:71], s26 offen lds
  s_add_u32 m0, s28, 8192
  s_add_u32 s26, s27, 32768
  buffer_load_dwordx4 v32, s[68:71], s26 offen lds
  s_add_u32 m0, s28, 9216
  s_add_u32 s26, s27, 36864
  buffer_load_dwordx4 v33, s[68:71], s26 offen lds
  s_add_u32 m0, s28, 10240
  s_add_u32 s26, s27, 40960
  buffer_load_dwordx4 v32, s[68:71], s26 offen lds
  s_add_u32 m0, s28, 11264
  s_add_u32 s26, s27, 45056
  buffer_load_dwordx4 v33, s[68:71], s26 offen lds
  s_add_u32 m0, s28, 12288
  s_add_u32 s26, s27, 49152
  buffer_load_dwordx4 v34, s[68:71], s26 offen lds
  s_add_u32 m0, s28, 13312
  s_add_u32 s26, s27, 53248
  buffer_load_dwordx4 v35, s[68:71], s26 offen lds
  s_add_u32 m0, s28, 14336
  s_add_u32 s26, s27, 57344
  buffer_load_dwordx4 v34, s[68:71], s26 offen lds
  s_add_u32 m0, s28, 15360
  s_add_u32 s26, s27, 61440
  buffer_load_dwordx4 v35, s[68:71], s26 offen lds
  s_add_u32 m0, s28, 16384
  s_add_u32 s26, s27, 65536
  buffer_load_dwordx4 v32, s[68:71], s26 offen lds
  s_add_u32 m0, s28, 17408
  s_add_u32 s26, s27, 69632
  buffer_load_dwordx4 v33, s[68:71], s26 offen lds
  s_add_u32 m0, s28, 18432
  s_add_u32 s26, s27, 73728
  buffer_load_dwordx4 v32, s[68:71], s26 offen lds
  s_add_u32 m0, s28, 19456
  s_add_u32 s26, s27, 77824
  buffer_load_dwordx4 v33, s[68:71], s26 offen lds
  s_add_u32 m0, s28, 20480
  s_add_u32 s26, s27, 81920
  buffer_load_dwordx4 v34, s[68:71], s26 offen lds
  s_add_u32 m0, s28, 21504
  s_add_u32 s26, s27, 86016
  buffer_load_dwordx4 v35, s[68:71], s26 offen lds
  s_add_u32 m0, s28, 22528
  s_add_u32 s26, s27, 90112
  buffer_load_dwordx4 v34, s[68:71], s26 offen lds
  s_add_u32 m0, s28, 23552
  s_add_u32 s26, s27, 94208
  buffer_load_dwordx4 v35, s[68:71], s26 offen lds
  s_add_u32 m0, s28, 24576
  s_add_u32 s26, s27, 98304
  buffer_load_dwordx4 v32, s[68:71], s26 offen lds
  s_add_u32 m0, s28, 25600
  s_add_u32 s26, s27, 102400
  buffer_load_dwordx4 v33, s[68:71], s26 offen lds
  s_add_u32 m0, s28, 26624
  s_add_u32 s26, s27, 106496
  buffer_load_dwordx4 v32, s[68:71], s26 offen lds
  s_add_u32 m0, s28, 27648
  s_add_u32 s26, s27, 110592
  buffer_load_dwordx4 v33, s[68:71], s26 offen lds
  s_add_u32 m0, s28, 28672
  s_add_u32 s26, s27, 114688
  buffer_load_dwordx4 v34, s[68:71], s26 offen lds
  s_add_u32 m0, s28, 29696
  s_add_u32 s26, s27, 118784
  buffer_load_dwordx4 v35, s[68:71], s26 offen lds
  s_add_u32 m0, s28, 30720
  s_add_u32 s26, s27, 122880
  buffer_load_dwordx4 v34, s[68:71], s26 offen lds
  s_add_u32 m0, s28, 31744
  s_add_u32 s26, s27, 126976
  buffer_load_dwordx4 v35, s[68:71], s26 offen lds
  v_and_b32 v73, 3, v72
  v_bfe_u32 v74, v72, 2, 2
  v_lshrrev_b32 v81, 1, v74
  v_and_b32 v82, 1, v74
  v_and_b32 v83, 1, v75
  v_lshrrev_b32 v76, 1, v75
  v_lshlrev_b32 v76, 3, v76
  v_lshl_add_u32 v76, v83, 4, v76
  v_lshl_add_u32 v76, v81, 2, v76
  v_add_u32 v76, v76, v82
  v_lshlrev_b32 v78, 8, v76
  v_lshlrev_b32 v76, 1, v82
  v_lshl_add_u32 v76, v81, 2, v76
  v_lshl_add_u32 v76, v83, 3, v76
  v_lshrrev_b32 v77, 1, v73
  v_xor_b32 v76, v76, v77
  v_lshl_add_u32 v78, v76, 4, v78
  v_and_b32 v77, 1, v73
  v_lshl_add_u32 v78, v77, 3, v78
  v_add_u32 v78, s28, v78
  s_and_b32 s26, s12, 1
  s_lshl_b32 s26, s26, 7
  v_xor_b32 v78, s26, v78
  s_waitcnt vmcnt(0)
  v_xor_b32 v79, 0, v78
  ds_read_b64_tr_b16 a[0:1], v79 offset:8192
  ds_read_b64_tr_b16 a[2:3], v79 offset:8704
  ds_read_b64_tr_b16 a[4:5], v79 offset:0
  ds_read_b64_tr_b16 a[6:7], v79 offset:512
  ds_read_b64_tr_b16 a[136:137], v79 offset:24576
  ds_read_b64_tr_b16 a[138:139], v79 offset:25088
  ds_read_b64_tr_b16 a[140:141], v79 offset:16384
  ds_read_b64_tr_b16 a[142:143], v79 offset:16896
  v_xor_b32 v79, 32, v78
  ds_read_b64_tr_b16 a[8:9], v79 offset:8192
  ds_read_b64_tr_b16 a[10:11], v79 offset:8704
  ds_read_b64_tr_b16 a[12:13], v79 offset:0
  ds_read_b64_tr_b16 a[14:15], v79 offset:512
  ds_read_b64_tr_b16 a[152:153], v79 offset:24576
  ds_read_b64_tr_b16 a[154:155], v79 offset:25088
  ds_read_b64_tr_b16 a[156:157], v79 offset:16384
  ds_read_b64_tr_b16 a[158:159], v79 offset:16896
  v_xor_b32 v79, 64, v78
  ds_read_b64_tr_b16 a[160:161], v79 offset:8192
  ds_read_b64_tr_b16 a[162:163], v79 offset:8704
  ds_read_b64_tr_b16 a[164:165], v79 offset:0
  ds_read_b64_tr_b16 a[166:167], v79 offset:512
  ds_read_b64_tr_b16 a[168:169], v79 offset:24576
  ds_read_b64_tr_b16 a[170:171], v79 offset:25088
  ds_read_b64_tr_b16 a[172:173], v79 offset:16384
  ds_read_b64_tr_b16 a[174:175], v79 offset:16896
  v_xor_b32 v79, 96, v78
  ds_read_b64_tr_b16 a[176:177], v79 offset:8192
  ds_read_b64_tr_b16 a[178:179], v79 offset:8704
  ds_read_b64_tr_b16 a[180:181], v79 offset:0
  ds_read_b64_tr_b16 a[182:183], v79 offset:512
  ds_read_b64_tr_b16 a[184:185], v79 offset:24576
  ds_read_b64_tr_b16 a[186:187], v79 offset:25088
  ds_read_b64_tr_b16 a[188:189], v79 offset:16384
  ds_read_b64_tr_b16 a[190:191], v79 offset:16896
  v_xor_b32 v79, 128, v78
  ds_read_b64_tr_b16 a[192:193], v79 offset:8192
  ds_read_b64_tr_b16 a[194:195], v79 offset:8704
  ds_read_b64_tr_b16 a[196:197], v79 offset:0
  ds_read_b64_tr_b16 a[198:199], v79 offset:512
  ds_read_b64_tr_b16 a[200:201], v79 offset:24576
  ds_read_b64_tr_b16 a[202:203], v79 offset:25088
  ds_read_b64_tr_b16 a[204:205], v79 offset:16384
  ds_read_b64_tr_b16 a[206:207], v79 offset:16896
  v_xor_b32 v79, 160, v78
  ds_read_b64_tr_b16 a[208:209], v79 offset:8192
  ds_read_b64_tr_b16 a[210:211], v79 offset:8704
  ds_read_b64_tr_b16 a[212:213], v79 offset:0
  ds_read_b64_tr_b16 a[214:215], v79 offset:512
  ds_read_b64_tr_b16 a[216:217], v79 offset:24576
  ds_read_b64_tr_b16 a[218:219], v79 offset:25088
  ds_read_b64_tr_b16 a[220:221], v79 offset:16384
  ds_read_b64_tr_b16 a[222:223], v79 offset:16896
  v_xor_b32 v79, 192, v78
  ds_read_b64_tr_b16 a[224:225], v79 offset:8192
  ds_read_b64_tr_b16 a[226:227], v79 offset:8704
  ds_read_b64_tr_b16 a[228:229], v79 offset:0
  ds_read_b64_tr_b16 a[230:231], v79 offset:512
  ds_read_b64_tr_b16 a[16:17], v79 offset:24576
  ds_read_b64_tr_b16 a[18:19], v79 offset:25088
  ds_read_b64_tr_b16 a[20:21], v79 offset:16384
  ds_read_b64_tr_b16 a[22:23], v79 offset:16896
  v_xor_b32 v79, 224, v78
  ds_read_b64_tr_b16 a[240:241], v79 offset:8192
  ds_read_b64_tr_b16 a[242:243], v79 offset:8704
  ds_read_b64_tr_b16 a[244:245], v79 offset:0
  ds_read_b64_tr_b16 a[246:247], v79 offset:512
  ds_read_b64_tr_b16 a[24:25], v79 offset:24576
  ds_read_b64_tr_b16 a[26:27], v79 offset:25088
  ds_read_b64_tr_b16 a[28:29], v79 offset:16384
  ds_read_b64_tr_b16 a[30:31], v79 offset:16896
  s_waitcnt lgkmcnt(0)
  s_barrier
  ds_write_b128 v4, a[0:3] offset:16384
  ds_write_b128 v4, a[4:7] offset:17408
  ds_write_b128 v4, a[8:11] offset:18432
  ds_write_b128 v4, a[12:15] offset:19456
  ds_write_b128 v4, a[16:19] offset:20480
  ds_write_b128 v4, a[20:23] offset:21504
  ds_write_b128 v4, a[24:27] offset:22528
  ds_write_b128 v4, a[28:31] offset:23552
  s_mov_b32 s29, 112
  s_cmp_lg_u32 s13, 0
  s_cbranch_scc1 L_ew_na
  v_mov_b32 v76, 1
  s_mov_b64 exec, 1
  buffer_atomic_add v76, off, s[48:51], s29
  s_mov_b64 exec, -1
L_ew_na:
  buffer_load_dword v32, off, s[48:51], 0 offset:16 sc1
  buffer_load_dword v34, off, s[48:51], s29 sc1
  s_mul_i32 s27, s80, 72
  buffer_load_dword v33, off, s[48:51], s27 sc1
  s_mov_b64 exec, 0x3f
  buffer_load_dword v11, v0, s[4:7], s58 offen sc1
  s_mov_b64 exec, -1
  s_branch L_wdone
L_main:
  s_cmp_lg_u32 s13, 0
  s_cbranch_scc1 L_wb1
  s_cmp_lg_u32 s80, 0
  s_cselect_b32 s29, 112, 16
  s_waitcnt vmcnt(16)
  s_barrier
  v_mov_b32 v77, 1
  s_mov_b64 exec, 1
  buffer_atomic_add v77, off, s[48:51], s29
  s_mov_b64 exec, -1
  v_xor_b32 v79, 0, v76
  v_lshlrev_b32 v79, 4, v79
  v_lshl_add_u32 v79, v75, 10, v79
  v_xor_b32 v80, 128, v79
  v_and_b32 v73, 3, v72
  v_bfe_u32 v74, v72, 2, 2
  v_lshrrev_b32 v85, 1, v74
  v_and_b32 v86, 1, v74
  v_and_b32 v87, 1, v75
  v_lshrrev_b32 v76, 1, v75
  v_lshlrev_b32 v76, 4, v76
  v_lshl_add_u32 v76, v85, 3, v76
  v_lshl_add_u32 v76, v87, 2, v76
  v_add_u32 v76, v76, v86
  v_lshlrev_b32 v81, 8, v76
  v_lshlrev_b32 v76, 1, v86
  v_lshl_add_u32 v76, v87, 2, v76
  v_lshl_add_u32 v76, v85, 3, v76
  v_lshrrev_b32 v77, 1, v73
  v_add_u32 v83, 0, v77
  v_xor_b32 v76, v76, v83
  v_lshl_add_u32 v81, v76, 4, v81
  v_and_b32 v84, 1, v73
  v_lshl_add_u32 v81, v84, 3, v81
  v_lshrrev_b32 v76, 1, v75
  v_lshlrev_b32 v76, 3, v76
  v_lshl_add_u32 v76, v87, 4, v76
  v_lshl_add_u32 v76, v85, 2, v76
  v_add_u32 v76, v76, v86
  v_lshlrev_b32 v82, 8, v76
  v_lshlrev_b32 v76, 1, v86
  v_lshl_add_u32 v76, v85, 2, v76
  v_lshl_add_u32 v76, v87, 3, v76
  v_xor_b32 v76, v76, v77
  v_lshl_add_u32 v82, v76, 4, v82
  v_lshl_add_u32 v82, v84, 3, v82
  s_lshl_b32 s77, s12, 17
  s_and_b32 s78, s12, 1
  s_lshl_b32 s78, s78, 7
  s_mov_b32 m0, 0x18000
  s_add_u32 s79, s76, 0x200000
  buffer_load_dwordx4 v78, s[72:75], s79 offen nt lds
  s_mov_b32 m0, 0x19000
  s_add_u32 s79, s76, 0x280000
  buffer_load_dwordx4 v78, s[72:75], s79 offen nt lds
  s_mov_b32 m0, 0x1a000
  s_add_u32 s79, s76, 0x208000
  buffer_load_dwordx4 v78, s[72:75], s79 offen nt lds
  s_mov_b32 m0, 0x1b000
  s_add_u32 s79, s76, 0x288000
  buffer_load_dwordx4 v78, s[72:75], s79 offen nt lds
  s_mov_b32 m0, 0x1c000
  s_add_u32 s79, s76, 0x210000
  buffer_load_dwordx4 v78, s[72:75], s79 offen nt lds
  s_mov_b32 m0, 0x1d000
  s_add_u32 s79, s76, 0x290000
  buffer_load_dwordx4 v78, s[72:75], s79 offen nt lds
  s_mov_b32 m0, 0x1e000
  s_add_u32 s79, s76, 0x218000
  buffer_load_dwordx4 v78, s[72:75], s79 offen nt lds
  s_mov_b32 m0, 0x1f000
  s_add_u32 s79, s76, 0x298000
  buffer_load_dwordx4 v78, s[72:75], s79 offen nt lds
  s_mov_b32 m0, 0x20000
  s_add_u32 s79, s76, 0x300000
  buffer_load_dwordx4 v78, s[72:75], s79 offen nt lds
  s_mov_b32 m0, 0x21000
  s_add_u32 s79, s76, 0x380000
  buffer_load_dwordx4 v78, s[72:75], s79 offen nt lds
  s_mov_b32 m0, 0x22000
  s_add_u32 s79, s76, 0x308000
  buffer_load_dwordx4 v78, s[72:75], s79 offen nt lds
  s_mov_b32 m0, 0x23000
  s_add_u32 s79, s76, 0x388000
  buffer_load_dwordx4 v78, s[72:75], s79 offen nt lds
  s_mov_b32 m0, 0x24000
  s_add_u32 s79, s76, 0x310000
  buffer_load_dwordx4 v78, s[72:75], s79 offen nt lds
  s_mov_b32 m0, 0x25000
  s_add_u32 s79, s76, 0x390000
  buffer_load_dwordx4 v78, s[72:75], s79 offen nt lds
  s_mov_b32 m0, 0x26000
  s_add_u32 s79, s76, 0x318000
  buffer_load_dwordx4 v78, s[72:75], s79 offen nt lds
  s_mov_b32 m0, 0x27000
  s_add_u32 s79, s76, 0x398000
  buffer_load_dwordx4 v78, s[72:75], s79 offen nt lds
  s_mov_b32 m0, 0x0
  s_add_u32 s79, s77, 0x0
  buffer_load_dwordx4 v79, s[68:71], s79 offen nt lds
  s_mov_b32 m0, 0x1000
  s_add_u32 s79, s77, 0x4000
  buffer_load_dwordx4 v80, s[68:71], s79 offen nt lds
  s_mov_b32 m0, 0x2000
  s_add_u32 s79, s77, 0x8000
  buffer_load_dwordx4 v79, s[68:71], s79 offen nt lds
  s_mov_b32 m0, 0x3000
  s_add_u32 s79, s77, 0xc000
  buffer_load_dwordx4 v80, s[68:71], s79 offen nt lds
  s_mov_b32 m0, 0x4000
  s_add_u32 s79, s77, 0x100
  buffer_load_dwordx4 v79, s[68:71], s79 offen nt lds
  s_mov_b32 m0, 0x5000
  s_add_u32 s79, s77, 0x4100
  buffer_load_dwordx4 v80, s[68:71], s79 offen nt lds
  s_mov_b32 m0, 0x6000
  s_add_u32 s79, s77, 0x8100
  buffer_load_dwordx4 v79, s[68:71], s79 offen nt lds
  s_mov_b32 m0, 0x7000
  s_add_u32 s79, s77, 0xc100
  buffer_load_dwordx4 v80, s[68:71], s79 offen nt lds
  s_waitcnt vmcnt(37)
  s_barrier
  v_add_u32 v83, 0x8000, v81
  v_xor_b32 v84, 32, v83
  ds_read_b64_tr_b16 v[40:41], v83 offset:0
  ds_read_b64_tr_b16 v[42:43], v83 offset:512
  ds_read_b64_tr_b16 v[44:45], v83 offset:8192
  ds_read_b64_tr_b16 v[46:47], v83 offset:8704
  ds_read_b64_tr_b16 v[48:49], v84 offset:0
  ds_read_b64_tr_b16 v[50:51], v84 offset:512
  ds_read_b64_tr_b16 v[52:53], v84 offset:8192
  ds_read_b64_tr_b16 v[54:55], v84 offset:8704
  s_waitcnt lgkmcnt(0)
  s_waitcnt vmcnt(33)
  s_barrier
  s_mov_b32 m0, 0x8000
  s_add_u32 s79, s77, 0x200
  buffer_load_dwordx4 v79, s[68:71], s79 offen nt lds
  s_mov_b32 m0, 0x9000
  s_add_u32 s79, s77, 0x4200
  buffer_load_dwordx4 v80, s[68:71], s79 offen nt lds
  s_mov_b32 m0, 0xa000
  s_add_u32 s79, s77, 0x8200
  buffer_load_dwordx4 v79, s[68:71], s79 offen nt lds
  s_mov_b32 m0, 0xb000
  s_add_u32 s79, s77, 0xc200
  buffer_load_dwordx4 v80, s[68:71], s79 offen nt lds
  v_add_u32 v83, 0xc000, v81
  v_xor_b32 v84, 32, v83
  ds_read_b64_tr_b16 v[56:57], v83 offset:0
  ds_read_b64_tr_b16 v[58:59], v83 offset:512
  ds_read_b64_tr_b16 v[60:61], v83 offset:8192
  ds_read_b64_tr_b16 v[62:63], v83 offset:8704
  ds_read_b64_tr_b16 v[64:65], v84 offset:0
  ds_read_b64_tr_b16 v[66:67], v84 offset:512
  ds_read_b64_tr_b16 v[68:69], v84 offset:8192
  ds_read_b64_tr_b16 v[70:71], v84 offset:8704
  s_waitcnt lgkmcnt(0)
  s_waitcnt vmcnt(33)
  s_barrier
  s_mov_b32 m0, 0xc000
  s_add_u32 s79, s77, 0x300
  buffer_load_dwordx4 v79, s[68:71], s79 offen nt lds
  s_mov_b32 m0, 0xd000
  s_add_u32 s79, s77, 0x4300
  buffer_load_dwordx4 v80, s[68:71], s79 offen nt lds
  s_mov_b32 m0, 0xe000
  s_add_u32 s79, s77, 0x8300
  buffer_load_dwordx4 v79, s[68:71], s79 offen nt lds
  s_mov_b32 m0, 0xf000
  s_add_u32 s79, s77, 0xc300
  buffer_load_dwordx4 v80, s[68:71], s79 offen nt lds
  v_add_u32 v83, 0x10000, v81
  v_xor_b32 v84, 32, v83
  ds_read_b64_tr_b16 v[224:225], v83 offset:0
  ds_read_b64_tr_b16 v[226:227], v83 offset:512
  ds_read_b64_tr_b16 v[228:229], v83 offset:8192
  ds_read_b64_tr_b16 v[230:231], v83 offset:8704
  ds_read_b64_tr_b16 v[232:233], v84 offset:0
  ds_read_b64_tr_b16 v[234:235], v84 offset:512
  ds_read_b64_tr_b16 v[236:237], v84 offset:8192
  ds_read_b64_tr_b16 v[238:239], v84 offset:8704
  s_waitcnt lgkmcnt(0)
  s_waitcnt vmcnt(33)
  s_barrier
  s_mov_b32 m0, 0x10000
  s_add_u32 s79, s77, 0x10000
  buffer_load_dwordx4 v79, s[68:71], s79 offen nt lds
  s_mov_b32 m0, 0x11000
  s_add_u32 s79, s77, 0x14000
  buffer_load_dwordx4 v80, s[68:71], s79 offen nt lds
  s_mov_b32 m0, 0x12000
  s_add_u32 s79, s77, 0x18000
  buffer_load_dwordx4 v79, s[68:71], s79 offen nt lds
  s_mov_b32 m0, 0x13000
  s_add_u32 s79, s77, 0x1c000
  buffer_load_dwordx4 v80, s[68:71], s79 offen nt lds
  v_add_u32 v83, 0x14000, v81
  v_xor_b32 v84, 32, v83
  ds_read_b64_tr_b16 v[240:241], v83 offset:0
  ds_read_b64_tr_b16 v[242:243], v83 offset:512
  ds_read_b64_tr_b16 v[244:245], v83 offset:8192
  ds_read_b64_tr_b16 v[246:247], v83 offset:8704
  ds_read_b64_tr_b16 v[248:249], v84 offset:0
  ds_read_b64_tr_b16 v[250:251], v84 offset:512
  ds_read_b64_tr_b16 v[252:253], v84 offset:8192
  ds_read_b64_tr_b16 v[254:255], v84 offset:8704
  s_waitcnt lgkmcnt(0)
  s_waitcnt vmcnt(32)
  s_barrier
  s_mov_b32 m0, 0x14000
  s_add_u32 s79, s77, 0x10100
  buffer_load_dwordx4 v79, s[68:71], s79 offen nt lds
  s_mov_b32 m0, 0x15000
  s_add_u32 s79, s77, 0x14100
  buffer_load_dwordx4 v80, s[68:71], s79 offen nt lds
  s_mov_b32 m0, 0x16000
  s_add_u32 s79, s77, 0x18100
  buffer_load_dwordx4 v79, s[68:71], s79 offen nt lds
  s_mov_b32 m0, 0x17000
  s_add_u32 s79, s77, 0x1c100
  buffer_load_dwordx4 v80, s[68:71], s79 offen nt lds
  v_add_u32 v83, 0x18000, v81
  v_xor_b32 v84, 32, v83
  ds_read_b64_tr_b16 a[64:65], v83 offset:0
  ds_read_b64_tr_b16 a[66:67], v83 offset:512
  ds_read_b64_tr_b16 a[68:69], v83 offset:8192
  ds_read_b64_tr_b16 a[70:71], v83 offset:8704
  ds_read_b64_tr_b16 a[72:73], v84 offset:0
  ds_read_b64_tr_b16 a[74:75], v84 offset:512
  ds_read_b64_tr_b16 a[76:77], v84 offset:8192
  ds_read_b64_tr_b16 a[78:79], v84 offset:8704
  s_waitcnt lgkmcnt(0)
  s_waitcnt vmcnt(32)
  s_barrier
  s_mov_b32 m0, 0x18000
  s_add_u32 s79, s77, 0x10200
  buffer_load_dwordx4 v79, s[68:71], s79 offen nt lds
  s_mov_b32 m0, 0x19000
  s_add_u32 s79, s77, 0x14200
  buffer_load_dwordx4 v80, s[68:71], s79 offen nt lds
  s_mov_b32 m0, 0x1a000
  s_add_u32 s79, s77, 0x18200
  buffer_load_dwordx4 v79, s[68:71], s79 offen nt lds
  s_mov_b32 m0, 0x1b000
  s_add_u32 s79, s77, 0x1c200
  buffer_load_dwordx4 v80, s[68:71], s79 offen nt lds
  v_add_u32 v83, 0x1c000, v81
  v_xor_b32 v84, 32, v83
  ds_read_b64_tr_b16 a[80:81], v83 offset:0
  ds_read_b64_tr_b16 a[82:83], v83 offset:512
  ds_read_b64_tr_b16 a[84:85], v83 offset:8192
  ds_read_b64_tr_b16 a[86:87], v83 offset:8704
  ds_read_b64_tr_b16 a[88:89], v84 offset:0
  ds_read_b64_tr_b16 a[90:91], v84 offset:512
  ds_read_b64_tr_b16 a[92:93], v84 offset:8192
  ds_read_b64_tr_b16 a[94:95], v84 offset:8704
  s_waitcnt lgkmcnt(0)
  s_waitcnt vmcnt(32)
  s_barrier
  s_mov_b32 m0, 0x1c000
  s_add_u32 s79, s77, 0x10300
  buffer_load_dwordx4 v79, s[68:71], s79 offen nt lds
  s_mov_b32 m0, 0x1d000
  s_add_u32 s79, s77, 0x14300
  buffer_load_dwordx4 v80, s[68:71], s79 offen nt lds
  s_mov_b32 m0, 0x1e000
  s_add_u32 s79, s77, 0x18300
  buffer_load_dwordx4 v79, s[68:71], s79 offen nt lds
  s_mov_b32 m0, 0x1f000
  s_add_u32 s79, s77, 0x1c300
  buffer_load_dwordx4 v80, s[68:71], s79 offen nt lds
  s_getpc_b64 s[90:91]
L_pc0:
  s_add_u32 s90, s90, L_E_chk-L_pc0+0
  s_addc_u32 s91, s91, 0
  v_lshlrev_b32 v76, 3, v0
  global_load_dword v77, v76, s[90:91]
  v_add_u32 v83, 0x20000, v81
  v_xor_b32 v84, 32, v83
  ds_read_b64_tr_b16 a[128:129], v83 offset:0
  ds_read_b64_tr_b16 a[130:131], v83 offset:512
  ds_read_b64_tr_b16 a[132:133], v83 offset:8192
  ds_read_b64_tr_b16 a[134:135], v83 offset:8704
  ds_read_b64_tr_b16 a[144:145], v84 offset:0
  ds_read_b64_tr_b16 a[146:147], v84 offset:512
  ds_read_b64_tr_b16 a[148:149], v84 offset:8192
  ds_read_b64_tr_b16 a[150:151], v84 offset:8704
  s_waitcnt lgkmcnt(0)
  s_waitcnt vmcnt(33)
  s_barrier
  s_mov_b32 m0, 0x20000
  s_add_u32 s79, s76, 0x0
  buffer_load_dwordx4 v78, s[60:63], s79 offen nt lds
  s_mov_b32 m0, 0x21000
  s_add_u32 s79, s76, 0x80000
  buffer_load_dwordx4 v78, s[60:63], s79 offen nt lds
  s_mov_b32 m0, 0x22000
  s_add_u32 s79, s76, 0x8000
  buffer_load_dwordx4 v78, s[60:63], s79 offen nt lds
  s_mov_b32 m0, 0x23000
  s_add_u32 s79, s76, 0x88000
  buffer_load_dwordx4 v78, s[60:63], s79 offen nt lds
  v_add_u32 v83, 0x24000, v81
  v_xor_b32 v84, 32, v83
  ds_read_b64_tr_b16 a[232:233], v83 offset:0
  ds_read_b64_tr_b16 a[234:235], v83 offset:512
  ds_read_b64_tr_b16 a[236:237], v83 offset:8192
  ds_read_b64_tr_b16 a[238:239], v83 offset:8704
  ds_read_b64_tr_b16 a[248:249], v84 offset:0
  ds_read_b64_tr_b16 a[250:251], v84 offset:512
  ds_read_b64_tr_b16 a[252:253], v84 offset:8192
  ds_read_b64_tr_b16 a[254:255], v84 offset:8704
  s_waitcnt lgkmcnt(0)
  s_waitcnt vmcnt(33)
  s_barrier
  s_mov_b32 m0, 0x24000
  s_add_u32 s79, s76, 0x10000
  buffer_load_dwordx4 v78, s[60:63], s79 offen nt lds
  s_mov_b32 m0, 0x25000
  s_add_u32 s79, s76, 0x90000
  buffer_load_dwordx4 v78, s[60:63], s79 offen nt lds
  s_mov_b32 m0, 0x26000
  s_add_u32 s79, s76, 0x18000
  buffer_load_dwordx4 v78, s[60:63], s79 offen nt lds
  s_mov_b32 m0, 0x27000
  s_add_u32 s79, s76, 0x98000
  buffer_load_dwordx4 v78, s[60:63], s79 offen nt lds
  v_add_u32 v84, 0x0, v82
  v_xor_b32 v84, s78, v84
  v_xor_b32 v83, 0, v84
  ds_read_b64_tr_b16 a[96:97], v83 offset:8192
  ds_read_b64_tr_b16 a[98:99], v83 offset:8704
  ds_read_b64_tr_b16 a[100:101], v83 offset:0
  ds_read_b64_tr_b16 a[102:103], v83 offset:512
  v_xor_b32 v83, 32, v84
  ds_read_b64_tr_b16 a[104:105], v83 offset:8192
  ds_read_b64_tr_b16 a[106:107], v83 offset:8704
  ds_read_b64_tr_b16 a[108:109], v83 offset:0
  ds_read_b64_tr_b16 a[110:111], v83 offset:512
  v_xor_b32 v83, 64, v84
  ds_read_b64_tr_b16 a[160:161], v83 offset:8192
  ds_read_b64_tr_b16 a[162:163], v83 offset:8704
  ds_read_b64_tr_b16 a[164:165], v83 offset:0
  ds_read_b64_tr_b16 a[166:167], v83 offset:512
  v_xor_b32 v83, 96, v84
  ds_read_b64_tr_b16 a[176:177], v83 offset:8192
  ds_read_b64_tr_b16 a[178:179], v83 offset:8704
  ds_read_b64_tr_b16 a[180:181], v83 offset:0
  ds_read_b64_tr_b16 a[182:183], v83 offset:512
  v_xor_b32 v83, 128, v84
  ds_read_b64_tr_b16 a[192:193], v83 offset:8192
  ds_read_b64_tr_b16 a[194:195], v83 offset:8704
  ds_read_b64_tr_b16 a[196:197], v83 offset:0
  ds_read_b64_tr_b16 a[198:199], v83 offset:512
  v_xor_b32 v83, 160, v84
  ds_read_b64_tr_b16 a[208:209], v83 offset:8192
  ds_read_b64_tr_b16 a[210:211], v83 offset:8704
  ds_read_b64_tr_b16 a[212:213], v83 offset:0
  ds_read_b64_tr_b16 a[214:215], v83 offset:512
  v_xor_b32 v83, 192, v84
  ds_read_b64_tr_b16 a[224:225], v83 offset:8192
  ds_read_b64_tr_b16 a[226:227], v83 offset:8704
  ds_read_b64_tr_b16 a[228:229], v83 offset:0
  ds_read_b64_tr_b16 a[230:231], v83 offset:512
  v_xor_b32 v83, 224, v84
  ds_read_b64_tr_b16 a[240:241], v83 offset:8192
  ds_read_b64_tr_b16 a[242:243], v83 offset:8704
  ds_read_b64_tr_b16 a[244:245], v83 offset:0
  ds_read_b64_tr_b16 a[246:247], v83 offset:512
  s_waitcnt lgkmcnt(0)
  s_waitcnt vmcnt(33)
  s_barrier
  s_mov_b32 m0, 0x0
  s_add_u32 s79, s76, 0x100000
  buffer_load_dwordx4 v78, s[60:63], s79 offen nt lds
  s_mov_b32 m0, 0x1000
  s_add_u32 s79, s76, 0x180000
  buffer_load_dwordx4 v78, s[60:63], s79 offen nt lds
  s_mov_b32 m0, 0x2000
  s_add_u32 s79, s76, 0x108000
  buffer_load_dwordx4 v78, s[60:63], s79 offen nt lds
  s_mov_b32 m0, 0x3000
  s_add_u32 s79, s76, 0x188000
  buffer_load_dwordx4 v78, s[60:63], s79 offen nt lds
  s_waitcnt lgkmcnt(0)
  s_waitcnt vmcnt(33)
  s_barrier
  s_mov_b32 m0, 0x4000
  s_add_u32 s79, s76, 0x110000
  buffer_load_dwordx4 v78, s[60:63], s79 offen nt lds
  s_mov_b32 m0, 0x5000
  s_add_u32 s79, s76, 0x190000
  buffer_load_dwordx4 v78, s[60:63], s79 offen nt lds
  s_mov_b32 m0, 0x6000
  s_add_u32 s79, s76, 0x118000
  buffer_load_dwordx4 v78, s[60:63], s79 offen nt lds
  s_mov_b32 m0, 0x7000
  s_add_u32 s79, s76, 0x198000
  buffer_load_dwordx4 v78, s[60:63], s79 offen nt lds
  s_waitcnt lgkmcnt(0)
  s_waitcnt vmcnt(33)
  s_barrier
  s_mov_b32 m0, 0x8000
  s_add_u32 s79, s76, 0x200000
  buffer_load_dwordx4 v78, s[60:63], s79 offen nt lds
  s_mov_b32 m0, 0x9000
  s_add_u32 s79, s76, 0x280000
  buffer_load_dwordx4 v78, s[60:63], s79 offen nt lds
  s_mov_b32 m0, 0xa000
  s_add_u32 s79, s76, 0x208000
  buffer_load_dwordx4 v78, s[60:63], s79 offen nt lds
  s_mov_b32 m0, 0xb000
  s_add_u32 s79, s76, 0x288000
  buffer_load_dwordx4 v78, s[60:63], s79 offen nt lds
  s_waitcnt lgkmcnt(0)
  s_waitcnt vmcnt(33)
  s_barrier
  s_mov_b32 m0, 0xc000
  s_add_u32 s79, s76, 0x210000
  buffer_load_dwordx4 v78, s[60:63], s79 offen nt lds
  s_mov_b32 m0, 0xd000
  s_add_u32 s79, s76, 0x290000
  buffer_load_dwordx4 v78, s[60:63], s79 offen nt lds
  s_mov_b32 m0, 0xe000
  s_add_u32 s79, s76, 0x218000
  buffer_load_dwordx4 v78, s[60:63], s79 offen nt lds
  s_mov_b32 m0, 0xf000
  s_add_u32 s79, s76, 0x298000
  buffer_load_dwordx4 v78, s[60:63], s79 offen nt lds
  v_add_u32 v84, 0x10000, v82
  v_xor_b32 v84, s78, v84
  v_xor_b32 v83, 0, v84
  ds_read_b64_tr_b16 a[136:137], v83 offset:8192
  ds_read_b64_tr_b16 a[138:139], v83 offset:8704
  ds_read_b64_tr_b16 a[140:141], v83 offset:0
  ds_read_b64_tr_b16 a[142:143], v83 offset:512
  v_xor_b32 v83, 32, v84
  ds_read_b64_tr_b16 a[152:153], v83 offset:8192
  ds_read_b64_tr_b16 a[154:155], v83 offset:8704
  ds_read_b64_tr_b16 a[156:157], v83 offset:0
  ds_read_b64_tr_b16 a[158:159], v83 offset:512
  v_xor_b32 v83, 64, v84
  ds_read_b64_tr_b16 a[168:169], v83 offset:8192
  ds_read_b64_tr_b16 a[170:171], v83 offset:8704
  ds_read_b64_tr_b16 a[172:173], v83 offset:0
  ds_read_b64_tr_b16 a[174:175], v83 offset:512
  v_xor_b32 v83, 96, v84
  ds_read_b64_tr_b16 a[184:185], v83 offset:8192
  ds_read_b64_tr_b16 a[186:187], v83 offset:8704
  ds_read_b64_tr_b16 a[188:189], v83 offset:0
  ds_read_b64_tr_b16 a[190:191], v83 offset:512
  v_xor_b32 v83, 128, v84
  ds_read_b64_tr_b16 a[200:201], v83 offset:8192
  ds_read_b64_tr_b16 a[202:203], v83 offset:8704
  ds_read_b64_tr_b16 a[204:205], v83 offset:0
  ds_read_b64_tr_b16 a[206:207], v83 offset:512
  v_xor_b32 v83, 160, v84
  ds_read_b64_tr_b16 a[216:217], v83 offset:8192
  ds_read_b64_tr_b16 a[218:219], v83 offset:8704
  ds_read_b64_tr_b16 a[220:221], v83 offset:0
  ds_read_b64_tr_b16 a[222:223], v83 offset:512
  v_xor_b32 v83, 192, v84
  ds_read_b64_tr_b16 a[112:113], v83 offset:8192
  ds_read_b64_tr_b16 a[114:115], v83 offset:8704
  ds_read_b64_tr_b16 a[116:117], v83 offset:0
  ds_read_b64_tr_b16 a[118:119], v83 offset:512
  v_xor_b32 v83, 224, v84
  ds_read_b64_tr_b16 a[120:121], v83 offset:8192
  ds_read_b64_tr_b16 a[122:123], v83 offset:8704
  ds_read_b64_tr_b16 a[124:125], v83 offset:0
  ds_read_b64_tr_b16 a[126:127], v83 offset:512
  s_waitcnt lgkmcnt(0)
  s_waitcnt vmcnt(33)
  s_barrier
  s_mov_b32 m0, 0x10000
  s_add_u32 s79, s76, 0x300000
  buffer_load_dwordx4 v78, s[60:63], s79 offen nt lds
  s_mov_b32 m0, 0x11000
  s_add_u32 s79, s76, 0x380000
  buffer_load_dwordx4 v78, s[60:63], s79 offen nt lds
  s_mov_b32 m0, 0x12000
  s_add_u32 s79, s76, 0x308000
  buffer_load_dwordx4 v78, s[60:63], s79 offen nt lds
  s_mov_b32 m0, 0x13000
  s_add_u32 s79, s76, 0x388000
  buffer_load_dwordx4 v78, s[60:63], s79 offen nt lds
  s_waitcnt lgkmcnt(0)
  s_waitcnt vmcnt(33)
  s_barrier
  s_mov_b32 m0, 0x14000
  s_add_u32 s79, s76, 0x310000
  buffer_load_dwordx4 v78, s[60:63], s79 offen nt lds
  s_mov_b32 m0, 0x15000
  s_add_u32 s79, s76, 0x390000
  buffer_load_dwordx4 v78, s[60:63], s79 offen nt lds
  s_mov_b32 m0, 0x16000
  s_add_u32 s79, s76, 0x318000
  buffer_load_dwordx4 v78, s[60:63], s79 offen nt lds
  s_mov_b32 m0, 0x17000
  s_add_u32 s79, s76, 0x398000
  buffer_load_dwordx4 v78, s[60:63], s79 offen nt lds
  s_waitcnt lgkmcnt(0)
  s_waitcnt vmcnt(33)
  s_barrier
  s_mov_b32 m0, 0x18000
  s_add_u32 s79, s76, 0x0
  buffer_load_dwordx4 v78, s[64:67], s79 offen nt lds
  s_mov_b32 m0, 0x19000
  s_add_u32 s79, s76, 0x80000
  buffer_load_dwordx4 v78, s[64:67], s79 offen nt lds
  s_mov_b32 m0, 0x1a000
  s_add_u32 s79, s76, 0x8000
  buffer_load_dwordx4 v78, s[64:67], s79 offen nt lds
  s_mov_b32 m0, 0x1b000
  s_add_u32 s79, s76, 0x88000
  buffer_load_dwordx4 v78, s[64:67], s79 offen nt lds
  s_waitcnt lgkmcnt(0)
  s_waitcnt vmcnt(32)
  s_barrier
  s_mov_b32 m0, 0x1c000
  s_add_u32 s79, s76, 0x10000
  buffer_load_dwordx4 v78, s[64:67], s79 offen nt lds
  s_mov_b32 m0, 0x1d000
  s_add_u32 s79, s76, 0x90000
  buffer_load_dwordx4 v78, s[64:67], s79 offen nt lds
  s_mov_b32 m0, 0x1e000
  s_add_u32 s79, s76, 0x18000
  buffer_load_dwordx4 v78, s[64:67], s79 offen nt lds
  s_mov_b32 m0, 0x1f000
  s_add_u32 s79, s76, 0x98000
  buffer_load_dwordx4 v78, s[64:67], s79 offen nt lds
  v_add_u32 v83, 0x20000, v81
  v_xor_b32 v84, 32, v83
  ds_read_b64_tr_b16 v[96:97], v83 offset:0
  ds_read_b64_tr_b16 v[98:99], v83 offset:512
  ds_read_b64_tr_b16 v[100:101], v83 offset:8192
  ds_read_b64_tr_b16 v[102:103], v83 offset:8704
  ds_read_b64_tr_b16 v[104:105], v84 offset:0
  ds_read_b64_tr_b16 v[106:107], v84 offset:512
  ds_read_b64_tr_b16 v[108:109], v84 offset:8192
  ds_read_b64_tr_b16 v[110:111], v84 offset:8704
  s_waitcnt lgkmcnt(0)
  s_waitcnt vmcnt(32)
  s_barrier
  s_mov_b32 m0, 0x20000
  s_add_u32 s79, s76, 0x100000
  buffer_load_dwordx4 v78, s[64:67], s79 offen nt lds
  s_mov_b32 m0, 0x21000
  s_add_u32 s79, s76, 0x180000
  buffer_load_dwordx4 v78, s[64:67], s79 offen nt lds
  s_mov_b32 m0, 0x22000
  s_add_u32 s79, s76, 0x108000
  buffer_load_dwordx4 v78, s[64:67], s79 offen nt lds
  s_mov_b32 m0, 0x23000
  s_add_u32 s79, s76, 0x188000
  buffer_load_dwordx4 v78, s[64:67], s79 offen nt lds
  v_add_u32 v83, 0x24000, v81
  v_xor_b32 v84, 32, v83
  ds_read_b64_tr_b16 v[112:113], v83 offset:0
  ds_read_b64_tr_b16 v[114:115], v83 offset:512
  ds_read_b64_tr_b16 v[116:117], v83 offset:8192
  ds_read_b64_tr_b16 v[118:119], v83 offset:8704
  ds_read_b64_tr_b16 v[120:121], v84 offset:0
  ds_read_b64_tr_b16 v[122:123], v84 offset:512
  ds_read_b64_tr_b16 v[124:125], v84 offset:8192
  ds_read_b64_tr_b16 v[126:127], v84 offset:8704
  s_waitcnt lgkmcnt(0)
  s_waitcnt vmcnt(32)
  s_barrier
  s_mov_b32 m0, 0x24000
  s_add_u32 s79, s76, 0x110000
  buffer_load_dwordx4 v78, s[64:67], s79 offen nt lds
  s_mov_b32 m0, 0x25000
  s_add_u32 s79, s76, 0x190000
  buffer_load_dwordx4 v78, s[64:67], s79 offen nt lds
  s_mov_b32 m0, 0x26000
  s_add_u32 s79, s76, 0x118000
  buffer_load_dwordx4 v78, s[64:67], s79 offen nt lds
  s_mov_b32 m0, 0x27000
  s_add_u32 s79, s76, 0x198000
  buffer_load_dwordx4 v78, s[64:67], s79 offen nt lds
  v_add_u32 v83, 0x0, v81
  v_xor_b32 v84, 32, v83
  ds_read_b64_tr_b16 v[128:129], v83 offset:0
  ds_read_b64_tr_b16 v[130:131], v83 offset:512
  ds_read_b64_tr_b16 v[132:133], v83 offset:8192
  ds_read_b64_tr_b16 v[134:135], v83 offset:8704
  ds_read_b64_tr_b16 v[136:137], v84 offset:0
  ds_read_b64_tr_b16 v[138:139], v84 offset:512
  ds_read_b64_tr_b16 v[140:141], v84 offset:8192
  ds_read_b64_tr_b16 v[142:143], v84 offset:8704
  s_waitcnt lgkmcnt(0)
  s_waitcnt vmcnt(32)
  s_barrier
  s_mov_b32 m0, 0x0
  s_add_u32 s79, s76, 0x200000
  buffer_load_dwordx4 v78, s[64:67], s79 offen nt lds
  s_mov_b32 m0, 0x1000
  s_add_u32 s79, s76, 0x280000
  buffer_load_dwordx4 v78, s[64:67], s79 offen nt lds
  s_mov_b32 m0, 0x2000
  s_add_u32 s79, s76, 0x208000
  buffer_load_dwordx4 v78, s[64:67], s79 offen nt lds
  s_mov_b32 m0, 0x3000
  s_add_u32 s79, s76, 0x288000
  buffer_load_dwordx4 v78, s[64:67], s79 offen nt lds
  v_add_u32 v83, 0x4000, v81
  v_xor_b32 v84, 32, v83
  ds_read_b64_tr_b16 v[144:145], v83 offset:0
  ds_read_b64_tr_b16 v[146:147], v83 offset:512
  ds_read_b64_tr_b16 v[148:149], v83 offset:8192
  ds_read_b64_tr_b16 v[150:151], v83 offset:8704
  ds_read_b64_tr_b16 v[152:153], v84 offset:0
  ds_read_b64_tr_b16 v[154:155], v84 offset:512
  ds_read_b64_tr_b16 v[156:157], v84 offset:8192
  ds_read_b64_tr_b16 v[158:159], v84 offset:8704
  s_waitcnt lgkmcnt(0)
  s_waitcnt vmcnt(32)
  s_barrier
  s_mov_b32 m0, 0x4000
  s_add_u32 s79, s76, 0x210000
  buffer_load_dwordx4 v78, s[64:67], s79 offen nt lds
  s_mov_b32 m0, 0x5000
  s_add_u32 s79, s76, 0x290000
  buffer_load_dwordx4 v78, s[64:67], s79 offen nt lds
  s_mov_b32 m0, 0x6000
  s_add_u32 s79, s76, 0x218000
  buffer_load_dwordx4 v78, s[64:67], s79 offen nt lds
  s_mov_b32 m0, 0x7000
  s_add_u32 s79, s76, 0x298000
  buffer_load_dwordx4 v78, s[64:67], s79 offen nt lds
  buffer_load_dwordx4 v[16:19], v0, s[4:7], s20 offen sc1
  buffer_load_dwordx4 v[16:19], v0, s[4:7], s16 offen offset:0 sc1
  buffer_load_dwordx4 v[16:19], v0, s[4:7], s21 offen sc1
  buffer_load_dwordx4 v[16:19], v0, s[4:7], s16 offen offset:1024 sc1
  buffer_load_dword v16, off, s[4:7], s24 sc1
  s_add_u32 s27, s22, 0x17a000
  buffer_load_dword v16, off, s[4:7], s27 sc1
  v_add_u32 v83, 0x8000, v81
  v_xor_b32 v84, 32, v83
  ds_read_b64_tr_b16 v[160:161], v83 offset:0
  ds_read_b64_tr_b16 v[162:163], v83 offset:512
  ds_read_b64_tr_b16 v[164:165], v83 offset:8192
  ds_read_b64_tr_b16 v[166:167], v83 offset:8704
  ds_read_b64_tr_b16 v[168:169], v84 offset:0
  ds_read_b64_tr_b16 v[170:171], v84 offset:512
  ds_read_b64_tr_b16 v[172:173], v84 offset:8192
  ds_read_b64_tr_b16 v[174:175], v84 offset:8704
  s_waitcnt lgkmcnt(0)
  s_waitcnt vmcnt(38)
  s_barrier
  s_mov_b32 m0, 0x8000
  s_add_u32 s79, s76, 0x300000
  buffer_load_dwordx4 v78, s[64:67], s79 offen nt lds
  s_mov_b32 m0, 0x9000
  s_add_u32 s79, s76, 0x380000
  buffer_load_dwordx4 v78, s[64:67], s79 offen nt lds
  s_mov_b32 m0, 0xa000
  s_add_u32 s79, s76, 0x308000
  buffer_load_dwordx4 v78, s[64:67], s79 offen nt lds
  s_mov_b32 m0, 0xb000
  s_add_u32 s79, s76, 0x388000
  buffer_load_dwordx4 v78, s[64:67], s79 offen nt lds
  v_add_u32 v83, 0xc000, v81
  v_xor_b32 v84, 32, v83
  ds_read_b64_tr_b16 v[176:177], v83 offset:0
  ds_read_b64_tr_b16 v[178:179], v83 offset:512
  ds_read_b64_tr_b16 v[180:181], v83 offset:8192
  ds_read_b64_tr_b16 v[182:183], v83 offset:8704
  ds_read_b64_tr_b16 v[184:185], v84 offset:0
  ds_read_b64_tr_b16 v[186:187], v84 offset:512
  ds_read_b64_tr_b16 v[188:189], v84 offset:8192
  ds_read_b64_tr_b16 v[190:191], v84 offset:8704
  s_waitcnt lgkmcnt(0)
  s_waitcnt vmcnt(38)
  s_barrier
  s_mov_b32 m0, 0xc000
  s_add_u32 s79, s76, 0x310000
  buffer_load_dwordx4 v78, s[64:67], s79 offen nt lds
  s_mov_b32 m0, 0xd000
  s_add_u32 s79, s76, 0x390000
  buffer_load_dwordx4 v78, s[64:67], s79 offen nt lds
  s_mov_b32 m0, 0xe000
  s_add_u32 s79, s76, 0x318000
  buffer_load_dwordx4 v78, s[64:67], s79 offen nt lds
  s_mov_b32 m0, 0xf000
  s_add_u32 s79, s76, 0x398000
  buffer_load_dwordx4 v78, s[64:67], s79 offen nt lds
  v_add_u32 v83, 0x10000, v81
  v_xor_b32 v84, 32, v83
  ds_read_b64_tr_b16 v[192:193], v83 offset:0
  ds_read_b64_tr_b16 v[194:195], v83 offset:512
  ds_read_b64_tr_b16 v[196:197], v83 offset:8192
  ds_read_b64_tr_b16 v[198:199], v83 offset:8704
  ds_read_b64_tr_b16 v[200:201], v84 offset:0
  ds_read_b64_tr_b16 v[202:203], v84 offset:512
  ds_read_b64_tr_b16 v[204:205], v84 offset:8192
  ds_read_b64_tr_b16 v[206:207], v84 offset:8704
  s_waitcnt lgkmcnt(0)
  s_waitcnt vmcnt(38)
  s_barrier
  ds_write_b128 v4, v[40:43] offset:0
  ds_write_b128 v4, v[44:47] offset:1024
  ds_write_b128 v4, v[48:51] offset:2048
  ds_write_b128 v4, v[52:55] offset:3072
  ds_write_b128 v4, v[56:59] offset:4096
  ds_write_b128 v4, v[60:63] offset:5120
  ds_write_b128 v4, v[64:67] offset:6144
  ds_write_b128 v4, v[68:71] offset:7168
  ds_write_b128 v4, a[64:67] offset:8192
  ds_write_b128 v4, a[68:71] offset:9216
  ds_write_b128 v4, a[72:75] offset:10240
  ds_write_b128 v4, a[76:79] offset:11264
  ds_write_b128 v4, a[80:83] offset:12288
  ds_write_b128 v4, a[84:87] offset:13312
  ds_write_b128 v4, a[88:91] offset:14336
  ds_write_b128 v4, a[92:95] offset:15360
  v_add_u32 v83, 0x14000, v81
  v_xor_b32 v84, 32, v83
  ds_read_b64_tr_b16 v[208:209], v83 offset:0
  ds_read_b64_tr_b16 v[210:211], v83 offset:512
  ds_read_b64_tr_b16 v[212:213], v83 offset:8192
  ds_read_b64_tr_b16 v[214:215], v83 offset:8704
  ds_read_b64_tr_b16 v[216:217], v84 offset:0
  ds_read_b64_tr_b16 v[218:219], v84 offset:512
  ds_read_b64_tr_b16 v[220:221], v84 offset:8192
  ds_read_b64_tr_b16 v[222:223], v84 offset:8704
  s_waitcnt lgkmcnt(0)
  s_waitcnt vmcnt(34)
  s_barrier
  buffer_load_dword v32, off, s[48:51], 0 offset:16 sc1
  buffer_load_dword v34, off, s[48:51], s29 sc1
  s_mul_i32 s27, s80, 72
  buffer_load_dword v33, off, s[48:51], s27 sc1
  s_mov_b64 exec, 0x3f
  buffer_load_dword v11, v0, s[4:7], s58 offen sc1
  s_mov_b64 exec, -1
  ds_write_b128 v4, a[96:99] offset:16384
  ds_write_b128 v4, a[100:103] offset:17408
  ds_write_b128 v4, a[104:107] offset:18432
  ds_write_b128 v4, a[108:111] offset:19456
  ds_write_b128 v4, a[112:115] offset:20480
  ds_write_b128 v4, a[116:119] offset:21504
  ds_write_b128 v4, a[120:123] offset:22528
  ds_write_b128 v4, a[124:127] offset:23552
  v_add_u32 v83, 0x18000, v81
  v_xor_b32 v84, 32, v83
  ds_read_b64_tr_b16 a[0:1], v83 offset:0
  ds_read_b64_tr_b16 a[2:3], v83 offset:512
  ds_read_b64_tr_b16 a[4:5], v83 offset:8192
  ds_read_b64_tr_b16 a[6:7], v83 offset:8704
  ds_read_b64_tr_b16 a[8:9], v84 offset:0
  ds_read_b64_tr_b16 a[10:11], v84 offset:512
  ds_read_b64_tr_b16 a[12:13], v84 offset:8192
  ds_read_b64_tr_b16 a[14:15], v84 offset:8704
  s_waitcnt lgkmcnt(0)
  s_waitcnt vmcnt(34)
  s_barrier
  v_add_u32 v83, 0x1c000, v81
  v_xor_b32 v84, 32, v83
  ds_read_b64_tr_b16 a[16:17], v83 offset:0
  ds_read_b64_tr_b16 a[18:19], v83 offset:512
  ds_read_b64_tr_b16 a[20:21], v83 offset:8192
  ds_read_b64_tr_b16 a[22:23], v83 offset:8704
  ds_read_b64_tr_b16 a[24:25], v84 offset:0
  ds_read_b64_tr_b16 a[26:27], v84 offset:512
  ds_read_b64_tr_b16 a[28:29], v84 offset:8192
  ds_read_b64_tr_b16 a[30:31], v84 offset:8704
  s_waitcnt lgkmcnt(0)
  s_waitcnt vmcnt(30)
  s_barrier
  v_add_u32 v83, 0x20000, v81
  v_xor_b32 v84, 32, v83
  ds_read_b64_tr_b16 a[32:33], v83 offset:0
  ds_read_b64_tr_b16 a[34:35], v83 offset:512
  ds_read_b64_tr_b16 a[36:37], v83 offset:8192
  ds_read_b64_tr_b16 a[38:39], v83 offset:8704
  ds_read_b64_tr_b16 a[40:41], v84 offset:0
  ds_read_b64_tr_b16 a[42:43], v84 offset:512
  ds_read_b64_tr_b16 a[44:45], v84 offset:8192
  ds_read_b64_tr_b16 a[46:47], v84 offset:8704
  s_waitcnt lgkmcnt(0)
  s_waitcnt vmcnt(26)
  s_barrier
  v_add_u32 v83, 0x24000, v81
  v_xor_b32 v84, 32, v83
  ds_read_b64_tr_b16 a[48:49], v83 offset:0
  ds_read_b64_tr_b16 a[50:51], v83 offset:512
  ds_read_b64_tr_b16 a[52:53], v83 offset:8192
  ds_read_b64_tr_b16 a[54:55], v83 offset:8704
  ds_read_b64_tr_b16 a[56:57], v84 offset:0
  ds_read_b64_tr_b16 a[58:59], v84 offset:512
  ds_read_b64_tr_b16 a[60:61], v84 offset:8192
  ds_read_b64_tr_b16 a[62:63], v84 offset:8704
  s_waitcnt lgkmcnt(0)
  s_waitcnt vmcnt(22)
  s_barrier
  s_waitcnt lgkmcnt(0)
  v_add_u32 v83, 0x0, v81
  v_xor_b32 v84, 32, v83
  ds_read_b64_tr_b16 a[64:65], v83 offset:0
  ds_read_b64_tr_b16 a[66:67], v83 offset:512
  ds_read_b64_tr_b16 a[68:69], v83 offset:8192
  ds_read_b64_tr_b16 a[70:71], v83 offset:8704
  ds_read_b64_tr_b16 a[72:73], v84 offset:0
  ds_read_b64_tr_b16 a[74:75], v84 offset:512
  ds_read_b64_tr_b16 a[76:77], v84 offset:8192
  ds_read_b64_tr_b16 a[78:79], v84 offset:8704
  s_waitcnt lgkmcnt(0)
  s_waitcnt vmcnt(18)
  s_barrier
  v_add_u32 v83, 0x4000, v81
  v_xor_b32 v84, 32, v83
  ds_read_b64_tr_b16 a[80:81], v83 offset:0
  ds_read_b64_tr_b16 a[82:83], v83 offset:512
  ds_read_b64_tr_b16 a[84:85], v83 offset:8192
  ds_read_b64_tr_b16 a[86:87], v83 offset:8704
  ds_read_b64_tr_b16 a[88:89], v84 offset:0
  ds_read_b64_tr_b16 a[90:91], v84 offset:512
  ds_read_b64_tr_b16 a[92:93], v84 offset:8192
  ds_read_b64_tr_b16 a[94:95], v84 offset:8704
  s_waitcnt lgkmcnt(0)
  s_waitcnt vmcnt(8)
  s_barrier
  v_add_u32 v83, 0x8000, v81
  v_xor_b32 v84, 32, v83
  ds_read_b64_tr_b16 a[96:97], v83 offset:0
  ds_read_b64_tr_b16 a[98:99], v83 offset:512
  ds_read_b64_tr_b16 a[100:101], v83 offset:8192
  ds_read_b64_tr_b16 a[102:103], v83 offset:8704
  ds_read_b64_tr_b16 a[104:105], v84 offset:0
  ds_read_b64_tr_b16 a[106:107], v84 offset:512
  ds_read_b64_tr_b16 a[108:109], v84 offset:8192
  ds_read_b64_tr_b16 a[110:111], v84 offset:8704
  s_waitcnt lgkmcnt(0)
  s_waitcnt vmcnt(4)
  s_barrier
  v_add_u32 v83, 0xc000, v81
  v_xor_b32 v84, 32, v83
  ds_read_b64_tr_b16 a[112:113], v83 offset:0
  ds_read_b64_tr_b16 a[114:115], v83 offset:512
  ds_read_b64_tr_b16 a[116:117], v83 offset:8192
  ds_read_b64_tr_b16 a[118:119], v83 offset:8704
  ds_read_b64_tr_b16 a[120:121], v84 offset:0
  ds_read_b64_tr_b16 a[122:123], v84 offset:512
  ds_read_b64_tr_b16 a[124:125], v84 offset:8192
  ds_read_b64_tr_b16 a[126:127], v84 offset:8704
  s_waitcnt lgkmcnt(0)
  s_barrier
  s_branch L_wdone
L_wb1:
  s_cmp_lg_u32 s13, 1
  s_cbranch_scc1 L_wb2
  s_cmp_lg_u32 s80, 0
  s_cselect_b32 s29, 112, 16
  s_waitcnt vmcnt(16)
  s_barrier
  v_xor_b32 v79, 4, v76
  v_lshlrev_b32 v79, 4, v79
  v_lshl_add_u32 v79, v75, 10, v79
  v_xor_b32 v80, 128, v79
  v_and_b32 v73, 3, v72
  v_bfe_u32 v74, v72, 2, 2
  v_lshrrev_b32 v85, 1, v74
  v_and_b32 v86, 1, v74
  v_and_b32 v87, 1, v75
  v_lshrrev_b32 v76, 1, v75
  v_lshlrev_b32 v76, 4, v76
  v_lshl_add_u32 v76, v85, 3, v76
  v_lshl_add_u32 v76, v87, 2, v76
  v_add_u32 v76, v76, v86
  v_lshlrev_b32 v81, 8, v76
  v_lshlrev_b32 v76, 1, v86
  v_lshl_add_u32 v76, v87, 2, v76
  v_lshl_add_u32 v76, v85, 3, v76
  v_lshrrev_b32 v77, 1, v73
  v_add_u32 v83, 4, v77
  v_xor_b32 v76, v76, v83
  v_lshl_add_u32 v81, v76, 4, v81
  v_and_b32 v84, 1, v73
  v_lshl_add_u32 v81, v84, 3, v81
  v_lshrrev_b32 v76, 1, v75
  v_lshlrev_b32 v76, 3, v76
  v_lshl_add_u32 v76, v87, 4, v76
  v_lshl_add_u32 v76, v85, 2, v76
  v_add_u32 v76, v76, v86
  v_lshlrev_b32 v82, 8, v76
  v_lshlrev_b32 v76, 1, v86
  v_lshl_add_u32 v76, v85, 2, v76
  v_lshl_add_u32 v76, v87, 3, v76
  v_xor_b32 v76, v76, v77
  v_lshl_add_u32 v82, v76, 4, v82
  v_lshl_add_u32 v82, v84, 3, v82
  s_lshl_b32 s77, s12, 17
  s_and_b32 s78, s12, 1
  s_lshl_b32 s78, s78, 7
  s_mov_b32 m0, 0x18400
  s_add_u32 s79, s76, 0x202000
  buffer_load_dwordx4 v78, s[72:75], s79 offen nt lds
  s_mov_b32 m0, 0x19400
  s_add_u32 s79, s76, 0x282000
  buffer_load_dwordx4 v78, s[72:75], s79 offen nt lds
  s_mov_b32 m0, 0x1a400
  s_add_u32 s79, s76, 0x20a000
  buffer_load_dwordx4 v78, s[72:75], s79 offen nt lds
  s_mov_b32 m0, 0x1b400
  s_add_u32 s79, s76, 0x28a000
  buffer_load_dwordx4 v78, s[72:75], s79 offen nt lds
  s_mov_b32 m0, 0x1c400
  s_add_u32 s79, s76, 0x212000
  buffer_load_dwordx4 v78, s[72:75], s79 offen nt lds
  s_mov_b32 m0, 0x1d400
  s_add_u32 s79, s76, 0x292000
  buffer_load_dwordx4 v78, s[72:75], s79 offen nt lds
  s_mov_b32 m0, 0x1e400
  s_add_u32 s79, s76, 0x21a000
  buffer_load_dwordx4 v78, s[72:75], s79 offen nt lds
  s_mov_b32 m0, 0x1f400
  s_add_u32 s79, s76, 0x29a000
  buffer_load_dwordx4 v78, s[72:75], s79 offen nt lds
  s_mov_b32 m0, 0x20400
  s_add_u32 s79, s76, 0x302000
  buffer_load_dwordx4 v78, s[72:75], s79 offen nt lds
  s_mov_b32 m0, 0x21400
  s_add_u32 s79, s76, 0x382000
  buffer_load_dwordx4 v78, s[72:75], s79 offen nt lds
  s_mov_b32 m0, 0x22400
  s_add_u32 s79, s76, 0x30a000
  buffer_load_dwordx4 v78, s[72:75], s79 offen nt lds
  s_mov_b32 m0, 0x23400
  s_add_u32 s79, s76, 0x38a000
  buffer_load_dwordx4 v78, s[72:75], s79 offen nt lds
  s_mov_b32 m0, 0x24400
  s_add_u32 s79, s76, 0x312000
  buffer_load_dwordx4 v78, s[72:75], s79 offen nt lds
  s_mov_b32 m0, 0x25400
  s_add_u32 s79, s76, 0x392000
  buffer_load_dwordx4 v78, s[72:75], s79 offen nt lds
  s_mov_b32 m0, 0x26400
  s_add_u32 s79, s76, 0x31a000
  buffer_load_dwordx4 v78, s[72:75], s79 offen nt lds
  s_mov_b32 m0, 0x27400
  s_add_u32 s79, s76, 0x39a000
  buffer_load_dwordx4 v78, s[72:75], s79 offen nt lds
  s_mov_b32 m0, 0x400
  s_add_u32 s79, s77, 0x1000
  buffer_load_dwordx4 v79, s[68:71], s79 offen nt lds
  s_mov_b32 m0, 0x1400
  s_add_u32 s79, s77, 0x5000
  buffer_load_dwordx4 v80, s[68:71], s79 offen nt lds
  s_mov_b32 m0, 0x2400
  s_add_u32 s79, s77, 0x9000
  buffer_load_dwordx4 v79, s[68:71], s79 offen nt lds
  s_mov_b32 m0, 0x3400
  s_add_u32 s79, s77, 0xd000
  buffer_load_dwordx4 v80, s[68:71], s79 offen nt lds
  s_mov_b32 m0, 0x4400
  s_add_u32 s79, s77, 0x1100
  buffer_load_dwordx4 v79, s[68:71], s79 offen nt lds
  s_mov_b32 m0, 0x5400
  s_add_u32 s79, s77, 0x5100
  buffer_load_dwordx4 v80, s[68:71], s79 offen nt lds
  s_mov_b32 m0, 0x6400
  s_add_u32 s79, s77, 0x9100
  buffer_load_dwordx4 v79, s[68:71], s79 offen nt lds
  s_mov_b32 m0, 0x7400
  s_add_u32 s79, s77, 0xd100
  buffer_load_dwordx4 v80, s[68:71], s79 offen nt lds
  s_waitcnt vmcnt(36)
  s_barrier
  v_add_u32 v83, 0x8000, v81
  v_xor_b32 v84, 32, v83
  ds_read_b64_tr_b16 v[224:225], v83 offset:0
  ds_read_b64_tr_b16 v[226:227], v83 offset:512
  ds_read_b64_tr_b16 v[228:229], v83 offset:8192
  ds_read_b64_tr_b16 v[230:231], v83 offset:8704
  ds_read_b64_tr_b16 v[232:233], v84 offset:0
  ds_read_b64_tr_b16 v[234:235], v84 offset:512
  ds_read_b64_tr_b16 v[236:237], v84 offset:8192
  ds_read_b64_tr_b16 v[238:239], v84 offset:8704
  s_waitcnt lgkmcnt(0)
  s_waitcnt vmcnt(32)
  s_barrier
  s_mov_b32 m0, 0x8400
  s_add_u32 s79, s77, 0x1200
  buffer_load_dwordx4 v79, s[68:71], s79 offen nt lds
  s_mov_b32 m0, 0x9400
  s_add_u32 s79, s77, 0x5200
  buffer_load_dwordx4 v80, s[68:71], s79 offen nt lds
  s_mov_b32 m0, 0xa400
  s_add_u32 s79, s77, 0x9200
  buffer_load_dwordx4 v79, s[68:71], s79 offen nt lds
  s_mov_b32 m0, 0xb400
  s_add_u32 s79, s77, 0xd200
  buffer_load_dwordx4 v80, s[68:71], s79 offen nt lds
  v_add_u32 v83, 0xc000, v81
  v_xor_b32 v84, 32, v83
  ds_read_b64_tr_b16 v[240:241], v83 offset:0
  ds_read_b64_tr_b16 v[242:243], v83 offset:512
  ds_read_b64_tr_b16 v[244:245], v83 offset:8192
  ds_read_b64_tr_b16 v[246:247], v83 offset:8704
  ds_read_b64_tr_b16 v[248:249], v84 offset:0
  ds_read_b64_tr_b16 v[250:251], v84 offset:512
  ds_read_b64_tr_b16 v[252:253], v84 offset:8192
  ds_read_b64_tr_b16 v[254:255], v84 offset:8704
  s_waitcnt lgkmcnt(0)
  s_waitcnt vmcnt(32)
  s_barrier
  s_mov_b32 m0, 0xc400
  s_add_u32 s79, s77, 0x1300
  buffer_load_dwordx4 v79, s[68:71], s79 offen nt lds
  s_mov_b32 m0, 0xd400
  s_add_u32 s79, s77, 0x5300
  buffer_load_dwordx4 v80, s[68:71], s79 offen nt lds
  s_mov_b32 m0, 0xe400
  s_add_u32 s79, s77, 0x9300
  buffer_load_dwordx4 v79, s[68:71], s79 offen nt lds
  s_mov_b32 m0, 0xf400
  s_add_u32 s79, s77, 0xd300
  buffer_load_dwordx4 v80, s[68:71], s79 offen nt lds
  v_add_u32 v83, 0x10000, v81
  v_xor_b32 v84, 32, v83
  ds_read_b64_tr_b16 v[40:41], v83 offset:0
  ds_read_b64_tr_b16 v[42:43], v83 offset:512
  ds_read_b64_tr_b16 v[44:45], v83 offset:8192
  ds_read_b64_tr_b16 v[46:47], v83 offset:8704
  ds_read_b64_tr_b16 v[48:49], v84 offset:0
  ds_read_b64_tr_b16 v[50:51], v84 offset:512
  ds_read_b64_tr_b16 v[52:53], v84 offset:8192
  ds_read_b64_tr_b16 v[54:55], v84 offset:8704
  s_waitcnt lgkmcnt(0)
  s_waitcnt vmcnt(32)
  s_barrier
  s_mov_b32 m0, 0x10400
  s_add_u32 s79, s77, 0x11000
  buffer_load_dwordx4 v79, s[68:71], s79 offen nt lds
  s_mov_b32 m0, 0x11400
  s_add_u32 s79, s77, 0x15000
  buffer_load_dwordx4 v80, s[68:71], s79 offen nt lds
  s_mov_b32 m0, 0x12400
  s_add_u32 s79, s77, 0x19000
  buffer_load_dwordx4 v79, s[68:71], s79 offen nt lds
  s_mov_b32 m0, 0x13400
  s_add_u32 s79, s77, 0x1d000
  buffer_load_dwordx4 v80, s[68:71], s79 offen nt lds
  v_add_u32 v83, 0x14000, v81
  v_xor_b32 v84, 32, v83
  ds_read_b64_tr_b16 v[56:57], v83 offset:0
  ds_read_b64_tr_b16 v[58:59], v83 offset:512
  ds_read_b64_tr_b16 v[60:61], v83 offset:8192
  ds_read_b64_tr_b16 v[62:63], v83 offset:8704
  ds_read_b64_tr_b16 v[64:65], v84 offset:0
  ds_read_b64_tr_b16 v[66:67], v84 offset:512
  ds_read_b64_tr_b16 v[68:69], v84 offset:8192
  ds_read_b64_tr_b16 v[70:71], v84 offset:8704
  s_waitcnt lgkmcnt(0)
  s_waitcnt vmcnt(32)
  s_barrier
  s_mov_b32 m0, 0x14400
  s_add_u32 s79, s77, 0x11100
  buffer_load_dwordx4 v79, s[68:71], s79 offen nt lds
  s_mov_b32 m0, 0x15400
  s_add_u32 s79, s77, 0x15100
  buffer_load_dwordx4 v80, s[68:71], s79 offen nt lds
  s_mov_b32 m0, 0x16400
  s_add_u32 s79, s77, 0x19100
  buffer_load_dwordx4 v79, s[68:71], s79 offen nt lds
  s_mov_b32 m0, 0x17400
  s_add_u32 s79, s77, 0x1d100
  buffer_load_dwordx4 v80, s[68:71], s79 offen nt lds
  v_add_u32 v83, 0x18000, v81
  v_xor_b32 v84, 32, v83
  ds_read_b64_tr_b16 a[128:129], v83 offset:0
  ds_read_b64_tr_b16 a[130:131], v83 offset:512
  ds_read_b64_tr_b16 a[132:133], v83 offset:8192
  ds_read_b64_tr_b16 a[134:135], v83 offset:8704
  ds_read_b64_tr_b16 a[144:145], v84 offset:0
  ds_read_b64_tr_b16 a[146:147], v84 offset:512
  ds_read_b64_tr_b16 a[148:149], v84 offset:8192
  ds_read_b64_tr_b16 a[150:151], v84 offset:8704
  s_waitcnt lgkmcnt(0)
  s_waitcnt vmcnt(32)
  s_barrier
  s_mov_b32 m0, 0x18400
  s_add_u32 s79, s77, 0x11200
  buffer_load_dwordx4 v79, s[68:71], s79 offen nt lds
  s_mov_b32 m0, 0x19400
  s_add_u32 s79, s77, 0x15200
  buffer_load_dwordx4 v80, s[68:71], s79 offen nt lds
  s_mov_b32 m0, 0x1a400
  s_add_u32 s79, s77, 0x19200
  buffer_load_dwordx4 v79, s[68:71], s79 offen nt lds
  s_mov_b32 m0, 0x1b400
  s_add_u32 s79, s77, 0x1d200
  buffer_load_dwordx4 v80, s[68:71], s79 offen nt lds
  v_add_u32 v83, 0x1c000, v81
  v_xor_b32 v84, 32, v83
  ds_read_b64_tr_b16 a[232:233], v83 offset:0
  ds_read_b64_tr_b16 a[234:235], v83 offset:512
  ds_read_b64_tr_b16 a[236:237], v83 offset:8192
  ds_read_b64_tr_b16 a[238:239], v83 offset:8704
  ds_read_b64_tr_b16 a[248:249], v84 offset:0
  ds_read_b64_tr_b16 a[250:251], v84 offset:512
  ds_read_b64_tr_b16 a[252:253], v84 offset:8192
  ds_read_b64_tr_b16 a[254:255], v84 offset:8704
  s_waitcnt lgkmcnt(0)
  s_waitcnt vmcnt(32)
  s_barrier
  s_mov_b32 m0, 0x1c400
  s_add_u32 s79, s77, 0x11300
  buffer_load_dwordx4 v79, s[68:71], s79 offen nt lds
  s_mov_b32 m0, 0x1d400
  s_add_u32 s79, s77, 0x15300
  buffer_load_dwordx4 v80, s[68:71], s79 offen nt lds
  s_mov_b32 m0, 0x1e400
  s_add_u32 s79, s77, 0x19300
  buffer_load_dwordx4 v79, s[68:71], s79 offen nt lds
  s_mov_b32 m0, 0x1f400
  s_add_u32 s79, s77, 0x1d300
  buffer_load_dwordx4 v80, s[68:71], s79 offen nt lds
  s_getpc_b64 s[90:91]
L_pc1:
  s_add_u32 s90, s90, L_E_chk-L_pc1+6144
  s_addc_u32 s91, s91, 0
  v_lshlrev_b32 v76, 3, v0
  global_load_dword v77, v76, s[90:91]
  v_add_u32 v83, 0x20000, v81
  v_xor_b32 v84, 32, v83
  ds_read_b64_tr_b16 a[96:97], v83 offset:0
  ds_read_b64_tr_b16 a[98:99], v83 offset:512
  ds_read_b64_tr_b16 a[100:101], v83 offset:8192
  ds_read_b64_tr_b16 a[102:103], v83 offset:8704
  ds_read_b64_tr_b16 a[104:105], v84 offset:0
  ds_read_b64_tr_b16 a[106:107], v84 offset:512
  ds_read_b64_tr_b16 a[108:109], v84 offset:8192
  ds_read_b64_tr_b16 a[110:111], v84 offset:8704
  s_waitcnt lgkmcnt(0)
  s_waitcnt vmcnt(33)
  s_barrier
  s_mov_b32 m0, 0x20400
  s_add_u32 s79, s76, 0x2000
  buffer_load_dwordx4 v78, s[60:63], s79 offen nt lds
  s_mov_b32 m0, 0x21400
  s_add_u32 s79, s76, 0x82000
  buffer_load_dwordx4 v78, s[60:63], s79 offen nt lds
  s_mov_b32 m0, 0x22400
  s_add_u32 s79, s76, 0xa000
  buffer_load_dwordx4 v78, s[60:63], s79 offen nt lds
  s_mov_b32 m0, 0x23400
  s_add_u32 s79, s76, 0x8a000
  buffer_load_dwordx4 v78, s[60:63], s79 offen nt lds
  v_add_u32 v83, 0x24000, v81
  v_xor_b32 v84, 32, v83
  ds_read_b64_tr_b16 a[112:113], v83 offset:0
  ds_read_b64_tr_b16 a[114:115], v83 offset:512
  ds_read_b64_tr_b16 a[116:117], v83 offset:8192
  ds_read_b64_tr_b16 a[118:119], v83 offset:8704
  ds_read_b64_tr_b16 a[120:121], v84 offset:0
  ds_read_b64_tr_b16 a[122:123], v84 offset:512
  ds_read_b64_tr_b16 a[124:125], v84 offset:8192
  ds_read_b64_tr_b16 a[126:127], v84 offset:8704
  s_waitcnt lgkmcnt(0)
  s_waitcnt vmcnt(33)
  s_barrier
  s_mov_b32 m0, 0x24400
  s_add_u32 s79, s76, 0x12000
  buffer_load_dwordx4 v78, s[60:63], s79 offen nt lds
  s_mov_b32 m0, 0x25400
  s_add_u32 s79, s76, 0x92000
  buffer_load_dwordx4 v78, s[60:63], s79 offen nt lds
  s_mov_b32 m0, 0x26400
  s_add_u32 s79, s76, 0x1a000
  buffer_load_dwordx4 v78, s[60:63], s79 offen nt lds
  s_mov_b32 m0, 0x27400
  s_add_u32 s79, s76, 0x9a000
  buffer_load_dwordx4 v78, s[60:63], s79 offen nt lds
  s_waitcnt lgkmcnt(0)
  s_waitcnt vmcnt(33)
  s_barrier
  s_mov_b32 m0, 0x400
  s_add_u32 s79, s76, 0x102000
  buffer_load_dwordx4 v78, s[60:63], s79 offen nt lds
  s_mov_b32 m0, 0x1400
  s_add_u32 s79, s76, 0x182000
  buffer_load_dwordx4 v78, s[60:63], s79 offen nt lds
  s_mov_b32 m0, 0x2400
  s_add_u32 s79, s76, 0x10a000
  buffer_load_dwordx4 v78, s[60:63], s79 offen nt lds
  s_mov_b32 m0, 0x3400
  s_add_u32 s79, s76, 0x18a000
  buffer_load_dwordx4 v78, s[60:63], s79 offen nt lds
  v_add_u32 v84, 0x4000, v82
  v_xor_b32 v84, s78, v84
  v_xor_b32 v83, 0, v84
  ds_read_b64_tr_b16 a[64:65], v83 offset:8192
  ds_read_b64_tr_b16 a[66:67], v83 offset:8704
  ds_read_b64_tr_b16 a[68:69], v83 offset:0
  ds_read_b64_tr_b16 a[70:71], v83 offset:512
  v_xor_b32 v83, 32, v84
  ds_read_b64_tr_b16 a[72:73], v83 offset:8192
  ds_read_b64_tr_b16 a[74:75], v83 offset:8704
  ds_read_b64_tr_b16 a[76:77], v83 offset:0
  ds_read_b64_tr_b16 a[78:79], v83 offset:512
  v_xor_b32 v83, 64, v84
  ds_read_b64_tr_b16 a[160:161], v83 offset:8192
  ds_read_b64_tr_b16 a[162:163], v83 offset:8704
  ds_read_b64_tr_b16 a[164:165], v83 offset:0
  ds_read_b64_tr_b16 a[166:167], v83 offset:512
  v_xor_b32 v83, 96, v84
  ds_read_b64_tr_b16 a[176:177], v83 offset:8192
  ds_read_b64_tr_b16 a[178:179], v83 offset:8704
  ds_read_b64_tr_b16 a[180:181], v83 offset:0
  ds_read_b64_tr_b16 a[182:183], v83 offset:512
  v_xor_b32 v83, 128, v84
  ds_read_b64_tr_b16 a[192:193], v83 offset:8192
  ds_read_b64_tr_b16 a[194:195], v83 offset:8704
  ds_read_b64_tr_b16 a[196:197], v83 offset:0
  ds_read_b64_tr_b16 a[198:199], v83 offset:512
  v_xor_b32 v83, 160, v84
  ds_read_b64_tr_b16 a[208:209], v83 offset:8192
  ds_read_b64_tr_b16 a[210:211], v83 offset:8704
  ds_read_b64_tr_b16 a[212:213], v83 offset:0
  ds_read_b64_tr_b16 a[214:215], v83 offset:512
  v_xor_b32 v83, 192, v84
  ds_read_b64_tr_b16 a[224:225], v83 offset:8192
  ds_read_b64_tr_b16 a[226:227], v83 offset:8704
  ds_read_b64_tr_b16 a[228:229], v83 offset:0
  ds_read_b64_tr_b16 a[230:231], v83 offset:512
  v_xor_b32 v83, 224, v84
  ds_read_b64_tr_b16 a[240:241], v83 offset:8192
  ds_read_b64_tr_b16 a[242:243], v83 offset:8704
  ds_read_b64_tr_b16 a[244:245], v83 offset:0
  ds_read_b64_tr_b16 a[246:247], v83 offset:512
  s_waitcnt lgkmcnt(0)
  s_waitcnt vmcnt(33)
  s_barrier
  s_mov_b32 m0, 0x4400
  s_add_u32 s79, s76, 0x112000
  buffer_load_dwordx4 v78, s[60:63], s79 offen nt lds
  s_mov_b32 m0, 0x5400
  s_add_u32 s79, s76, 0x192000
  buffer_load_dwordx4 v78, s[60:63], s79 offen nt lds
  s_mov_b32 m0, 0x6400
  s_add_u32 s79, s76, 0x11a000
  buffer_load_dwordx4 v78, s[60:63], s79 offen nt lds
  s_mov_b32 m0, 0x7400
  s_add_u32 s79, s76, 0x19a000
  buffer_load_dwordx4 v78, s[60:63], s79 offen nt lds
  s_waitcnt lgkmcnt(0)
  s_waitcnt vmcnt(33)
  s_barrier
  s_mov_b32 m0, 0x8400
  s_add_u32 s79, s76, 0x202000
  buffer_load_dwordx4 v78, s[60:63], s79 offen nt lds
  s_mov_b32 m0, 0x9400
  s_add_u32 s79, s76, 0x282000
  buffer_load_dwordx4 v78, s[60:63], s79 offen nt lds
  s_mov_b32 m0, 0xa400
  s_add_u32 s79, s76, 0x20a000
  buffer_load_dwordx4 v78, s[60:63], s79 offen nt lds
  s_mov_b32 m0, 0xb400
  s_add_u32 s79, s76, 0x28a000
  buffer_load_dwordx4 v78, s[60:63], s79 offen nt lds
  s_waitcnt lgkmcnt(0)
  s_waitcnt vmcnt(33)
  s_barrier
  s_mov_b32 m0, 0xc400
  s_add_u32 s79, s76, 0x212000
  buffer_load_dwordx4 v78, s[60:63], s79 offen nt lds
  s_mov_b32 m0, 0xd400
  s_add_u32 s79, s76, 0x292000
  buffer_load_dwordx4 v78, s[60:63], s79 offen nt lds
  s_mov_b32 m0, 0xe400
  s_add_u32 s79, s76, 0x21a000
  buffer_load_dwordx4 v78, s[60:63], s79 offen nt lds
  s_mov_b32 m0, 0xf400
  s_add_u32 s79, s76, 0x29a000
  buffer_load_dwordx4 v78, s[60:63], s79 offen nt lds
  s_waitcnt lgkmcnt(0)
  s_waitcnt vmcnt(33)
  s_barrier
  s_mov_b32 m0, 0x10400
  s_add_u32 s79, s76, 0x302000
  buffer_load_dwordx4 v78, s[60:63], s79 offen nt lds
  s_mov_b32 m0, 0x11400
  s_add_u32 s79, s76, 0x382000
  buffer_load_dwordx4 v78, s[60:63], s79 offen nt lds
  s_mov_b32 m0, 0x12400
  s_add_u32 s79, s76, 0x30a000
  buffer_load_dwordx4 v78, s[60:63], s79 offen nt lds
  s_mov_b32 m0, 0x13400
  s_add_u32 s79, s76, 0x38a000
  buffer_load_dwordx4 v78, s[60:63], s79 offen nt lds
  v_add_u32 v84, 0x14000, v82
  v_xor_b32 v84, s78, v84
  v_xor_b32 v83, 0, v84
  ds_read_b64_tr_b16 a[136:137], v83 offset:8192
  ds_read_b64_tr_b16 a[138:139], v83 offset:8704
  ds_read_b64_tr_b16 a[140:141], v83 offset:0
  ds_read_b64_tr_b16 a[142:143], v83 offset:512
  v_xor_b32 v83, 32, v84
  ds_read_b64_tr_b16 a[152:153], v83 offset:8192
  ds_read_b64_tr_b16 a[154:155], v83 offset:8704
  ds_read_b64_tr_b16 a[156:157], v83 offset:0
  ds_read_b64_tr_b16 a[158:159], v83 offset:512
  v_xor_b32 v83, 64, v84
  ds_read_b64_tr_b16 a[168:169], v83 offset:8192
  ds_read_b64_tr_b16 a[170:171], v83 offset:8704
  ds_read_b64_tr_b16 a[172:173], v83 offset:0
  ds_read_b64_tr_b16 a[174:175], v83 offset:512
  v_xor_b32 v83, 96, v84
  ds_read_b64_tr_b16 a[184:185], v83 offset:8192
  ds_read_b64_tr_b16 a[186:187], v83 offset:8704
  ds_read_b64_tr_b16 a[188:189], v83 offset:0
  ds_read_b64_tr_b16 a[190:191], v83 offset:512
  v_xor_b32 v83, 128, v84
  ds_read_b64_tr_b16 a[200:201], v83 offset:8192
  ds_read_b64_tr_b16 a[202:203], v83 offset:8704
  ds_read_b64_tr_b16 a[204:205], v83 offset:0
  ds_read_b64_tr_b16 a[206:207], v83 offset:512
  v_xor_b32 v83, 160, v84
  ds_read_b64_tr_b16 a[216:217], v83 offset:8192
  ds_read_b64_tr_b16 a[218:219], v83 offset:8704
  ds_read_b64_tr_b16 a[220:221], v83 offset:0
  ds_read_b64_tr_b16 a[222:223], v83 offset:512
  v_xor_b32 v83, 192, v84
  ds_read_b64_tr_b16 a[80:81], v83 offset:8192
  ds_read_b64_tr_b16 a[82:83], v83 offset:8704
  ds_read_b64_tr_b16 a[84:85], v83 offset:0
  ds_read_b64_tr_b16 a[86:87], v83 offset:512
  v_xor_b32 v83, 224, v84
  ds_read_b64_tr_b16 a[88:89], v83 offset:8192
  ds_read_b64_tr_b16 a[90:91], v83 offset:8704
  ds_read_b64_tr_b16 a[92:93], v83 offset:0
  ds_read_b64_tr_b16 a[94:95], v83 offset:512
  s_waitcnt lgkmcnt(0)
  s_waitcnt vmcnt(33)
  s_barrier
  s_mov_b32 m0, 0x14400
  s_add_u32 s79, s76, 0x312000
  buffer_load_dwordx4 v78, s[60:63], s79 offen nt lds
  s_mov_b32 m0, 0x15400
  s_add_u32 s79, s76, 0x392000
  buffer_load_dwordx4 v78, s[60:63], s79 offen nt lds
  s_mov_b32 m0, 0x16400
  s_add_u32 s79, s76, 0x31a000
  buffer_load_dwordx4 v78, s[60:63], s79 offen nt lds
  s_mov_b32 m0, 0x17400
  s_add_u32 s79, s76, 0x39a000
  buffer_load_dwordx4 v78, s[60:63], s79 offen nt lds
  s_waitcnt lgkmcnt(0)
  s_waitcnt vmcnt(33)
  s_barrier
  s_mov_b32 m0, 0x18400
  s_add_u32 s79, s76, 0x2000
  buffer_load_dwordx4 v78, s[64:67], s79 offen nt lds
  s_mov_b32 m0, 0x19400
  s_add_u32 s79, s76, 0x82000
  buffer_load_dwordx4 v78, s[64:67], s79 offen nt lds
  s_mov_b32 m0, 0x1a400
  s_add_u32 s79, s76, 0xa000
  buffer_load_dwordx4 v78, s[64:67], s79 offen nt lds
  s_mov_b32 m0, 0x1b400
  s_add_u32 s79, s76, 0x8a000
  buffer_load_dwordx4 v78, s[64:67], s79 offen nt lds
  s_waitcnt lgkmcnt(0)
  s_waitcnt vmcnt(32)
  s_barrier
  s_mov_b32 m0, 0x1c400
  s_add_u32 s79, s76, 0x12000
  buffer_load_dwordx4 v78, s[64:67], s79 offen nt lds
  s_mov_b32 m0, 0x1d400
  s_add_u32 s79, s76, 0x92000
  buffer_load_dwordx4 v78, s[64:67], s79 offen nt lds
  s_mov_b32 m0, 0x1e400
  s_add_u32 s79, s76, 0x1a000
  buffer_load_dwordx4 v78, s[64:67], s79 offen nt lds
  s_mov_b32 m0, 0x1f400
  s_add_u32 s79, s76, 0x9a000
  buffer_load_dwordx4 v78, s[64:67], s79 offen nt lds
  v_add_u32 v83, 0x20000, v81
  v_xor_b32 v84, 32, v83
  ds_read_b64_tr_b16 v[128:129], v83 offset:0
  ds_read_b64_tr_b16 v[130:131], v83 offset:512
  ds_read_b64_tr_b16 v[132:133], v83 offset:8192
  ds_read_b64_tr_b16 v[134:135], v83 offset:8704
  ds_read_b64_tr_b16 v[136:137], v84 offset:0
  ds_read_b64_tr_b16 v[138:139], v84 offset:512
  ds_read_b64_tr_b16 v[140:141], v84 offset:8192
  ds_read_b64_tr_b16 v[142:143], v84 offset:8704
  s_waitcnt lgkmcnt(0)
  s_waitcnt vmcnt(32)
  s_barrier
  s_mov_b32 m0, 0x20400
  s_add_u32 s79, s76, 0x102000
  buffer_load_dwordx4 v78, s[64:67], s79 offen nt lds
  s_mov_b32 m0, 0x21400
  s_add_u32 s79, s76, 0x182000
  buffer_load_dwordx4 v78, s[64:67], s79 offen nt lds
  s_mov_b32 m0, 0x22400
  s_add_u32 s79, s76, 0x10a000
  buffer_load_dwordx4 v78, s[64:67], s79 offen nt lds
  s_mov_b32 m0, 0x23400
  s_add_u32 s79, s76, 0x18a000
  buffer_load_dwordx4 v78, s[64:67], s79 offen nt lds
  v_add_u32 v83, 0x24000, v81
  v_xor_b32 v84, 32, v83
  ds_read_b64_tr_b16 v[144:145], v83 offset:0
  ds_read_b64_tr_b16 v[146:147], v83 offset:512
  ds_read_b64_tr_b16 v[148:149], v83 offset:8192
  ds_read_b64_tr_b16 v[150:151], v83 offset:8704
  ds_read_b64_tr_b16 v[152:153], v84 offset:0
  ds_read_b64_tr_b16 v[154:155], v84 offset:512
  ds_read_b64_tr_b16 v[156:157], v84 offset:8192
  ds_read_b64_tr_b16 v[158:159], v84 offset:8704
  s_waitcnt lgkmcnt(0)
  s_waitcnt vmcnt(32)
  s_barrier
  s_mov_b32 m0, 0x24400
  s_add_u32 s79, s76, 0x112000
  buffer_load_dwordx4 v78, s[64:67], s79 offen nt lds
  s_mov_b32 m0, 0x25400
  s_add_u32 s79, s76, 0x192000
  buffer_load_dwordx4 v78, s[64:67], s79 offen nt lds
  s_mov_b32 m0, 0x26400
  s_add_u32 s79, s76, 0x11a000
  buffer_load_dwordx4 v78, s[64:67], s79 offen nt lds
  s_mov_b32 m0, 0x27400
  s_add_u32 s79, s76, 0x19a000
  buffer_load_dwordx4 v78, s[64:67], s79 offen nt lds
  v_add_u32 v83, 0x0, v81
  v_xor_b32 v84, 32, v83
  ds_read_b64_tr_b16 v[96:97], v83 offset:0
  ds_read_b64_tr_b16 v[98:99], v83 offset:512
  ds_read_b64_tr_b16 v[100:101], v83 offset:8192
  ds_read_b64_tr_b16 v[102:103], v83 offset:8704
  ds_read_b64_tr_b16 v[104:105], v84 offset:0
  ds_read_b64_tr_b16 v[106:107], v84 offset:512
  ds_read_b64_tr_b16 v[108:109], v84 offset:8192
  ds_read_b64_tr_b16 v[110:111], v84 offset:8704
  s_waitcnt lgkmcnt(0)
  s_waitcnt vmcnt(32)
  s_barrier
  s_mov_b32 m0, 0x400
  s_add_u32 s79, s76, 0x202000
  buffer_load_dwordx4 v78, s[64:67], s79 offen nt lds
  s_mov_b32 m0, 0x1400
  s_add_u32 s79, s76, 0x282000
  buffer_load_dwordx4 v78, s[64:67], s79 offen nt lds
  s_mov_b32 m0, 0x2400
  s_add_u32 s79, s76, 0x20a000
  buffer_load_dwordx4 v78, s[64:67], s79 offen nt lds
  s_mov_b32 m0, 0x3400
  s_add_u32 s79, s76, 0x28a000
  buffer_load_dwordx4 v78, s[64:67], s79 offen nt lds
  v_add_u32 v83, 0x4000, v81
  v_xor_b32 v84, 32, v83
  ds_read_b64_tr_b16 v[112:113], v83 offset:0
  ds_read_b64_tr_b16 v[114:115], v83 offset:512
  ds_read_b64_tr_b16 v[116:117], v83 offset:8192
  ds_read_b64_tr_b16 v[118:119], v83 offset:8704
  ds_read_b64_tr_b16 v[120:121], v84 offset:0
  ds_read_b64_tr_b16 v[122:123], v84 offset:512
  ds_read_b64_tr_b16 v[124:125], v84 offset:8192
  ds_read_b64_tr_b16 v[126:127], v84 offset:8704
  s_waitcnt lgkmcnt(0)
  s_waitcnt vmcnt(32)
  s_barrier
  s_mov_b32 m0, 0x4400
  s_add_u32 s79, s76, 0x212000
  buffer_load_dwordx4 v78, s[64:67], s79 offen nt lds
  s_mov_b32 m0, 0x5400
  s_add_u32 s79, s76, 0x292000
  buffer_load_dwordx4 v78, s[64:67], s79 offen nt lds
  s_mov_b32 m0, 0x6400
  s_add_u32 s79, s76, 0x21a000
  buffer_load_dwordx4 v78, s[64:67], s79 offen nt lds
  s_mov_b32 m0, 0x7400
  s_add_u32 s79, s76, 0x29a000
  buffer_load_dwordx4 v78, s[64:67], s79 offen nt lds
  buffer_load_dwordx4 v[16:19], v0, s[4:7], s20 offen sc1
  buffer_load_dwordx4 v[16:19], v0, s[4:7], s16 offen offset:0 sc1
  buffer_load_dwordx4 v[16:19], v0, s[4:7], s21 offen sc1
  buffer_load_dwordx4 v[16:19], v0, s[4:7], s16 offen offset:1024 sc1
  buffer_load_dword v16, off, s[4:7], s24 sc1
  s_add_u32 s27, s22, 0x17a000
  buffer_load_dword v16, off, s[4:7], s27 sc1
  v_add_u32 v83, 0x8000, v81
  v_xor_b32 v84, 32, v83
  ds_read_b64_tr_b16 v[192:193], v83 offset:0
  ds_read_b64_tr_b16 v[194:195], v83 offset:512
  ds_read_b64_tr_b16 v[196:197], v83 offset:8192
  ds_read_b64_tr_b16 v[198:199], v83 offset:8704
  ds_read_b64_tr_b16 v[200:201], v84 offset:0
  ds_read_b64_tr_b16 v[202:203], v84 offset:512
  ds_read_b64_tr_b16 v[204:205], v84 offset:8192
  ds_read_b64_tr_b16 v[206:207], v84 offset:8704
  s_waitcnt lgkmcnt(0)
  s_waitcnt vmcnt(38)
  s_barrier
  s_mov_b32 m0, 0x8400
  s_add_u32 s79, s76, 0x302000
  buffer_load_dwordx4 v78, s[64:67], s79 offen nt lds
  s_mov_b32 m0, 0x9400
  s_add_u32 s79, s76, 0x382000
  buffer_load_dwordx4 v78, s[64:67], s79 offen nt lds
  s_mov_b32 m0, 0xa400
  s_add_u32 s79, s76, 0x30a000
  buffer_load_dwordx4 v78, s[64:67], s79 offen nt lds
  s_mov_b32 m0, 0xb400
  s_add_u32 s79, s76, 0x38a000
  buffer_load_dwordx4 v78, s[64:67], s79 offen nt lds
  v_add_u32 v83, 0xc000, v81
  v_xor_b32 v84, 32, v83
  ds_read_b64_tr_b16 v[208:209], v83 offset:0
  ds_read_b64_tr_b16 v[210:211], v83 offset:512
  ds_read_b64_tr_b16 v[212:213], v83 offset:8192
  ds_read_b64_tr_b16 v[214:215], v83 offset:8704
  ds_read_b64_tr_b16 v[216:217], v84 offset:0
  ds_read_b64_tr_b16 v[218:219], v84 offset:512
  ds_read_b64_tr_b16 v[220:221], v84 offset:8192
  ds_read_b64_tr_b16 v[222:223], v84 offset:8704
  s_waitcnt lgkmcnt(0)
  s_waitcnt vmcnt(38)
  s_barrier
  s_mov_b32 m0, 0xc400
  s_add_u32 s79, s76, 0x312000
  buffer_load_dwordx4 v78, s[64:67], s79 offen nt lds
  s_mov_b32 m0, 0xd400
  s_add_u32 s79, s76, 0x392000
  buffer_load_dwordx4 v78, s[64:67], s79 offen nt lds
  s_mov_b32 m0, 0xe400
  s_add_u32 s79, s76, 0x31a000
  buffer_load_dwordx4 v78, s[64:67], s79 offen nt lds
  s_mov_b32 m0, 0xf400
  s_add_u32 s79, s76, 0x39a000
  buffer_load_dwordx4 v78, s[64:67], s79 offen nt lds
  v_add_u32 v83, 0x10000, v81
  v_xor_b32 v84, 32, v83
  ds_read_b64_tr_b16 v[160:161], v83 offset:0
  ds_read_b64_tr_b16 v[162:163], v83 offset:512
  ds_read_b64_tr_b16 v[164:165], v83 offset:8192
  ds_read_b64_tr_b16 v[166:167], v83 offset:8704
  ds_read_b64_tr_b16 v[168:169], v84 offset:0
  ds_read_b64_tr_b16 v[170:171], v84 offset:512
  ds_read_b64_tr_b16 v[172:173], v84 offset:8192
  ds_read_b64_tr_b16 v[174:175], v84 offset:8704
  s_waitcnt lgkmcnt(0)
  s_waitcnt vmcnt(38)
  s_barrier
  v_add_u32 v83, 0x14000, v81
  v_xor_b32 v84, 32, v83
  ds_read_b64_tr_b16 v[176:177], v83 offset:0
  ds_read_b64_tr_b16 v[178:179], v83 offset:512
  ds_read_b64_tr_b16 v[180:181], v83 offset:8192
  ds_read_b64_tr_b16 v[182:183], v83 offset:8704
  ds_read_b64_tr_b16 v[184:185], v84 offset:0
  ds_read_b64_tr_b16 v[186:187], v84 offset:512
  ds_read_b64_tr_b16 v[188:189], v84 offset:8192
  ds_read_b64_tr_b16 v[190:191], v84 offset:8704
  s_waitcnt lgkmcnt(0)
  s_waitcnt vmcnt(34)
  s_barrier
  buffer_load_dword v32, off, s[48:51], 0 offset:16 sc1
  buffer_load_dword v34, off, s[48:51], s29 sc1
  s_mul_i32 s27, s80, 72
  buffer_load_dword v33, off, s[48:51], s27 sc1
  s_mov_b64 exec, 0x3f
  buffer_load_dword v11, v0, s[4:7], s58 offen sc1
  s_mov_b64 exec, -1
  ds_write_b128 v4, v[40:43] offset:0
  ds_write_b128 v4, v[44:47] offset:1024
  ds_write_b128 v4, v[48:51] offset:2048
  ds_write_b128 v4, v[52:55] offset:3072
  ds_write_b128 v4, v[56:59] offset:4096
  ds_write_b128 v4, v[60:63] offset:5120
  ds_write_b128 v4, v[64:67] offset:6144
  ds_write_b128 v4, v[68:71] offset:7168
  v_add_u32 v83, 0x18000, v81
  v_xor_b32 v84, 32, v83
  ds_read_b64_tr_b16 a[32:33], v83 offset:0
  ds_read_b64_tr_b16 a[34:35], v83 offset:512
  ds_read_b64_tr_b16 a[36:37], v83 offset:8192
  ds_read_b64_tr_b16 a[38:39], v83 offset:8704
  ds_read_b64_tr_b16 a[40:41], v84 offset:0
  ds_read_b64_tr_b16 a[42:43], v84 offset:512
  ds_read_b64_tr_b16 a[44:45], v84 offset:8192
  ds_read_b64_tr_b16 a[46:47], v84 offset:8704
  s_waitcnt lgkmcnt(0)
  s_waitcnt vmcnt(34)
  s_barrier
  ds_write_b128 v4, a[96:99] offset:8192
  ds_write_b128 v4, a[100:103] offset:9216
  ds_write_b128 v4, a[104:107] offset:10240
  ds_write_b128 v4, a[108:111] offset:11264
  ds_write_b128 v4, a[112:115] offset:12288
  ds_write_b128 v4, a[116:119] offset:13312
  ds_write_b128 v4, a[120:123] offset:14336
  ds_write_b128 v4, a[124:127] offset:15360
  ds_write_b128 v4, a[64:67] offset:16384
  ds_write_b128 v4, a[68:71] offset:17408
  ds_write_b128 v4, a[72:75] offset:18432
  ds_write_b128 v4, a[76:79] offset:19456
  ds_write_b128 v4, a[80:83] offset:20480
  ds_write_b128 v4, a[84:87] offset:21504
  ds_write_b128 v4, a[88:91] offset:22528
  ds_write_b128 v4, a[92:95] offset:23552
  v_add_u32 v83, 0x1c000, v81
  v_xor_b32 v84, 32, v83
  ds_read_b64_tr_b16 a[48:49], v83 offset:0
  ds_read_b64_tr_b16 a[50:51], v83 offset:512
  ds_read_b64_tr_b16 a[52:53], v83 offset:8192
  ds_read_b64_tr_b16 a[54:55], v83 offset:8704
  ds_read_b64_tr_b16 a[56:57], v84 offset:0
  ds_read_b64_tr_b16 a[58:59], v84 offset:512
  ds_read_b64_tr_b16 a[60:61], v84 offset:8192
  ds_read_b64_tr_b16 a[62:63], v84 offset:8704
  s_waitcnt lgkmcnt(0)
  s_waitcnt vmcnt(30)
  s_barrier
  v_add_u32 v83, 0x20000, v81
  v_xor_b32 v84, 32, v83
  ds_read_b64_tr_b16 a[0:1], v83 offset:0
  ds_read_b64_tr_b16 a[2:3], v83 offset:512
  ds_read_b64_tr_b16 a[4:5], v83 offset:8192
  ds_read_b64_tr_b16 a[6:7], v83 offset:8704
  ds_read_b64_tr_b16 a[8:9], v84 offset:0
  ds_read_b64_tr_b16 a[10:11], v84 offset:512
  ds_read_b64_tr_b16 a[12:13], v84 offset:8192
  ds_read_b64_tr_b16 a[14:15], v84 offset:8704
  s_waitcnt lgkmcnt(0)
  s_waitcnt vmcnt(26)
  s_barrier
  v_add_u32 v83, 0x24000, v81
  v_xor_b32 v84, 32, v83
  ds_read_b64_tr_b16 a[16:17], v83 offset:0
  ds_read_b64_tr_b16 a[18:19], v83 offset:512
  ds_read_b64_tr_b16 a[20:21], v83 offset:8192
  ds_read_b64_tr_b16 a[22:23], v83 offset:8704
  ds_read_b64_tr_b16 a[24:25], v84 offset:0
  ds_read_b64_tr_b16 a[26:27], v84 offset:512
  ds_read_b64_tr_b16 a[28:29], v84 offset:8192
  ds_read_b64_tr_b16 a[30:31], v84 offset:8704
  s_waitcnt lgkmcnt(0)
  s_waitcnt vmcnt(22)
  s_barrier
  s_waitcnt lgkmcnt(0)
  v_add_u32 v83, 0x0, v81
  v_xor_b32 v84, 32, v83
  ds_read_b64_tr_b16 a[96:97], v83 offset:0
  ds_read_b64_tr_b16 a[98:99], v83 offset:512
  ds_read_b64_tr_b16 a[100:101], v83 offset:8192
  ds_read_b64_tr_b16 a[102:103], v83 offset:8704
  ds_read_b64_tr_b16 a[104:105], v84 offset:0
  ds_read_b64_tr_b16 a[106:107], v84 offset:512
  ds_read_b64_tr_b16 a[108:109], v84 offset:8192
  ds_read_b64_tr_b16 a[110:111], v84 offset:8704
  s_waitcnt lgkmcnt(0)
  s_waitcnt vmcnt(18)
  s_barrier
  v_add_u32 v83, 0x4000, v81
  v_xor_b32 v84, 32, v83
  ds_read_b64_tr_b16 a[112:113], v83 offset:0
  ds_read_b64_tr_b16 a[114:115], v83 offset:512
  ds_read_b64_tr_b16 a[116:117], v83 offset:8192
  ds_read_b64_tr_b16 a[118:119], v83 offset:8704
  ds_read_b64_tr_b16 a[120:121], v84 offset:0
  ds_read_b64_tr_b16 a[122:123], v84 offset:512
  ds_read_b64_tr_b16 a[124:125], v84 offset:8192
  ds_read_b64_tr_b16 a[126:127], v84 offset:8704
  s_waitcnt lgkmcnt(0)
  s_waitcnt vmcnt(8)
  s_barrier
  v_add_u32 v83, 0x8000, v81
  v_xor_b32 v84, 32, v83
  ds_read_b64_tr_b16 a[64:65], v83 offset:0
  ds_read_b64_tr_b16 a[66:67], v83 offset:512
  ds_read_b64_tr_b16 a[68:69], v83 offset:8192
  ds_read_b64_tr_b16 a[70:71], v83 offset:8704
  ds_read_b64_tr_b16 a[72:73], v84 offset:0
  ds_read_b64_tr_b16 a[74:75], v84 offset:512
  ds_read_b64_tr_b16 a[76:77], v84 offset:8192
  ds_read_b64_tr_b16 a[78:79], v84 offset:8704
  s_waitcnt lgkmcnt(0)
  s_waitcnt vmcnt(4)
  s_barrier
  v_add_u32 v83, 0xc000, v81
  v_xor_b32 v84, 32, v83
  ds_read_b64_tr_b16 a[80:81], v83 offset:0
  ds_read_b64_tr_b16 a[82:83], v83 offset:512
  ds_read_b64_tr_b16 a[84:85], v83 offset:8192
  ds_read_b64_tr_b16 a[86:87], v83 offset:8704
  ds_read_b64_tr_b16 a[88:89], v84 offset:0
  ds_read_b64_tr_b16 a[90:91], v84 offset:512
  ds_read_b64_tr_b16 a[92:93], v84 offset:8192
  ds_read_b64_tr_b16 a[94:95], v84 offset:8704
  s_waitcnt lgkmcnt(0)
  s_barrier
  s_branch L_wdone
L_wb2:
  s_cmp_lg_u32 s13, 2
  s_cbranch_scc1 L_wb3
  s_cmp_lg_u32 s80, 0
  s_cselect_b32 s29, 112, 16
  s_waitcnt vmcnt(16)
  s_barrier
  v_xor_b32 v79, 0, v76
  v_lshlrev_b32 v79, 4, v79
  v_lshl_add_u32 v79, v75, 10, v79
  v_xor_b32 v80, 128, v79
  v_and_b32 v73, 3, v72
  v_bfe_u32 v74, v72, 2, 2
  v_lshrrev_b32 v85, 1, v74
  v_and_b32 v86, 1, v74
  v_and_b32 v87, 1, v75
  v_lshrrev_b32 v76, 1, v75
  v_lshlrev_b32 v76, 4, v76
  v_lshl_add_u32 v76, v85, 3, v76
  v_lshl_add_u32 v76, v87, 2, v76
  v_add_u32 v76, v76, v86
  v_lshlrev_b32 v81, 8, v76
  v_lshlrev_b32 v76, 1, v86
  v_lshl_add_u32 v76, v87, 2, v76
  v_lshl_add_u32 v76, v85, 3, v76
  v_lshrrev_b32 v77, 1, v73
  v_add_u32 v83, 8, v77
  v_xor_b32 v76, v76, v83
  v_lshl_add_u32 v81, v76, 4, v81
  v_and_b32 v84, 1, v73
  v_lshl_add_u32 v81, v84, 3, v81
  v_lshrrev_b32 v76, 1, v75
  v_lshlrev_b32 v76, 3, v76
  v_lshl_add_u32 v76, v87, 4, v76
  v_lshl_add_u32 v76, v85, 2, v76
  v_add_u32 v76, v76, v86
  v_lshlrev_b32 v82, 8, v76
  v_lshlrev_b32 v76, 1, v86
  v_lshl_add_u32 v76, v85, 2, v76
  v_lshl_add_u32 v76, v87, 3, v76
  v_xor_b32 v76, v76, v77
  v_lshl_add_u32 v82, v76, 4, v82
  v_lshl_add_u32 v82, v84, 3, v82
  s_lshl_b32 s77, s12, 17
  s_and_b32 s78, s12, 1
  s_lshl_b32 s78, s78, 7
  s_mov_b32 m0, 0x18800
  s_add_u32 s79, s76, 0x204000
  buffer_load_dwordx4 v78, s[72:75], s79 offen nt lds
  s_mov_b32 m0, 0x19800
  s_add_u32 s79, s76, 0x284000
  buffer_load_dwordx4 v78, s[72:75], s79 offen nt lds
  s_mov_b32 m0, 0x1a800
  s_add_u32 s79, s76, 0x20c000
  buffer_load_dwordx4 v78, s[72:75], s79 offen nt lds
  s_mov_b32 m0, 0x1b800
  s_add_u32 s79, s76, 0x28c000
  buffer_load_dwordx4 v78, s[72:75], s79 offen nt lds
  s_mov_b32 m0, 0x1c800
  s_add_u32 s79, s76, 0x214000
  buffer_load_dwordx4 v78, s[72:75], s79 offen nt lds
  s_mov_b32 m0, 0x1d800
  s_add_u32 s79, s76, 0x294000
  buffer_load_dwordx4 v78, s[72:75], s79 offen nt lds
  s_mov_b32 m0, 0x1e800
  s_add_u32 s79, s76, 0x21c000
  buffer_load_dwordx4 v78, s[72:75], s79 offen nt lds
  s_mov_b32 m0, 0x1f800
  s_add_u32 s79, s76, 0x29c000
  buffer_load_dwordx4 v78, s[72:75], s79 offen nt lds
  s_mov_b32 m0, 0x20800
  s_add_u32 s79, s76, 0x304000
  buffer_load_dwordx4 v78, s[72:75], s79 offen nt lds
  s_mov_b32 m0, 0x21800
  s_add_u32 s79, s76, 0x384000
  buffer_load_dwordx4 v78, s[72:75], s79 offen nt lds
  s_mov_b32 m0, 0x22800
  s_add_u32 s79, s76, 0x30c000
  buffer_load_dwordx4 v78, s[72:75], s79 offen nt lds
  s_mov_b32 m0, 0x23800
  s_add_u32 s79, s76, 0x38c000
  buffer_load_dwordx4 v78, s[72:75], s79 offen nt lds
  s_mov_b32 m0, 0x24800
  s_add_u32 s79, s76, 0x314000
  buffer_load_dwordx4 v78, s[72:75], s79 offen nt lds
  s_mov_b32 m0, 0x25800
  s_add_u32 s79, s76, 0x394000
  buffer_load_dwordx4 v78, s[72:75], s79 offen nt lds
  s_mov_b32 m0, 0x26800
  s_add_u32 s79, s76, 0x31c000
  buffer_load_dwordx4 v78, s[72:75], s79 offen nt lds
  s_mov_b32 m0, 0x27800
  s_add_u32 s79, s76, 0x39c000
  buffer_load_dwordx4 v78, s[72:75], s79 offen nt lds
  s_mov_b32 m0, 0x800
  s_add_u32 s79, s77, 0x2000
  buffer_load_dwordx4 v79, s[68:71], s79 offen nt lds
  s_mov_b32 m0, 0x1800
  s_add_u32 s79, s77, 0x6000
  buffer_load_dwordx4 v80, s[68:71], s79 offen nt lds
  s_mov_b32 m0, 0x2800
  s_add_u32 s79, s77, 0xa000
  buffer_load_dwordx4 v79, s[68:71], s79 offen nt lds
  s_mov_b32 m0, 0x3800
  s_add_u32 s79, s77, 0xe000
  buffer_load_dwordx4 v80, s[68:71], s79 offen nt lds
  s_mov_b32 m0, 0x4800
  s_add_u32 s79, s77, 0x2100
  buffer_load_dwordx4 v79, s[68:71], s79 offen nt lds
  s_mov_b32 m0, 0x5800
  s_add_u32 s79, s77, 0x6100
  buffer_load_dwordx4 v80, s[68:71], s79 offen nt lds
  s_mov_b32 m0, 0x6800
  s_add_u32 s79, s77, 0xa100
  buffer_load_dwordx4 v79, s[68:71], s79 offen nt lds
  s_mov_b32 m0, 0x7800
  s_add_u32 s79, s77, 0xe100
  buffer_load_dwordx4 v80, s[68:71], s79 offen nt lds
  s_waitcnt vmcnt(36)
  s_barrier
  v_add_u32 v83, 0x8000, v81
  v_xor_b32 v84, 32, v83
  ds_read_b64_tr_b16 a[0:1], v83 offset:0
  ds_read_b64_tr_b16 a[2:3], v83 offset:512
  ds_read_b64_tr_b16 a[4:5], v83 offset:8192
  ds_read_b64_tr_b16 a[6:7], v83 offset:8704
  ds_read_b64_tr_b16 a[8:9], v84 offset:0
  ds_read_b64_tr_b16 a[10:11], v84 offset:512
  ds_read_b64_tr_b16 a[12:13], v84 offset:8192
  ds_read_b64_tr_b16 a[14:15], v84 offset:8704
  s_waitcnt lgkmcnt(0)
  s_waitcnt vmcnt(32)
  s_barrier
  s_mov_b32 m0, 0x8800
  s_add_u32 s79, s77, 0x2200
  buffer_load_dwordx4 v79, s[68:71], s79 offen nt lds
  s_mov_b32 m0, 0x9800
  s_add_u32 s79, s77, 0x6200
  buffer_load_dwordx4 v80, s[68:71], s79 offen nt lds
  s_mov_b32 m0, 0xa800
  s_add_u32 s79, s77, 0xa200
  buffer_load_dwordx4 v79, s[68:71], s79 offen nt lds
  s_mov_b32 m0, 0xb800
  s_add_u32 s79, s77, 0xe200
  buffer_load_dwordx4 v80, s[68:71], s79 offen nt lds
  v_add_u32 v83, 0xc000, v81
  v_xor_b32 v84, 32, v83
  ds_read_b64_tr_b16 a[16:17], v83 offset:0
  ds_read_b64_tr_b16 a[18:19], v83 offset:512
  ds_read_b64_tr_b16 a[20:21], v83 offset:8192
  ds_read_b64_tr_b16 a[22:23], v83 offset:8704
  ds_read_b64_tr_b16 a[24:25], v84 offset:0
  ds_read_b64_tr_b16 a[26:27], v84 offset:512
  ds_read_b64_tr_b16 a[28:29], v84 offset:8192
  ds_read_b64_tr_b16 a[30:31], v84 offset:8704
  s_waitcnt lgkmcnt(0)
  s_waitcnt vmcnt(32)
  s_barrier
  s_mov_b32 m0, 0xc800
  s_add_u32 s79, s77, 0x2300
  buffer_load_dwordx4 v79, s[68:71], s79 offen nt lds
  s_mov_b32 m0, 0xd800
  s_add_u32 s79, s77, 0x6300
  buffer_load_dwordx4 v80, s[68:71], s79 offen nt lds
  s_mov_b32 m0, 0xe800
  s_add_u32 s79, s77, 0xa300
  buffer_load_dwordx4 v79, s[68:71], s79 offen nt lds
  s_mov_b32 m0, 0xf800
  s_add_u32 s79, s77, 0xe300
  buffer_load_dwordx4 v80, s[68:71], s79 offen nt lds
  v_add_u32 v83, 0x10000, v81
  v_xor_b32 v84, 32, v83
  ds_read_b64_tr_b16 a[128:129], v83 offset:0
  ds_read_b64_tr_b16 a[130:131], v83 offset:512
  ds_read_b64_tr_b16 a[132:133], v83 offset:8192
  ds_read_b64_tr_b16 a[134:135], v83 offset:8704
  ds_read_b64_tr_b16 a[144:145], v84 offset:0
  ds_read_b64_tr_b16 a[146:147], v84 offset:512
  ds_read_b64_tr_b16 a[148:149], v84 offset:8192
  ds_read_b64_tr_b16 a[150:151], v84 offset:8704
  s_waitcnt lgkmcnt(0)
  s_waitcnt vmcnt(32)
  s_barrier
  s_mov_b32 m0, 0x10800
  s_add_u32 s79, s77, 0x12000
  buffer_load_dwordx4 v79, s[68:71], s79 offen nt lds
  s_mov_b32 m0, 0x11800
  s_add_u32 s79, s77, 0x16000
  buffer_load_dwordx4 v80, s[68:71], s79 offen nt lds
  s_mov_b32 m0, 0x12800
  s_add_u32 s79, s77, 0x1a000
  buffer_load_dwordx4 v79, s[68:71], s79 offen nt lds
  s_mov_b32 m0, 0x13800
  s_add_u32 s79, s77, 0x1e000
  buffer_load_dwordx4 v80, s[68:71], s79 offen nt lds
  v_add_u32 v83, 0x14000, v81
  v_xor_b32 v84, 32, v83
  ds_read_b64_tr_b16 a[232:233], v83 offset:0
  ds_read_b64_tr_b16 a[234:235], v83 offset:512
  ds_read_b64_tr_b16 a[236:237], v83 offset:8192
  ds_read_b64_tr_b16 a[238:239], v83 offset:8704
  ds_read_b64_tr_b16 a[248:249], v84 offset:0
  ds_read_b64_tr_b16 a[250:251], v84 offset:512
  ds_read_b64_tr_b16 a[252:253], v84 offset:8192
  ds_read_b64_tr_b16 a[254:255], v84 offset:8704
  s_waitcnt lgkmcnt(0)
  s_waitcnt vmcnt(32)
  s_barrier
  s_mov_b32 m0, 0x14800
  s_add_u32 s79, s77, 0x12100
  buffer_load_dwordx4 v79, s[68:71], s79 offen nt lds
  s_mov_b32 m0, 0x15800
  s_add_u32 s79, s77, 0x16100
  buffer_load_dwordx4 v80, s[68:71], s79 offen nt lds
  s_mov_b32 m0, 0x16800
  s_add_u32 s79, s77, 0x1a100
  buffer_load_dwordx4 v79, s[68:71], s79 offen nt lds
  s_mov_b32 m0, 0x17800
  s_add_u32 s79, s77, 0x1e100
  buffer_load_dwordx4 v80, s[68:71], s79 offen nt lds
  v_add_u32 v83, 0x18000, v81
  v_xor_b32 v84, 32, v83
  ds_read_b64_tr_b16 v[40:41], v83 offset:0
  ds_read_b64_tr_b16 v[42:43], v83 offset:512
  ds_read_b64_tr_b16 v[44:45], v83 offset:8192
  ds_read_b64_tr_b16 v[46:47], v83 offset:8704
  ds_read_b64_tr_b16 v[48:49], v84 offset:0
  ds_read_b64_tr_b16 v[50:51], v84 offset:512
  ds_read_b64_tr_b16 v[52:53], v84 offset:8192
  ds_read_b64_tr_b16 v[54:55], v84 offset:8704
  s_waitcnt lgkmcnt(0)
  s_waitcnt vmcnt(32)
  s_barrier
  s_mov_b32 m0, 0x18800
  s_add_u32 s79, s77, 0x12200
  buffer_load_dwordx4 v79, s[68:71], s79 offen nt lds
  s_mov_b32 m0, 0x19800
  s_add_u32 s79, s77, 0x16200
  buffer_load_dwordx4 v80, s[68:71], s79 offen nt lds
  s_mov_b32 m0, 0x1a800
  s_add_u32 s79, s77, 0x1a200
  buffer_load_dwordx4 v79, s[68:71], s79 offen nt lds
  s_mov_b32 m0, 0x1b800
  s_add_u32 s79, s77, 0x1e200
  buffer_load_dwordx4 v80, s[68:71], s79 offen nt lds
  v_add_u32 v83, 0x1c000, v81
  v_xor_b32 v84, 32, v83
  ds_read_b64_tr_b16 v[56:57], v83 offset:0
  ds_read_b64_tr_b16 v[58:59], v83 offset:512
  ds_read_b64_tr_b16 v[60:61], v83 offset:8192
  ds_read_b64_tr_b16 v[62:63], v83 offset:8704
  ds_read_b64_tr_b16 v[64:65], v84 offset:0
  ds_read_b64_tr_b16 v[66:67], v84 offset:512
  ds_read_b64_tr_b16 v[68:69], v84 offset:8192
  ds_read_b64_tr_b16 v[70:71], v84 offset:8704
  s_waitcnt lgkmcnt(0)
  s_waitcnt vmcnt(32)
  s_barrier
  s_mov_b32 m0, 0x1c800
  s_add_u32 s79, s77, 0x12300
  buffer_load_dwordx4 v79, s[68:71], s79 offen nt lds
  s_mov_b32 m0, 0x1d800
  s_add_u32 s79, s77, 0x16300
  buffer_load_dwordx4 v80, s[68:71], s79 offen nt lds
  s_mov_b32 m0, 0x1e800
  s_add_u32 s79, s77, 0x1a300
  buffer_load_dwordx4 v79, s[68:71], s79 offen nt lds
  s_mov_b32 m0, 0x1f800
  s_add_u32 s79, s77, 0x1e300
  buffer_load_dwordx4 v80, s[68:71], s79 offen nt lds
  s_getpc_b64 s[90:91]
L_pc2:
  s_add_u32 s90, s90, L_E_chk-L_pc2+12288
  s_addc_u32 s91, s91, 0
  v_lshlrev_b32 v76, 3, v0
  global_load_dword v77, v76, s[90:91]
  v_add_u32 v83, 0x20000, v81
  v_xor_b32 v84, 32, v83
  ds_read_b64_tr_b16 v[224:225], v83 offset:0
  ds_read_b64_tr_b16 v[226:227], v83 offset:512
  ds_read_b64_tr_b16 v[228:229], v83 offset:8192
  ds_read_b64_tr_b16 v[230:231], v83 offset:8704
  ds_read_b64_tr_b16 v[232:233], v84 offset:0
  ds_read_b64_tr_b16 v[234:235], v84 offset:512
  ds_read_b64_tr_b16 v[236:237], v84 offset:8192
  ds_read_b64_tr_b16 v[238:239], v84 offset:8704
  s_waitcnt lgkmcnt(0)
  s_waitcnt vmcnt(33)
  s_barrier
  s_mov_b32 m0, 0x20800
  s_add_u32 s79, s76, 0x4000
  buffer_load_dwordx4 v78, s[60:63], s79 offen nt lds
  s_mov_b32 m0, 0x21800
  s_add_u32 s79, s76, 0x84000
  buffer_load_dwordx4 v78, s[60:63], s79 offen nt lds
  s_mov_b32 m0, 0x22800
  s_add_u32 s79, s76, 0xc000
  buffer_load_dwordx4 v78, s[60:63], s79 offen nt lds
  s_mov_b32 m0, 0x23800
  s_add_u32 s79, s76, 0x8c000
  buffer_load_dwordx4 v78, s[60:63], s79 offen nt lds
  v_add_u32 v83, 0x24000, v81
  v_xor_b32 v84, 32, v83
  ds_read_b64_tr_b16 v[240:241], v83 offset:0
  ds_read_b64_tr_b16 v[242:243], v83 offset:512
  ds_read_b64_tr_b16 v[244:245], v83 offset:8192
  ds_read_b64_tr_b16 v[246:247], v83 offset:8704
  ds_read_b64_tr_b16 v[248:249], v84 offset:0
  ds_read_b64_tr_b16 v[250:251], v84 offset:512
  ds_read_b64_tr_b16 v[252:253], v84 offset:8192
  ds_read_b64_tr_b16 v[254:255], v84 offset:8704
  s_waitcnt lgkmcnt(0)
  s_waitcnt vmcnt(33)
  s_barrier
  s_mov_b32 m0, 0x24800
  s_add_u32 s79, s76, 0x14000
  buffer_load_dwordx4 v78, s[60:63], s79 offen nt lds
  s_mov_b32 m0, 0x25800
  s_add_u32 s79, s76, 0x94000
  buffer_load_dwordx4 v78, s[60:63], s79 offen nt lds
  s_mov_b32 m0, 0x26800
  s_add_u32 s79, s76, 0x1c000
  buffer_load_dwordx4 v78, s[60:63], s79 offen nt lds
  s_mov_b32 m0, 0x27800
  s_add_u32 s79, s76, 0x9c000
  buffer_load_dwordx4 v78, s[60:63], s79 offen nt lds
  s_waitcnt lgkmcnt(0)
  s_waitcnt vmcnt(33)
  s_barrier
  s_mov_b32 m0, 0x800
  s_add_u32 s79, s76, 0x104000
  buffer_load_dwordx4 v78, s[60:63], s79 offen nt lds
  s_mov_b32 m0, 0x1800
  s_add_u32 s79, s76, 0x184000
  buffer_load_dwordx4 v78, s[60:63], s79 offen nt lds
  s_mov_b32 m0, 0x2800
  s_add_u32 s79, s76, 0x10c000
  buffer_load_dwordx4 v78, s[60:63], s79 offen nt lds
  s_mov_b32 m0, 0x3800
  s_add_u32 s79, s76, 0x18c000
  buffer_load_dwordx4 v78, s[60:63], s79 offen nt lds
  s_waitcnt lgkmcnt(0)
  s_waitcnt vmcnt(33)
  s_barrier
  s_mov_b32 m0, 0x4800
  s_add_u32 s79, s76, 0x114000
  buffer_load_dwordx4 v78, s[60:63], s79 offen nt lds
  s_mov_b32 m0, 0x5800
  s_add_u32 s79, s76, 0x194000
  buffer_load_dwordx4 v78, s[60:63], s79 offen nt lds
  s_mov_b32 m0, 0x6800
  s_add_u32 s79, s76, 0x11c000
  buffer_load_dwordx4 v78, s[60:63], s79 offen nt lds
  s_mov_b32 m0, 0x7800
  s_add_u32 s79, s76, 0x19c000
  buffer_load_dwordx4 v78, s[60:63], s79 offen nt lds
  v_add_u32 v84, 0x8000, v82
  v_xor_b32 v84, s78, v84
  v_xor_b32 v83, 0, v84
  ds_read_b64_tr_b16 a[32:33], v83 offset:8192
  ds_read_b64_tr_b16 a[34:35], v83 offset:8704
  ds_read_b64_tr_b16 a[36:37], v83 offset:0
  ds_read_b64_tr_b16 a[38:39], v83 offset:512
  v_xor_b32 v83, 32, v84
  ds_read_b64_tr_b16 a[40:41], v83 offset:8192
  ds_read_b64_tr_b16 a[42:43], v83 offset:8704
  ds_read_b64_tr_b16 a[44:45], v83 offset:0
  ds_read_b64_tr_b16 a[46:47], v83 offset:512
  v_xor_b32 v83, 64, v84
  ds_read_b64_tr_b16 a[160:161], v83 offset:8192
  ds_read_b64_tr_b16 a[162:163], v83 offset:8704
  ds_read_b64_tr_b16 a[164:165], v83 offset:0
  ds_read_b64_tr_b16 a[166:167], v83 offset:512
  v_xor_b32 v83, 96, v84
  ds_read_b64_tr_b16 a[176:177], v83 offset:8192
  ds_read_b64_tr_b16 a[178:179], v83 offset:8704
  ds_read_b64_tr_b16 a[180:181], v83 offset:0
  ds_read_b64_tr_b16 a[182:183], v83 offset:512
  v_xor_b32 v83, 128, v84
  ds_read_b64_tr_b16 a[192:193], v83 offset:8192
  ds_read_b64_tr_b16 a[194:195], v83 offset:8704
  ds_read_b64_tr_b16 a[196:197], v83 offset:0
  ds_read_b64_tr_b16 a[198:199], v83 offset:512
  v_xor_b32 v83, 160, v84
  ds_read_b64_tr_b16 a[208:209], v83 offset:8192
  ds_read_b64_tr_b16 a[210:211], v83 offset:8704
  ds_read_b64_tr_b16 a[212:213], v83 offset:0
  ds_read_b64_tr_b16 a[214:215], v83 offset:512
  v_xor_b32 v83, 192, v84
  ds_read_b64_tr_b16 a[224:225], v83 offset:8192
  ds_read_b64_tr_b16 a[226:227], v83 offset:8704
  ds_read_b64_tr_b16 a[228:229], v83 offset:0
  ds_read_b64_tr_b16 a[230:231], v83 offset:512
  v_xor_b32 v83, 224, v84
  ds_read_b64_tr_b16 a[240:241], v83 offset:8192
  ds_read_b64_tr_b16 a[242:243], v83 offset:8704
  ds_read_b64_tr_b16 a[244:245], v83 offset:0
  ds_read_b64_tr_b16 a[246:247], v83 offset:512
  s_waitcnt lgkmcnt(0)
  s_waitcnt vmcnt(33)
  s_barrier
  s_mov_b32 m0, 0x8800
  s_add_u32 s79, s76, 0x204000
  buffer_load_dwordx4 v78, s[60:63], s79 offen nt lds
  s_mov_b32 m0, 0x9800
  s_add_u32 s79, s76, 0x284000
  buffer_load_dwordx4 v78, s[60:63], s79 offen nt lds
  s_mov_b32 m0, 0xa800
  s_add_u32 s79, s76, 0x20c000
  buffer_load_dwordx4 v78, s[60:63], s79 offen nt lds
  s_mov_b32 m0, 0xb800
  s_add_u32 s79, s76, 0x28c000
  buffer_load_dwordx4 v78, s[60:63], s79 offen nt lds
  s_waitcnt lgkmcnt(0)
  s_waitcnt vmcnt(33)
  s_barrier
  s_mov_b32 m0, 0xc800
  s_add_u32 s79, s76, 0x214000
  buffer_load_dwordx4 v78, s[60:63], s79 offen nt lds
  s_mov_b32 m0, 0xd800
  s_add_u32 s79, s76, 0x294000
  buffer_load_dwordx4 v78, s[60:63], s79 offen nt lds
  s_mov_b32 m0, 0xe800
  s_add_u32 s79, s76, 0x21c000
  buffer_load_dwordx4 v78, s[60:63], s79 offen nt lds
  s_mov_b32 m0, 0xf800
  s_add_u32 s79, s76, 0x29c000
  buffer_load_dwordx4 v78, s[60:63], s79 offen nt lds
  s_waitcnt lgkmcnt(0)
  s_waitcnt vmcnt(33)
  s_barrier
  s_mov_b32 m0, 0x10800
  s_add_u32 s79, s76, 0x304000
  buffer_load_dwordx4 v78, s[60:63], s79 offen nt lds
  s_mov_b32 m0, 0x11800
  s_add_u32 s79, s76, 0x384000
  buffer_load_dwordx4 v78, s[60:63], s79 offen nt lds
  s_mov_b32 m0, 0x12800
  s_add_u32 s79, s76, 0x30c000
  buffer_load_dwordx4 v78, s[60:63], s79 offen nt lds
  s_mov_b32 m0, 0x13800
  s_add_u32 s79, s76, 0x38c000
  buffer_load_dwordx4 v78, s[60:63], s79 offen nt lds
  s_waitcnt lgkmcnt(0)
  s_waitcnt vmcnt(33)
  s_barrier
  s_mov_b32 m0, 0x14800
  s_add_u32 s79, s76, 0x314000
  buffer_load_dwordx4 v78, s[60:63], s79 offen nt lds
  s_mov_b32 m0, 0x15800
  s_add_u32 s79, s76, 0x394000
  buffer_load_dwordx4 v78, s[60:63], s79 offen nt lds
  s_mov_b32 m0, 0x16800
  s_add_u32 s79, s76, 0x31c000
  buffer_load_dwordx4 v78, s[60:63], s79 offen nt lds
  s_mov_b32 m0, 0x17800
  s_add_u32 s79, s76, 0x39c000
  buffer_load_dwordx4 v78, s[60:63], s79 offen nt lds
  v_add_u32 v84, 0x18000, v82
  v_xor_b32 v84, s78, v84
  v_xor_b32 v83, 0, v84
  ds_read_b64_tr_b16 a[136:137], v83 offset:8192
  ds_read_b64_tr_b16 a[138:139], v83 offset:8704
  ds_read_b64_tr_b16 a[140:141], v83 offset:0
  ds_read_b64_tr_b16 a[142:143], v83 offset:512
  v_xor_b32 v83, 32, v84
  ds_read_b64_tr_b16 a[152:153], v83 offset:8192
  ds_read_b64_tr_b16 a[154:155], v83 offset:8704
  ds_read_b64_tr_b16 a[156:157], v83 offset:0
  ds_read_b64_tr_b16 a[158:159], v83 offset:512
  v_xor_b32 v83, 64, v84
  ds_read_b64_tr_b16 a[168:169], v83 offset:8192
  ds_read_b64_tr_b16 a[170:171], v83 offset:8704
  ds_read_b64_tr_b16 a[172:173], v83 offset:0
  ds_read_b64_tr_b16 a[174:175], v83 offset:512
  v_xor_b32 v83, 96, v84
  ds_read_b64_tr_b16 a[184:185], v83 offset:8192
  ds_read_b64_tr_b16 a[186:187], v83 offset:8704
  ds_read_b64_tr_b16 a[188:189], v83 offset:0
  ds_read_b64_tr_b16 a[190:191], v83 offset:512
  v_xor_b32 v83, 128, v84
  ds_read_b64_tr_b16 a[200:201], v83 offset:8192
  ds_read_b64_tr_b16 a[202:203], v83 offset:8704
  ds_read_b64_tr_b16 a[204:205], v83 offset:0
  ds_read_b64_tr_b16 a[206:207], v83 offset:512
  v_xor_b32 v83, 160, v84
  ds_read_b64_tr_b16 a[216:217], v83 offset:8192
  ds_read_b64_tr_b16 a[218:219], v83 offset:8704
  ds_read_b64_tr_b16 a[220:221], v83 offset:0
  ds_read_b64_tr_b16 a[222:223], v83 offset:512
  v_xor_b32 v83, 192, v84
  ds_read_b64_tr_b16 a[48:49], v83 offset:8192
  ds_read_b64_tr_b16 a[50:51], v83 offset:8704
  ds_read_b64_tr_b16 a[52:53], v83 offset:0
  ds_read_b64_tr_b16 a[54:55], v83 offset:512
  v_xor_b32 v83, 224, v84
  ds_read_b64_tr_b16 a[56:57], v83 offset:8192
  ds_read_b64_tr_b16 a[58:59], v83 offset:8704
  ds_read_b64_tr_b16 a[60:61], v83 offset:0
  ds_read_b64_tr_b16 a[62:63], v83 offset:512
  s_waitcnt lgkmcnt(0)
  s_waitcnt vmcnt(33)
  s_barrier
  s_mov_b32 m0, 0x18800
  s_add_u32 s79, s76, 0x4000
  buffer_load_dwordx4 v78, s[64:67], s79 offen nt lds
  s_mov_b32 m0, 0x19800
  s_add_u32 s79, s76, 0x84000
  buffer_load_dwordx4 v78, s[64:67], s79 offen nt lds
  s_mov_b32 m0, 0x1a800
  s_add_u32 s79, s76, 0xc000
  buffer_load_dwordx4 v78, s[64:67], s79 offen nt lds
  s_mov_b32 m0, 0x1b800
  s_add_u32 s79, s76, 0x8c000
  buffer_load_dwordx4 v78, s[64:67], s79 offen nt lds
  s_waitcnt lgkmcnt(0)
  s_waitcnt vmcnt(32)
  s_barrier
  s_mov_b32 m0, 0x1c800
  s_add_u32 s79, s76, 0x14000
  buffer_load_dwordx4 v78, s[64:67], s79 offen nt lds
  s_mov_b32 m0, 0x1d800
  s_add_u32 s79, s76, 0x94000
  buffer_load_dwordx4 v78, s[64:67], s79 offen nt lds
  s_mov_b32 m0, 0x1e800
  s_add_u32 s79, s76, 0x1c000
  buffer_load_dwordx4 v78, s[64:67], s79 offen nt lds
  s_mov_b32 m0, 0x1f800
  s_add_u32 s79, s76, 0x9c000
  buffer_load_dwordx4 v78, s[64:67], s79 offen nt lds
  v_add_u32 v83, 0x20000, v81
  v_xor_b32 v84, 32, v83
  ds_read_b64_tr_b16 v[160:161], v83 offset:0
  ds_read_b64_tr_b16 v[162:163], v83 offset:512
  ds_read_b64_tr_b16 v[164:165], v83 offset:8192
  ds_read_b64_tr_b16 v[166:167], v83 offset:8704
  ds_read_b64_tr_b16 v[168:169], v84 offset:0
  ds_read_b64_tr_b16 v[170:171], v84 offset:512
  ds_read_b64_tr_b16 v[172:173], v84 offset:8192
  ds_read_b64_tr_b16 v[174:175], v84 offset:8704
  s_waitcnt lgkmcnt(0)
  s_waitcnt vmcnt(32)
  s_barrier
  s_mov_b32 m0, 0x20800
  s_add_u32 s79, s76, 0x104000
  buffer_load_dwordx4 v78, s[64:67], s79 offen nt lds
  s_mov_b32 m0, 0x21800
  s_add_u32 s79, s76, 0x184000
  buffer_load_dwordx4 v78, s[64:67], s79 offen nt lds
  s_mov_b32 m0, 0x22800
  s_add_u32 s79, s76, 0x10c000
  buffer_load_dwordx4 v78, s[64:67], s79 offen nt lds
  s_mov_b32 m0, 0x23800
  s_add_u32 s79, s76, 0x18c000
  buffer_load_dwordx4 v78, s[64:67], s79 offen nt lds
  v_add_u32 v83, 0x24000, v81
  v_xor_b32 v84, 32, v83
  ds_read_b64_tr_b16 v[176:177], v83 offset:0
  ds_read_b64_tr_b16 v[178:179], v83 offset:512
  ds_read_b64_tr_b16 v[180:181], v83 offset:8192
  ds_read_b64_tr_b16 v[182:183], v83 offset:8704
  ds_read_b64_tr_b16 v[184:185], v84 offset:0
  ds_read_b64_tr_b16 v[186:187], v84 offset:512
  ds_read_b64_tr_b16 v[188:189], v84 offset:8192
  ds_read_b64_tr_b16 v[190:191], v84 offset:8704
  s_waitcnt lgkmcnt(0)
  s_waitcnt vmcnt(32)
  s_barrier
  s_mov_b32 m0, 0x24800
  s_add_u32 s79, s76, 0x114000
  buffer_load_dwordx4 v78, s[64:67], s79 offen nt lds
  s_mov_b32 m0, 0x25800
  s_add_u32 s79, s76, 0x194000
  buffer_load_dwordx4 v78, s[64:67], s79 offen nt lds
  s_mov_b32 m0, 0x26800
  s_add_u32 s79, s76, 0x11c000
  buffer_load_dwordx4 v78, s[64:67], s79 offen nt lds
  s_mov_b32 m0, 0x27800
  s_add_u32 s79, s76, 0x19c000
  buffer_load_dwordx4 v78, s[64:67], s79 offen nt lds
  v_add_u32 v83, 0x0, v81
  v_xor_b32 v84, 32, v83
  ds_read_b64_tr_b16 v[192:193], v83 offset:0
  ds_read_b64_tr_b16 v[194:195], v83 offset:512
  ds_read_b64_tr_b16 v[196:197], v83 offset:8192
  ds_read_b64_tr_b16 v[198:199], v83 offset:8704
  ds_read_b64_tr_b16 v[200:201], v84 offset:0
  ds_read_b64_tr_b16 v[202:203], v84 offset:512
  ds_read_b64_tr_b16 v[204:205], v84 offset:8192
  ds_read_b64_tr_b16 v[206:207], v84 offset:8704
  s_waitcnt lgkmcnt(0)
  s_waitcnt vmcnt(32)
  s_barrier
  s_mov_b32 m0, 0x800
  s_add_u32 s79, s76, 0x204000
  buffer_load_dwordx4 v78, s[64:67], s79 offen nt lds
  s_mov_b32 m0, 0x1800
  s_add_u32 s79, s76, 0x284000
  buffer_load_dwordx4 v78, s[64:67], s79 offen nt lds
  s_mov_b32 m0, 0x2800
  s_add_u32 s79, s76, 0x20c000
  buffer_load_dwordx4 v78, s[64:67], s79 offen nt lds
  s_mov_b32 m0, 0x3800
  s_add_u32 s79, s76, 0x28c000
  buffer_load_dwordx4 v78, s[64:67], s79 offen nt lds
  v_add_u32 v83, 0x4000, v81
  v_xor_b32 v84, 32, v83
  ds_read_b64_tr_b16 v[208:209], v83 offset:0
  ds_read_b64_tr_b16 v[210:211], v83 offset:512
  ds_read_b64_tr_b16 v[212:213], v83 offset:8192
  ds_read_b64_tr_b16 v[214:215], v83 offset:8704
  ds_read_b64_tr_b16 v[216:217], v84 offset:0
  ds_read_b64_tr_b16 v[218:219], v84 offset:512
  ds_read_b64_tr_b16 v[220:221], v84 offset:8192
  ds_read_b64_tr_b16 v[222:223], v84 offset:8704
  s_waitcnt lgkmcnt(0)
  s_waitcnt vmcnt(32)
  s_barrier
  s_mov_b32 m0, 0x4800
  s_add_u32 s79, s76, 0x214000
  buffer_load_dwordx4 v78, s[64:67], s79 offen nt lds
  s_mov_b32 m0, 0x5800
  s_add_u32 s79, s76, 0x294000
  buffer_load_dwordx4 v78, s[64:67], s79 offen nt lds
  s_mov_b32 m0, 0x6800
  s_add_u32 s79, s76, 0x21c000
  buffer_load_dwordx4 v78, s[64:67], s79 offen nt lds
  s_mov_b32 m0, 0x7800
  s_add_u32 s79, s76, 0x29c000
  buffer_load_dwordx4 v78, s[64:67], s79 offen nt lds
  buffer_load_dwordx4 v[16:19], v0, s[4:7], s20 offen sc1
  buffer_load_dwordx4 v[16:19], v0, s[4:7], s16 offen offset:0 sc1
  buffer_load_dwordx4 v[16:19], v0, s[4:7], s21 offen sc1
  buffer_load_dwordx4 v[16:19], v0, s[4:7], s16 offen offset:1024 sc1
  buffer_load_dword v16, off, s[4:7], s24 sc1
  s_add_u32 s27, s22, 0x17a000
  buffer_load_dword v16, off, s[4:7], s27 sc1
  v_add_u32 v83, 0x8000, v81
  v_xor_b32 v84, 32, v83
  ds_read_b64_tr_b16 v[96:97], v83 offset:0
  ds_read_b64_tr_b16 v[98:99], v83 offset:512
  ds_read_b64_tr_b16 v[100:101], v83 offset:8192
  ds_read_b64_tr_b16 v[102:103], v83 offset:8704
  ds_read_b64_tr_b16 v[104:105], v84 offset:0
  ds_read_b64_tr_b16 v[106:107], v84 offset:512
  ds_read_b64_tr_b16 v[108:109], v84 offset:8192
  ds_read_b64_tr_b16 v[110:111], v84 offset:8704
  s_waitcnt lgkmcnt(0)
  s_waitcnt vmcnt(38)
  s_barrier
  s_mov_b32 m0, 0x8800
  s_add_u32 s79, s76, 0x304000
  buffer_load_dwordx4 v78, s[64:67], s79 offen nt lds
  s_mov_b32 m0, 0x9800
  s_add_u32 s79, s76, 0x384000
  buffer_load_dwordx4 v78, s[64:67], s79 offen nt lds
  s_mov_b32 m0, 0xa800
  s_add_u32 s79, s76, 0x30c000
  buffer_load_dwordx4 v78, s[64:67], s79 offen nt lds
  s_mov_b32 m0, 0xb800
  s_add_u32 s79, s76, 0x38c000
  buffer_load_dwordx4 v78, s[64:67], s79 offen nt lds
  v_add_u32 v83, 0xc000, v81
  v_xor_b32 v84, 32, v83
  ds_read_b64_tr_b16 v[112:113], v83 offset:0
  ds_read_b64_tr_b16 v[114:115], v83 offset:512
  ds_read_b64_tr_b16 v[116:117], v83 offset:8192
  ds_read_b64_tr_b16 v[118:119], v83 offset:8704
  ds_read_b64_tr_b16 v[120:121], v84 offset:0
  ds_read_b64_tr_b16 v[122:123], v84 offset:512
  ds_read_b64_tr_b16 v[124:125], v84 offset:8192
  ds_read_b64_tr_b16 v[126:127], v84 offset:8704
  s_waitcnt lgkmcnt(0)
  s_waitcnt vmcnt(38)
  s_barrier
  s_mov_b32 m0, 0xc800
  s_add_u32 s79, s76, 0x314000
  buffer_load_dwordx4 v78, s[64:67], s79 offen nt lds
  s_mov_b32 m0, 0xd800
  s_add_u32 s79, s76, 0x394000
  buffer_load_dwordx4 v78, s[64:67], s79 offen nt lds
  s_mov_b32 m0, 0xe800
  s_add_u32 s79, s76, 0x31c000
  buffer_load_dwordx4 v78, s[64:67], s79 offen nt lds
  s_mov_b32 m0, 0xf800
  s_add_u32 s79, s76, 0x39c000
  buffer_load_dwordx4 v78, s[64:67], s79 offen nt lds
  v_add_u32 v83, 0x10000, v81
  v_xor_b32 v84, 32, v83
  ds_read_b64_tr_b16 v[128:129], v83 offset:0
  ds_read_b64_tr_b16 v[130:131], v83 offset:512
  ds_read_b64_tr_b16 v[132:133], v83 offset:8192
  ds_read_b64_tr_b16 v[134:135], v83 offset:8704
  ds_read_b64_tr_b16 v[136:137], v84 offset:0
  ds_read_b64_tr_b16 v[138:139], v84 offset:512
  ds_read_b64_tr_b16 v[140:141], v84 offset:8192
  ds_read_b64_tr_b16 v[142:143], v84 offset:8704
  s_waitcnt lgkmcnt(0)
  s_waitcnt vmcnt(38)
  s_barrier
  v_add_u32 v83, 0x14000, v81
  v_xor_b32 v84, 32, v83
  ds_read_b64_tr_b16 v[144:145], v83 offset:0
  ds_read_b64_tr_b16 v[146:147], v83 offset:512
  ds_read_b64_tr_b16 v[148:149], v83 offset:8192
  ds_read_b64_tr_b16 v[150:151], v83 offset:8704
  ds_read_b64_tr_b16 v[152:153], v84 offset:0
  ds_read_b64_tr_b16 v[154:155], v84 offset:512
  ds_read_b64_tr_b16 v[156:157], v84 offset:8192
  ds_read_b64_tr_b16 v[158:159], v84 offset:8704
  s_waitcnt lgkmcnt(0)
  s_waitcnt vmcnt(34)
  s_barrier
  buffer_load_dword v32, off, s[48:51], 0 offset:16 sc1
  buffer_load_dword v34, off, s[48:51], s29 sc1
  s_mul_i32 s27, s80, 72
  buffer_load_dword v33, off, s[48:51], s27 sc1
  s_mov_b64 exec, 0x3f
  buffer_load_dword v11, v0, s[4:7], s58 offen sc1
  s_mov_b64 exec, -1
  v_add_u32 v83, 0x18000, v81
  v_xor_b32 v84, 32, v83
  ds_read_b64_tr_b16 a[64:65], v83 offset:0
  ds_read_b64_tr_b16 a[66:67], v83 offset:512
  ds_read_b64_tr_b16 a[68:69], v83 offset:8192
  ds_read_b64_tr_b16 a[70:71], v83 offset:8704
  ds_read_b64_tr_b16 a[72:73], v84 offset:0
  ds_read_b64_tr_b16 a[74:75], v84 offset:512
  ds_read_b64_tr_b16 a[76:77], v84 offset:8192
  ds_read_b64_tr_b16 a[78:79], v84 offset:8704
  s_waitcnt lgkmcnt(0)
  s_waitcnt vmcnt(34)
  s_barrier
  v_add_u32 v83, 0x1c000, v81
  v_xor_b32 v84, 32, v83
  ds_read_b64_tr_b16 a[80:81], v83 offset:0
  ds_read_b64_tr_b16 a[82:83], v83 offset:512
  ds_read_b64_tr_b16 a[84:85], v83 offset:8192
  ds_read_b64_tr_b16 a[86:87], v83 offset:8704
  ds_read_b64_tr_b16 a[88:89], v84 offset:0
  ds_read_b64_tr_b16 a[90:91], v84 offset:512
  ds_read_b64_tr_b16 a[92:93], v84 offset:8192
  ds_read_b64_tr_b16 a[94:95], v84 offset:8704
  s_waitcnt lgkmcnt(0)
  s_waitcnt vmcnt(30)
  s_barrier
  ds_write_b128 v4, v[40:43] offset:0
  ds_write_b128 v4, v[44:47] offset:1024
  ds_write_b128 v4, v[48:51] offset:2048
  ds_write_b128 v4, v[52:55] offset:3072
  ds_write_b128 v4, v[56:59] offset:4096
  ds_write_b128 v4, v[60:63] offset:5120
  ds_write_b128 v4, v[64:67] offset:6144
  ds_write_b128 v4, v[68:71] offset:7168
  ds_write_b128 v4, a[0:3] offset:8192
  ds_write_b128 v4, a[4:7] offset:9216
  ds_write_b128 v4, a[8:11] offset:10240
  ds_write_b128 v4, a[12:15] offset:11264
  ds_write_b128 v4, a[16:19] offset:12288
  ds_write_b128 v4, a[20:23] offset:13312
  ds_write_b128 v4, a[24:27] offset:14336
  ds_write_b128 v4, a[28:31] offset:15360
  v_add_u32 v83, 0x20000, v81
  v_xor_b32 v84, 32, v83
  ds_read_b64_tr_b16 a[96:97], v83 offset:0
  ds_read_b64_tr_b16 a[98:99], v83 offset:512
  ds_read_b64_tr_b16 a[100:101], v83 offset:8192
  ds_read_b64_tr_b16 a[102:103], v83 offset:8704
  ds_read_b64_tr_b16 a[104:105], v84 offset:0
  ds_read_b64_tr_b16 a[106:107], v84 offset:512
  ds_read_b64_tr_b16 a[108:109], v84 offset:8192
  ds_read_b64_tr_b16 a[110:111], v84 offset:8704
  s_waitcnt lgkmcnt(0)
  s_waitcnt vmcnt(26)
  s_barrier
  ds_write_b128 v4, a[32:35] offset:16384
  ds_write_b128 v4, a[36:39] offset:17408
  ds_write_b128 v4, a[40:43] offset:18432
  ds_write_b128 v4, a[44:47] offset:19456
  ds_write_b128 v4, a[48:51] offset:20480
  ds_write_b128 v4, a[52:55] offset:21504
  ds_write_b128 v4, a[56:59] offset:22528
  ds_write_b128 v4, a[60:63] offset:23552
  v_add_u32 v83, 0x24000, v81
  v_xor_b32 v84, 32, v83
  ds_read_b64_tr_b16 a[112:113], v83 offset:0
  ds_read_b64_tr_b16 a[114:115], v83 offset:512
  ds_read_b64_tr_b16 a[116:117], v83 offset:8192
  ds_read_b64_tr_b16 a[118:119], v83 offset:8704
  ds_read_b64_tr_b16 a[120:121], v84 offset:0
  ds_read_b64_tr_b16 a[122:123], v84 offset:512
  ds_read_b64_tr_b16 a[124:125], v84 offset:8192
  ds_read_b64_tr_b16 a[126:127], v84 offset:8704
  s_waitcnt lgkmcnt(0)
  s_waitcnt vmcnt(22)
  s_barrier
  s_waitcnt lgkmcnt(0)
  v_add_u32 v83, 0x0, v81
  v_xor_b32 v84, 32, v83
  ds_read_b64_tr_b16 a[0:1], v83 offset:0
  ds_read_b64_tr_b16 a[2:3], v83 offset:512
  ds_read_b64_tr_b16 a[4:5], v83 offset:8192
  ds_read_b64_tr_b16 a[6:7], v83 offset:8704
  ds_read_b64_tr_b16 a[8:9], v84 offset:0
  ds_read_b64_tr_b16 a[10:11], v84 offset:512
  ds_read_b64_tr_b16 a[12:13], v84 offset:8192
  ds_read_b64_tr_b16 a[14:15], v84 offset:8704
  s_waitcnt lgkmcnt(0)
  s_waitcnt vmcnt(18)
  s_barrier
  v_add_u32 v83, 0x4000, v81
  v_xor_b32 v84, 32, v83
  ds_read_b64_tr_b16 a[16:17], v83 offset:0
  ds_read_b64_tr_b16 a[18:19], v83 offset:512
  ds_read_b64_tr_b16 a[20:21], v83 offset:8192
  ds_read_b64_tr_b16 a[22:23], v83 offset:8704
  ds_read_b64_tr_b16 a[24:25], v84 offset:0
  ds_read_b64_tr_b16 a[26:27], v84 offset:512
  ds_read_b64_tr_b16 a[28:29], v84 offset:8192
  ds_read_b64_tr_b16 a[30:31], v84 offset:8704
  s_waitcnt lgkmcnt(0)
  s_waitcnt vmcnt(8)
  s_barrier
  v_add_u32 v83, 0x8000, v81
  v_xor_b32 v84, 32, v83
  ds_read_b64_tr_b16 a[32:33], v83 offset:0
  ds_read_b64_tr_b16 a[34:35], v83 offset:512
  ds_read_b64_tr_b16 a[36:37], v83 offset:8192
  ds_read_b64_tr_b16 a[38:39], v83 offset:8704
  ds_read_b64_tr_b16 a[40:41], v84 offset:0
  ds_read_b64_tr_b16 a[42:43], v84 offset:512
  ds_read_b64_tr_b16 a[44:45], v84 offset:8192
  ds_read_b64_tr_b16 a[46:47], v84 offset:8704
  s_waitcnt lgkmcnt(0)
  s_waitcnt vmcnt(4)
  s_barrier
  v_add_u32 v83, 0xc000, v81
  v_xor_b32 v84, 32, v83
  ds_read_b64_tr_b16 a[48:49], v83 offset:0
  ds_read_b64_tr_b16 a[50:51], v83 offset:512
  ds_read_b64_tr_b16 a[52:53], v83 offset:8192
  ds_read_b64_tr_b16 a[54:55], v83 offset:8704
  ds_read_b64_tr_b16 a[56:57], v84 offset:0
  ds_read_b64_tr_b16 a[58:59], v84 offset:512
  ds_read_b64_tr_b16 a[60:61], v84 offset:8192
  ds_read_b64_tr_b16 a[62:63], v84 offset:8704
  s_waitcnt lgkmcnt(0)
  s_barrier
  s_branch L_wdone
L_wb3:
  s_cmp_lg_u32 s80, 0
  s_cselect_b32 s29, 112, 16
  s_waitcnt vmcnt(16)
  s_barrier
  v_xor_b32 v79, 4, v76
  v_lshlrev_b32 v79, 4, v79
  v_lshl_add_u32 v79, v75, 10, v79
  v_xor_b32 v80, 128, v79
  v_and_b32 v73, 3, v72
  v_bfe_u32 v74, v72, 2, 2
  v_lshrrev_b32 v85, 1, v74
  v_and_b32 v86, 1, v74
  v_and_b32 v87, 1, v75
  v_lshrrev_b32 v76, 1, v75
  v_lshlrev_b32 v76, 4, v76
  v_lshl_add_u32 v76, v85, 3, v76
  v_lshl_add_u32 v76, v87, 2, v76
  v_add_u32 v76, v76, v86
  v_lshlrev_b32 v81, 8, v76
  v_lshlrev_b32 v76, 1, v86
  v_lshl_add_u32 v76, v87, 2, v76
  v_lshl_add_u32 v76, v85, 3, v76
  v_lshrrev_b32 v77, 1, v73
  v_add_u32 v83, 12, v77
  v_xor_b32 v76, v76, v83
  v_lshl_add_u32 v81, v76, 4, v81
  v_and_b32 v84, 1, v73
  v_lshl_add_u32 v81, v84, 3, v81
  v_lshrrev_b32 v76, 1, v75
  v_lshlrev_b32 v76, 3, v76
  v_lshl_add_u32 v76, v87, 4, v76
  v_lshl_add_u32 v76, v85, 2, v76
  v_add_u32 v76, v76, v86
  v_lshlrev_b32 v82, 8, v76
  v_lshlrev_b32 v76, 1, v86
  v_lshl_add_u32 v76, v85, 2, v76
  v_lshl_add_u32 v76, v87, 3, v76
  v_xor_b32 v76, v76, v77
  v_lshl_add_u32 v82, v76, 4, v82
  v_lshl_add_u32 v82, v84, 3, v82
  s_lshl_b32 s77, s12, 17
  s_and_b32 s78, s12, 1
  s_lshl_b32 s78, s78, 7
  s_mov_b32 m0, 0x18c00
  s_add_u32 s79, s76, 0x206000
  buffer_load_dwordx4 v78, s[72:75], s79 offen nt lds
  s_mov_b32 m0, 0x19c00
  s_add_u32 s79, s76, 0x286000
  buffer_load_dwordx4 v78, s[72:75], s79 offen nt lds
  s_mov_b32 m0, 0x1ac00
  s_add_u32 s79, s76, 0x20e000
  buffer_load_dwordx4 v78, s[72:75], s79 offen nt lds
  s_mov_b32 m0, 0x1bc00
  s_add_u32 s79, s76, 0x28e000
  buffer_load_dwordx4 v78, s[72:75], s79 offen nt lds
  s_mov_b32 m0, 0x1cc00
  s_add_u32 s79, s76, 0x216000
  buffer_load_dwordx4 v78, s[72:75], s79 offen nt lds
  s_mov_b32 m0, 0x1dc00
  s_add_u32 s79, s76, 0x296000
  buffer_load_dwordx4 v78, s[72:75], s79 offen nt lds
  s_mov_b32 m0, 0x1ec00
  s_add_u32 s79, s76, 0x21e000
  buffer_load_dwordx4 v78, s[72:75], s79 offen nt lds
  s_mov_b32 m0, 0x1fc00
  s_add_u32 s79, s76, 0x29e000
  buffer_load_dwordx4 v78, s[72:75], s79 offen nt lds
  s_mov_b32 m0, 0x20c00
  s_add_u32 s79, s76, 0x306000
  buffer_load_dwordx4 v78, s[72:75], s79 offen nt lds
  s_mov_b32 m0, 0x21c00
  s_add_u32 s79, s76, 0x386000
  buffer_load_dwordx4 v78, s[72:75], s79 offen nt lds
  s_mov_b32 m0, 0x22c00
  s_add_u32 s79, s76, 0x30e000
  buffer_load_dwordx4 v78, s[72:75], s79 offen nt lds
  s_mov_b32 m0, 0x23c00
  s_add_u32 s79, s76, 0x38e000
  buffer_load_dwordx4 v78, s[72:75], s79 offen nt lds
  s_mov_b32 m0, 0x24c00
  s_add_u32 s79, s76, 0x316000
  buffer_load_dwordx4 v78, s[72:75], s79 offen nt lds
  s_mov_b32 m0, 0x25c00
  s_add_u32 s79, s76, 0x396000
  buffer_load_dwordx4 v78, s[72:75], s79 offen nt lds
  s_mov_b32 m0, 0x26c00
  s_add_u32 s79, s76, 0x31e000
  buffer_load_dwordx4 v78, s[72:75], s79 offen nt lds
  s_mov_b32 m0, 0x27c00
  s_add_u32 s79, s76, 0x39e000
  buffer_load_dwordx4 v78, s[72:75], s79 offen nt lds
  s_mov_b32 m0, 0xc00
  s_add_u32 s79, s77, 0x3000
  buffer_load_dwordx4 v79, s[68:71], s79 offen nt lds
  s_mov_b32 m0, 0x1c00
  s_add_u32 s79, s77, 0x7000
  buffer_load_dwordx4 v80, s[68:71], s79 offen nt lds
  s_mov_b32 m0, 0x2c00
  s_add_u32 s79, s77, 0xb000
  buffer_load_dwordx4 v79, s[68:71], s79 offen nt lds
  s_mov_b32 m0, 0x3c00
  s_add_u32 s79, s77, 0xf000
  buffer_load_dwordx4 v80, s[68:71], s79 offen nt lds
  s_mov_b32 m0, 0x4c00
  s_add_u32 s79, s77, 0x3100
  buffer_load_dwordx4 v79, s[68:71], s79 offen nt lds
  s_mov_b32 m0, 0x5c00
  s_add_u32 s79, s77, 0x7100
  buffer_load_dwordx4 v80, s[68:71], s79 offen nt lds
  s_mov_b32 m0, 0x6c00
  s_add_u32 s79, s77, 0xb100
  buffer_load_dwordx4 v79, s[68:71], s79 offen nt lds
  s_mov_b32 m0, 0x7c00
  s_add_u32 s79, s77, 0xf100
  buffer_load_dwordx4 v80, s[68:71], s79 offen nt lds
  s_waitcnt vmcnt(36)
  s_barrier
  v_add_u32 v83, 0x8000, v81
  v_xor_b32 v84, 32, v83
  ds_read_b64_tr_b16 a[128:129], v83 offset:0
  ds_read_b64_tr_b16 a[130:131], v83 offset:512
  ds_read_b64_tr_b16 a[132:133], v83 offset:8192
  ds_read_b64_tr_b16 a[134:135], v83 offset:8704
  ds_read_b64_tr_b16 a[144:145], v84 offset:0
  ds_read_b64_tr_b16 a[146:147], v84 offset:512
  ds_read_b64_tr_b16 a[148:149], v84 offset:8192
  ds_read_b64_tr_b16 a[150:151], v84 offset:8704
  s_waitcnt lgkmcnt(0)
  s_waitcnt vmcnt(32)
  s_barrier
  s_mov_b32 m0, 0x8c00
  s_add_u32 s79, s77, 0x3200
  buffer_load_dwordx4 v79, s[68:71], s79 offen nt lds
  s_mov_b32 m0, 0x9c00
  s_add_u32 s79, s77, 0x7200
  buffer_load_dwordx4 v80, s[68:71], s79 offen nt lds
  s_mov_b32 m0, 0xac00
  s_add_u32 s79, s77, 0xb200
  buffer_load_dwordx4 v79, s[68:71], s79 offen nt lds
  s_mov_b32 m0, 0xbc00
  s_add_u32 s79, s77, 0xf200
  buffer_load_dwordx4 v80, s[68:71], s79 offen nt lds
  v_add_u32 v83, 0xc000, v81
  v_xor_b32 v84, 32, v83
  ds_read_b64_tr_b16 a[232:233], v83 offset:0
  ds_read_b64_tr_b16 a[234:235], v83 offset:512
  ds_read_b64_tr_b16 a[236:237], v83 offset:8192
  ds_read_b64_tr_b16 a[238:239], v83 offset:8704
  ds_read_b64_tr_b16 a[248:249], v84 offset:0
  ds_read_b64_tr_b16 a[250:251], v84 offset:512
  ds_read_b64_tr_b16 a[252:253], v84 offset:8192
  ds_read_b64_tr_b16 a[254:255], v84 offset:8704
  s_waitcnt lgkmcnt(0)
  s_waitcnt vmcnt(32)
  s_barrier
  s_mov_b32 m0, 0xcc00
  s_add_u32 s79, s77, 0x3300
  buffer_load_dwordx4 v79, s[68:71], s79 offen nt lds
  s_mov_b32 m0, 0xdc00
  s_add_u32 s79, s77, 0x7300
  buffer_load_dwordx4 v80, s[68:71], s79 offen nt lds
  s_mov_b32 m0, 0xec00
  s_add_u32 s79, s77, 0xb300
  buffer_load_dwordx4 v79, s[68:71], s79 offen nt lds
  s_mov_b32 m0, 0xfc00
  s_add_u32 s79, s77, 0xf300
  buffer_load_dwordx4 v80, s[68:71], s79 offen nt lds
  v_add_u32 v83, 0x10000, v81
  v_xor_b32 v84, 32, v83
  ds_read_b64_tr_b16 a[32:33], v83 offset:0
  ds_read_b64_tr_b16 a[34:35], v83 offset:512
  ds_read_b64_tr_b16 a[36:37], v83 offset:8192
  ds_read_b64_tr_b16 a[38:39], v83 offset:8704
  ds_read_b64_tr_b16 a[40:41], v84 offset:0
  ds_read_b64_tr_b16 a[42:43], v84 offset:512
  ds_read_b64_tr_b16 a[44:45], v84 offset:8192
  ds_read_b64_tr_b16 a[46:47], v84 offset:8704
  s_waitcnt lgkmcnt(0)
  s_waitcnt vmcnt(32)
  s_barrier
  s_mov_b32 m0, 0x10c00
  s_add_u32 s79, s77, 0x13000
  buffer_load_dwordx4 v79, s[68:71], s79 offen nt lds
  s_mov_b32 m0, 0x11c00
  s_add_u32 s79, s77, 0x17000
  buffer_load_dwordx4 v80, s[68:71], s79 offen nt lds
  s_mov_b32 m0, 0x12c00
  s_add_u32 s79, s77, 0x1b000
  buffer_load_dwordx4 v79, s[68:71], s79 offen nt lds
  s_mov_b32 m0, 0x13c00
  s_add_u32 s79, s77, 0x1f000
  buffer_load_dwordx4 v80, s[68:71], s79 offen nt lds
  v_add_u32 v83, 0x14000, v81
  v_xor_b32 v84, 32, v83
  ds_read_b64_tr_b16 a[48:49], v83 offset:0
  ds_read_b64_tr_b16 a[50:51], v83 offset:512
  ds_read_b64_tr_b16 a[52:53], v83 offset:8192
  ds_read_b64_tr_b16 a[54:55], v83 offset:8704
  ds_read_b64_tr_b16 a[56:57], v84 offset:0
  ds_read_b64_tr_b16 a[58:59], v84 offset:512
  ds_read_b64_tr_b16 a[60:61], v84 offset:8192
  ds_read_b64_tr_b16 a[62:63], v84 offset:8704
  s_waitcnt lgkmcnt(0)
  s_waitcnt vmcnt(32)
  s_barrier
  s_mov_b32 m0, 0x14c00
  s_add_u32 s79, s77, 0x13100
  buffer_load_dwordx4 v79, s[68:71], s79 offen nt lds
  s_mov_b32 m0, 0x15c00
  s_add_u32 s79, s77, 0x17100
  buffer_load_dwordx4 v80, s[68:71], s79 offen nt lds
  s_mov_b32 m0, 0x16c00
  s_add_u32 s79, s77, 0x1b100
  buffer_load_dwordx4 v79, s[68:71], s79 offen nt lds
  s_mov_b32 m0, 0x17c00
  s_add_u32 s79, s77, 0x1f100
  buffer_load_dwordx4 v80, s[68:71], s79 offen nt lds
  v_add_u32 v83, 0x18000, v81
  v_xor_b32 v84, 32, v83
  ds_read_b64_tr_b16 v[224:225], v83 offset:0
  ds_read_b64_tr_b16 v[226:227], v83 offset:512
  ds_read_b64_tr_b16 v[228:229], v83 offset:8192
  ds_read_b64_tr_b16 v[230:231], v83 offset:8704
  ds_read_b64_tr_b16 v[232:233], v84 offset:0
  ds_read_b64_tr_b16 v[234:235], v84 offset:512
  ds_read_b64_tr_b16 v[236:237], v84 offset:8192
  ds_read_b64_tr_b16 v[238:239], v84 offset:8704
  s_waitcnt lgkmcnt(0)
  s_waitcnt vmcnt(32)
  s_barrier
  s_mov_b32 m0, 0x18c00
  s_add_u32 s79, s77, 0x13200
  buffer_load_dwordx4 v79, s[68:71], s79 offen nt lds
  s_mov_b32 m0, 0x19c00
  s_add_u32 s79, s77, 0x17200
  buffer_load_dwordx4 v80, s[68:71], s79 offen nt lds
  s_mov_b32 m0, 0x1ac00
  s_add_u32 s79, s77, 0x1b200
  buffer_load_dwordx4 v79, s[68:71], s79 offen nt lds
  s_mov_b32 m0, 0x1bc00
  s_add_u32 s79, s77, 0x1f200
  buffer_load_dwordx4 v80, s[68:71], s79 offen nt lds
  v_add_u32 v83, 0x1c000, v81
  v_xor_b32 v84, 32, v83
  ds_read_b64_tr_b16 v[240:241], v83 offset:0
  ds_read_b64_tr_b16 v[242:243], v83 offset:512
  ds_read_b64_tr_b16 v[244:245], v83 offset:8192
  ds_read_b64_tr_b16 v[246:247], v83 offset:8704
  ds_read_b64_tr_b16 v[248:249], v84 offset:0
  ds_read_b64_tr_b16 v[250:251], v84 offset:512
  ds_read_b64_tr_b16 v[252:253], v84 offset:8192
  ds_read_b64_tr_b16 v[254:255], v84 offset:8704
  s_waitcnt lgkmcnt(0)
  s_waitcnt vmcnt(32)
  s_barrier
  s_mov_b32 m0, 0x1cc00
  s_add_u32 s79, s77, 0x13300
  buffer_load_dwordx4 v79, s[68:71], s79 offen nt lds
  s_mov_b32 m0, 0x1dc00
  s_add_u32 s79, s77, 0x17300
  buffer_load_dwordx4 v80, s[68:71], s79 offen nt lds
  s_mov_b32 m0, 0x1ec00
  s_add_u32 s79, s77, 0x1b300
  buffer_load_dwordx4 v79, s[68:71], s79 offen nt lds
  s_mov_b32 m0, 0x1fc00
  s_add_u32 s79, s77, 0x1f300
  buffer_load_dwordx4 v80, s[68:71], s79 offen nt lds
  s_getpc_b64 s[90:91]
L_pc3:
  s_add_u32 s90, s90, L_E_chk-L_pc3+18432
  s_addc_u32 s91, s91, 0
  v_lshlrev_b32 v76, 3, v0
  global_load_dword v77, v76, s[90:91]
  v_add_u32 v83, 0x20000, v81
  v_xor_b32 v84, 32, v83
  ds_read_b64_tr_b16 v[40:41], v83 offset:0
  ds_read_b64_tr_b16 v[42:43], v83 offset:512
  ds_read_b64_tr_b16 v[44:45], v83 offset:8192
  ds_read_b64_tr_b16 v[46:47], v83 offset:8704
  ds_read_b64_tr_b16 v[48:49], v84 offset:0
  ds_read_b64_tr_b16 v[50:51], v84 offset:512
  ds_read_b64_tr_b16 v[52:53], v84 offset:8192
  ds_read_b64_tr_b16 v[54:55], v84 offset:8704
  s_waitcnt lgkmcnt(0)
  s_waitcnt vmcnt(33)
  s_barrier
  s_mov_b32 m0, 0x20c00
  s_add_u32 s79, s76, 0x6000
  buffer_load_dwordx4 v78, s[60:63], s79 offen nt lds
  s_mov_b32 m0, 0x21c00
  s_add_u32 s79, s76, 0x86000
  buffer_load_dwordx4 v78, s[60:63], s79 offen nt lds
  s_mov_b32 m0, 0x22c00
  s_add_u32 s79, s76, 0xe000
  buffer_load_dwordx4 v78, s[60:63], s79 offen nt lds
  s_mov_b32 m0, 0x23c00
  s_add_u32 s79, s76, 0x8e000
  buffer_load_dwordx4 v78, s[60:63], s79 offen nt lds
  v_add_u32 v83, 0x24000, v81
  v_xor_b32 v84, 32, v83
  ds_read_b64_tr_b16 v[56:57], v83 offset:0
  ds_read_b64_tr_b16 v[58:59], v83 offset:512
  ds_read_b64_tr_b16 v[60:61], v83 offset:8192
  ds_read_b64_tr_b16 v[62:63], v83 offset:8704
  ds_read_b64_tr_b16 v[64:65], v84 offset:0
  ds_read_b64_tr_b16 v[66:67], v84 offset:512
  ds_read_b64_tr_b16 v[68:69], v84 offset:8192
  ds_read_b64_tr_b16 v[70:71], v84 offset:8704
  s_waitcnt lgkmcnt(0)
  s_waitcnt vmcnt(33)
  s_barrier
  s_mov_b32 m0, 0x24c00
  s_add_u32 s79, s76, 0x16000
  buffer_load_dwordx4 v78, s[60:63], s79 offen nt lds
  s_mov_b32 m0, 0x25c00
  s_add_u32 s79, s76, 0x96000
  buffer_load_dwordx4 v78, s[60:63], s79 offen nt lds
  s_mov_b32 m0, 0x26c00
  s_add_u32 s79, s76, 0x1e000
  buffer_load_dwordx4 v78, s[60:63], s79 offen nt lds
  s_mov_b32 m0, 0x27c00
  s_add_u32 s79, s76, 0x9e000
  buffer_load_dwordx4 v78, s[60:63], s79 offen nt lds
  s_waitcnt lgkmcnt(0)
  s_waitcnt vmcnt(33)
  s_barrier
  s_mov_b32 m0, 0xc00
  s_add_u32 s79, s76, 0x106000
  buffer_load_dwordx4 v78, s[60:63], s79 offen nt lds
  s_mov_b32 m0, 0x1c00
  s_add_u32 s79, s76, 0x186000
  buffer_load_dwordx4 v78, s[60:63], s79 offen nt lds
  s_mov_b32 m0, 0x2c00
  s_add_u32 s79, s76, 0x10e000
  buffer_load_dwordx4 v78, s[60:63], s79 offen nt lds
  s_mov_b32 m0, 0x3c00
  s_add_u32 s79, s76, 0x18e000
  buffer_load_dwordx4 v78, s[60:63], s79 offen nt lds
  s_waitcnt lgkmcnt(0)
  s_waitcnt vmcnt(33)
  s_barrier
  s_mov_b32 m0, 0x4c00
  s_add_u32 s79, s76, 0x116000
  buffer_load_dwordx4 v78, s[60:63], s79 offen nt lds
  s_mov_b32 m0, 0x5c00
  s_add_u32 s79, s76, 0x196000
  buffer_load_dwordx4 v78, s[60:63], s79 offen nt lds
  s_mov_b32 m0, 0x6c00
  s_add_u32 s79, s76, 0x11e000
  buffer_load_dwordx4 v78, s[60:63], s79 offen nt lds
  s_mov_b32 m0, 0x7c00
  s_add_u32 s79, s76, 0x19e000
  buffer_load_dwordx4 v78, s[60:63], s79 offen nt lds
  s_waitcnt lgkmcnt(0)
  s_waitcnt vmcnt(33)
  s_barrier
  s_mov_b32 m0, 0x8c00
  s_add_u32 s79, s76, 0x206000
  buffer_load_dwordx4 v78, s[60:63], s79 offen nt lds
  s_mov_b32 m0, 0x9c00
  s_add_u32 s79, s76, 0x286000
  buffer_load_dwordx4 v78, s[60:63], s79 offen nt lds
  s_mov_b32 m0, 0xac00
  s_add_u32 s79, s76, 0x20e000
  buffer_load_dwordx4 v78, s[60:63], s79 offen nt lds
  s_mov_b32 m0, 0xbc00
  s_add_u32 s79, s76, 0x28e000
  buffer_load_dwordx4 v78, s[60:63], s79 offen nt lds
  v_add_u32 v84, 0xc000, v82
  v_xor_b32 v84, s78, v84
  v_xor_b32 v83, 0, v84
  ds_read_b64_tr_b16 a[0:1], v83 offset:8192
  ds_read_b64_tr_b16 a[2:3], v83 offset:8704
  ds_read_b64_tr_b16 a[4:5], v83 offset:0
  ds_read_b64_tr_b16 a[6:7], v83 offset:512
  v_xor_b32 v83, 32, v84
  ds_read_b64_tr_b16 a[8:9], v83 offset:8192
  ds_read_b64_tr_b16 a[10:11], v83 offset:8704
  ds_read_b64_tr_b16 a[12:13], v83 offset:0
  ds_read_b64_tr_b16 a[14:15], v83 offset:512
  v_xor_b32 v83, 64, v84
  ds_read_b64_tr_b16 a[160:161], v83 offset:8192
  ds_read_b64_tr_b16 a[162:163], v83 offset:8704
  ds_read_b64_tr_b16 a[164:165], v83 offset:0
  ds_read_b64_tr_b16 a[166:167], v83 offset:512
  v_xor_b32 v83, 96, v84
  ds_read_b64_tr_b16 a[176:177], v83 offset:8192
  ds_read_b64_tr_b16 a[178:179], v83 offset:8704
  ds_read_b64_tr_b16 a[180:181], v83 offset:0
  ds_read_b64_tr_b16 a[182:183], v83 offset:512
  v_xor_b32 v83, 128, v84
  ds_read_b64_tr_b16 a[192:193], v83 offset:8192
  ds_read_b64_tr_b16 a[194:195], v83 offset:8704
  ds_read_b64_tr_b16 a[196:197], v83 offset:0
  ds_read_b64_tr_b16 a[198:199], v83 offset:512
  v_xor_b32 v83, 160, v84
  ds_read_b64_tr_b16 a[208:209], v83 offset:8192
  ds_read_b64_tr_b16 a[210:211], v83 offset:8704
  ds_read_b64_tr_b16 a[212:213], v83 offset:0
  ds_read_b64_tr_b16 a[214:215], v83 offset:512
  v_xor_b32 v83, 192, v84
  ds_read_b64_tr_b16 a[224:225], v83 offset:8192
  ds_read_b64_tr_b16 a[226:227], v83 offset:8704
  ds_read_b64_tr_b16 a[228:229], v83 offset:0
  ds_read_b64_tr_b16 a[230:231], v83 offset:512
  v_xor_b32 v83, 224, v84
  ds_read_b64_tr_b16 a[240:241], v83 offset:8192
  ds_read_b64_tr_b16 a[242:243], v83 offset:8704
  ds_read_b64_tr_b16 a[244:245], v83 offset:0
  ds_read_b64_tr_b16 a[246:247], v83 offset:512
  s_waitcnt lgkmcnt(0)
  s_waitcnt vmcnt(33)
  s_barrier
  s_mov_b32 m0, 0xcc00
  s_add_u32 s79, s76, 0x216000
  buffer_load_dwordx4 v78, s[60:63], s79 offen nt lds
  s_mov_b32 m0, 0xdc00
  s_add_u32 s79, s76, 0x296000
  buffer_load_dwordx4 v78, s[60:63], s79 offen nt lds
  s_mov_b32 m0, 0xec00
  s_add_u32 s79, s76, 0x21e000
  buffer_load_dwordx4 v78, s[60:63], s79 offen nt lds
  s_mov_b32 m0, 0xfc00
  s_add_u32 s79, s76, 0x29e000
  buffer_load_dwordx4 v78, s[60:63], s79 offen nt lds
  s_waitcnt lgkmcnt(0)
  s_waitcnt vmcnt(33)
  s_barrier
  s_mov_b32 m0, 0x10c00
  s_add_u32 s79, s76, 0x306000
  buffer_load_dwordx4 v78, s[60:63], s79 offen nt lds
  s_mov_b32 m0, 0x11c00
  s_add_u32 s79, s76, 0x386000
  buffer_load_dwordx4 v78, s[60:63], s79 offen nt lds
  s_mov_b32 m0, 0x12c00
  s_add_u32 s79, s76, 0x30e000
  buffer_load_dwordx4 v78, s[60:63], s79 offen nt lds
  s_mov_b32 m0, 0x13c00
  s_add_u32 s79, s76, 0x38e000
  buffer_load_dwordx4 v78, s[60:63], s79 offen nt lds
  s_waitcnt lgkmcnt(0)
  s_waitcnt vmcnt(33)
  s_barrier
  s_mov_b32 m0, 0x14c00
  s_add_u32 s79, s76, 0x316000
  buffer_load_dwordx4 v78, s[60:63], s79 offen nt lds
  s_mov_b32 m0, 0x15c00
  s_add_u32 s79, s76, 0x396000
  buffer_load_dwordx4 v78, s[60:63], s79 offen nt lds
  s_mov_b32 m0, 0x16c00
  s_add_u32 s79, s76, 0x31e000
  buffer_load_dwordx4 v78, s[60:63], s79 offen nt lds
  s_mov_b32 m0, 0x17c00
  s_add_u32 s79, s76, 0x39e000
  buffer_load_dwordx4 v78, s[60:63], s79 offen nt lds
  s_waitcnt lgkmcnt(0)
  s_waitcnt vmcnt(33)
  s_barrier
  s_mov_b32 m0, 0x18c00
  s_add_u32 s79, s76, 0x6000
  buffer_load_dwordx4 v78, s[64:67], s79 offen nt lds
  s_mov_b32 m0, 0x19c00
  s_add_u32 s79, s76, 0x86000
  buffer_load_dwordx4 v78, s[64:67], s79 offen nt lds
  s_mov_b32 m0, 0x1ac00
  s_add_u32 s79, s76, 0xe000
  buffer_load_dwordx4 v78, s[64:67], s79 offen nt lds
  s_mov_b32 m0, 0x1bc00
  s_add_u32 s79, s76, 0x8e000
  buffer_load_dwordx4 v78, s[64:67], s79 offen nt lds
  v_add_u32 v84, 0x1c000, v82
  v_xor_b32 v84, s78, v84
  v_xor_b32 v83, 0, v84
  ds_read_b64_tr_b16 a[136:137], v83 offset:8192
  ds_read_b64_tr_b16 a[138:139], v83 offset:8704
  ds_read_b64_tr_b16 a[140:141], v83 offset:0
  ds_read_b64_tr_b16 a[142:143], v83 offset:512
  v_xor_b32 v83, 32, v84
  ds_read_b64_tr_b16 a[152:153], v83 offset:8192
  ds_read_b64_tr_b16 a[154:155], v83 offset:8704
  ds_read_b64_tr_b16 a[156:157], v83 offset:0
  ds_read_b64_tr_b16 a[158:159], v83 offset:512
  v_xor_b32 v83, 64, v84
  ds_read_b64_tr_b16 a[168:169], v83 offset:8192
  ds_read_b64_tr_b16 a[170:171], v83 offset:8704
  ds_read_b64_tr_b16 a[172:173], v83 offset:0
  ds_read_b64_tr_b16 a[174:175], v83 offset:512
  v_xor_b32 v83, 96, v84
  ds_read_b64_tr_b16 a[184:185], v83 offset:8192
  ds_read_b64_tr_b16 a[186:187], v83 offset:8704
  ds_read_b64_tr_b16 a[188:189], v83 offset:0
  ds_read_b64_tr_b16 a[190:191], v83 offset:512
  v_xor_b32 v83, 128, v84
  ds_read_b64_tr_b16 a[200:201], v83 offset:8192
  ds_read_b64_tr_b16 a[202:203], v83 offset:8704
  ds_read_b64_tr_b16 a[204:205], v83 offset:0
  ds_read_b64_tr_b16 a[206:207], v83 offset:512
  v_xor_b32 v83, 160, v84
  ds_read_b64_tr_b16 a[216:217], v83 offset:8192
  ds_read_b64_tr_b16 a[218:219], v83 offset:8704
  ds_read_b64_tr_b16 a[220:221], v83 offset:0
  ds_read_b64_tr_b16 a[222:223], v83 offset:512
  v_xor_b32 v83, 192, v84
  ds_read_b64_tr_b16 a[16:17], v83 offset:8192
  ds_read_b64_tr_b16 a[18:19], v83 offset:8704
  ds_read_b64_tr_b16 a[20:21], v83 offset:0
  ds_read_b64_tr_b16 a[22:23], v83 offset:512
  v_xor_b32 v83, 224, v84
  ds_read_b64_tr_b16 a[24:25], v83 offset:8192
  ds_read_b64_tr_b16 a[26:27], v83 offset:8704
  ds_read_b64_tr_b16 a[28:29], v83 offset:0
  ds_read_b64_tr_b16 a[30:31], v83 offset:512
  s_waitcnt lgkmcnt(0)
  s_waitcnt vmcnt(32)
  s_barrier
  s_mov_b32 m0, 0x1cc00
  s_add_u32 s79, s76, 0x16000
  buffer_load_dwordx4 v78, s[64:67], s79 offen nt lds
  s_mov_b32 m0, 0x1dc00
  s_add_u32 s79, s76, 0x96000
  buffer_load_dwordx4 v78, s[64:67], s79 offen nt lds
  s_mov_b32 m0, 0x1ec00
  s_add_u32 s79, s76, 0x1e000
  buffer_load_dwordx4 v78, s[64:67], s79 offen nt lds
  s_mov_b32 m0, 0x1fc00
  s_add_u32 s79, s76, 0x9e000
  buffer_load_dwordx4 v78, s[64:67], s79 offen nt lds
  v_add_u32 v83, 0x20000, v81
  v_xor_b32 v84, 32, v83
  ds_read_b64_tr_b16 v[192:193], v83 offset:0
  ds_read_b64_tr_b16 v[194:195], v83 offset:512
  ds_read_b64_tr_b16 v[196:197], v83 offset:8192
  ds_read_b64_tr_b16 v[198:199], v83 offset:8704
  ds_read_b64_tr_b16 v[200:201], v84 offset:0
  ds_read_b64_tr_b16 v[202:203], v84 offset:512
  ds_read_b64_tr_b16 v[204:205], v84 offset:8192
  ds_read_b64_tr_b16 v[206:207], v84 offset:8704
  s_waitcnt lgkmcnt(0)
  s_waitcnt vmcnt(32)
  s_barrier
  s_mov_b32 m0, 0x20c00
  s_add_u32 s79, s76, 0x106000
  buffer_load_dwordx4 v78, s[64:67], s79 offen nt lds
  s_mov_b32 m0, 0x21c00
  s_add_u32 s79, s76, 0x186000
  buffer_load_dwordx4 v78, s[64:67], s79 offen nt lds
  s_mov_b32 m0, 0x22c00
  s_add_u32 s79, s76, 0x10e000
  buffer_load_dwordx4 v78, s[64:67], s79 offen nt lds
  s_mov_b32 m0, 0x23c00
  s_add_u32 s79, s76, 0x18e000
  buffer_load_dwordx4 v78, s[64:67], s79 offen nt lds
  v_add_u32 v83, 0x24000, v81
  v_xor_b32 v84, 32, v83
  ds_read_b64_tr_b16 v[208:209], v83 offset:0
  ds_read_b64_tr_b16 v[210:211], v83 offset:512
  ds_read_b64_tr_b16 v[212:213], v83 offset:8192
  ds_read_b64_tr_b16 v[214:215], v83 offset:8704
  ds_read_b64_tr_b16 v[216:217], v84 offset:0
  ds_read_b64_tr_b16 v[218:219], v84 offset:512
  ds_read_b64_tr_b16 v[220:221], v84 offset:8192
  ds_read_b64_tr_b16 v[222:223], v84 offset:8704
  s_waitcnt lgkmcnt(0)
  s_waitcnt vmcnt(32)
  s_barrier
  s_mov_b32 m0, 0x24c00
  s_add_u32 s79, s76, 0x116000
  buffer_load_dwordx4 v78, s[64:67], s79 offen nt lds
  s_mov_b32 m0, 0x25c00
  s_add_u32 s79, s76, 0x196000
  buffer_load_dwordx4 v78, s[64:67], s79 offen nt lds
  s_mov_b32 m0, 0x26c00
  s_add_u32 s79, s76, 0x11e000
  buffer_load_dwordx4 v78, s[64:67], s79 offen nt lds
  s_mov_b32 m0, 0x27c00
  s_add_u32 s79, s76, 0x19e000
  buffer_load_dwordx4 v78, s[64:67], s79 offen nt lds
  v_add_u32 v83, 0x0, v81
  v_xor_b32 v84, 32, v83
  ds_read_b64_tr_b16 v[160:161], v83 offset:0
  ds_read_b64_tr_b16 v[162:163], v83 offset:512
  ds_read_b64_tr_b16 v[164:165], v83 offset:8192
  ds_read_b64_tr_b16 v[166:167], v83 offset:8704
  ds_read_b64_tr_b16 v[168:169], v84 offset:0
  ds_read_b64_tr_b16 v[170:171], v84 offset:512
  ds_read_b64_tr_b16 v[172:173], v84 offset:8192
  ds_read_b64_tr_b16 v[174:175], v84 offset:8704
  s_waitcnt lgkmcnt(0)
  s_waitcnt vmcnt(32)
  s_barrier
  s_mov_b32 m0, 0xc00
  s_add_u32 s79, s76, 0x206000
  buffer_load_dwordx4 v78, s[64:67], s79 offen nt lds
  s_mov_b32 m0, 0x1c00
  s_add_u32 s79, s76, 0x286000
  buffer_load_dwordx4 v78, s[64:67], s79 offen nt lds
  s_mov_b32 m0, 0x2c00
  s_add_u32 s79, s76, 0x20e000
  buffer_load_dwordx4 v78, s[64:67], s79 offen nt lds
  s_mov_b32 m0, 0x3c00
  s_add_u32 s79, s76, 0x28e000
  buffer_load_dwordx4 v78, s[64:67], s79 offen nt lds
  v_add_u32 v83, 0x4000, v81
  v_xor_b32 v84, 32, v83
  ds_read_b64_tr_b16 v[176:177], v83 offset:0
  ds_read_b64_tr_b16 v[178:179], v83 offset:512
  ds_read_b64_tr_b16 v[180:181], v83 offset:8192
  ds_read_b64_tr_b16 v[182:183], v83 offset:8704
  ds_read_b64_tr_b16 v[184:185], v84 offset:0
  ds_read_b64_tr_b16 v[186:187], v84 offset:512
  ds_read_b64_tr_b16 v[188:189], v84 offset:8192
  ds_read_b64_tr_b16 v[190:191], v84 offset:8704
  s_waitcnt lgkmcnt(0)
  s_waitcnt vmcnt(32)
  s_barrier
  s_mov_b32 m0, 0x4c00
  s_add_u32 s79, s76, 0x216000
  buffer_load_dwordx4 v78, s[64:67], s79 offen nt lds
  s_mov_b32 m0, 0x5c00
  s_add_u32 s79, s76, 0x296000
  buffer_load_dwordx4 v78, s[64:67], s79 offen nt lds
  s_mov_b32 m0, 0x6c00
  s_add_u32 s79, s76, 0x21e000
  buffer_load_dwordx4 v78, s[64:67], s79 offen nt lds
  s_mov_b32 m0, 0x7c00
  s_add_u32 s79, s76, 0x29e000
  buffer_load_dwordx4 v78, s[64:67], s79 offen nt lds
  buffer_load_dwordx4 v[16:19], v0, s[4:7], s20 offen sc1
  buffer_load_dwordx4 v[16:19], v0, s[4:7], s16 offen offset:0 sc1
  buffer_load_dwordx4 v[16:19], v0, s[4:7], s21 offen sc1
  buffer_load_dwordx4 v[16:19], v0, s[4:7], s16 offen offset:1024 sc1
  buffer_load_dword v16, off, s[4:7], s24 sc1
  s_add_u32 s27, s22, 0x17a000
  buffer_load_dword v16, off, s[4:7], s27 sc1
  v_add_u32 v83, 0x8000, v81
  v_xor_b32 v84, 32, v83
  ds_read_b64_tr_b16 v[128:129], v83 offset:0
  ds_read_b64_tr_b16 v[130:131], v83 offset:512
  ds_read_b64_tr_b16 v[132:133], v83 offset:8192
  ds_read_b64_tr_b16 v[134:135], v83 offset:8704
  ds_read_b64_tr_b16 v[136:137], v84 offset:0
  ds_read_b64_tr_b16 v[138:139], v84 offset:512
  ds_read_b64_tr_b16 v[140:141], v84 offset:8192
  ds_read_b64_tr_b16 v[142:143], v84 offset:8704
  s_waitcnt lgkmcnt(0)
  s_waitcnt vmcnt(38)
  s_barrier
  s_mov_b32 m0, 0x8c00
  s_add_u32 s79, s76, 0x306000
  buffer_load_dwordx4 v78, s[64:67], s79 offen nt lds
  s_mov_b32 m0, 0x9c00
  s_add_u32 s79, s76, 0x386000
  buffer_load_dwordx4 v78, s[64:67], s79 offen nt lds
  s_mov_b32 m0, 0xac00
  s_add_u32 s79, s76, 0x30e000
  buffer_load_dwordx4 v78, s[64:67], s79 offen nt lds
  s_mov_b32 m0, 0xbc00
  s_add_u32 s79, s76, 0x38e000
  buffer_load_dwordx4 v78, s[64:67], s79 offen nt lds
  v_add_u32 v83, 0xc000, v81
  v_xor_b32 v84, 32, v83
  ds_read_b64_tr_b16 v[144:145], v83 offset:0
  ds_read_b64_tr_b16 v[146:147], v83 offset:512
  ds_read_b64_tr_b16 v[148:149], v83 offset:8192
  ds_read_b64_tr_b16 v[150:151], v83 offset:8704
  ds_read_b64_tr_b16 v[152:153], v84 offset:0
  ds_read_b64_tr_b16 v[154:155], v84 offset:512
  ds_read_b64_tr_b16 v[156:157], v84 offset:8192
  ds_read_b64_tr_b16 v[158:159], v84 offset:8704
  s_waitcnt lgkmcnt(0)
  s_waitcnt vmcnt(38)
  s_barrier
  s_mov_b32 m0, 0xcc00
  s_add_u32 s79, s76, 0x316000
  buffer_load_dwordx4 v78, s[64:67], s79 offen nt lds
  s_mov_b32 m0, 0xdc00
  s_add_u32 s79, s76, 0x396000
  buffer_load_dwordx4 v78, s[64:67], s79 offen nt lds
  s_mov_b32 m0, 0xec00
  s_add_u32 s79, s76, 0x31e000
  buffer_load_dwordx4 v78, s[64:67], s79 offen nt lds
  s_mov_b32 m0, 0xfc00
  s_add_u32 s79, s76, 0x39e000
  buffer_load_dwordx4 v78, s[64:67], s79 offen nt lds
  v_add_u32 v83, 0x10000, v81
  v_xor_b32 v84, 32, v83
  ds_read_b64_tr_b16 v[96:97], v83 offset:0
  ds_read_b64_tr_b16 v[98:99], v83 offset:512
  ds_read_b64_tr_b16 v[100:101], v83 offset:8192
  ds_read_b64_tr_b16 v[102:103], v83 offset:8704
  ds_read_b64_tr_b16 v[104:105], v84 offset:0
  ds_read_b64_tr_b16 v[106:107], v84 offset:512
  ds_read_b64_tr_b16 v[108:109], v84 offset:8192
  ds_read_b64_tr_b16 v[110:111], v84 offset:8704
  s_waitcnt lgkmcnt(0)
  s_waitcnt vmcnt(38)
  s_barrier
  v_add_u32 v83, 0x14000, v81
  v_xor_b32 v84, 32, v83
  ds_read_b64_tr_b16 v[112:113], v83 offset:0
  ds_read_b64_tr_b16 v[114:115], v83 offset:512
  ds_read_b64_tr_b16 v[116:117], v83 offset:8192
  ds_read_b64_tr_b16 v[118:119], v83 offset:8704
  ds_read_b64_tr_b16 v[120:121], v84 offset:0
  ds_read_b64_tr_b16 v[122:123], v84 offset:512
  ds_read_b64_tr_b16 v[124:125], v84 offset:8192
  ds_read_b64_tr_b16 v[126:127], v84 offset:8704
  s_waitcnt lgkmcnt(0)
  s_waitcnt vmcnt(34)
  s_barrier
  buffer_load_dword v32, off, s[48:51], 0 offset:16 sc1
  buffer_load_dword v34, off, s[48:51], s29 sc1
  s_mul_i32 s27, s80, 72
  buffer_load_dword v33, off, s[48:51], s27 sc1
  s_mov_b64 exec, 0x3f
  buffer_load_dword v11, v0, s[4:7], s58 offen sc1
  s_mov_b64 exec, -1
  v_add_u32 v83, 0x18000, v81
  v_xor_b32 v84, 32, v83
  ds_read_b64_tr_b16 a[96:97], v83 offset:0
  ds_read_b64_tr_b16 a[98:99], v83 offset:512
  ds_read_b64_tr_b16 a[100:101], v83 offset:8192
  ds_read_b64_tr_b16 a[102:103], v83 offset:8704
  ds_read_b64_tr_b16 a[104:105], v84 offset:0
  ds_read_b64_tr_b16 a[106:107], v84 offset:512
  ds_read_b64_tr_b16 a[108:109], v84 offset:8192
  ds_read_b64_tr_b16 a[110:111], v84 offset:8704
  s_waitcnt lgkmcnt(0)
  s_waitcnt vmcnt(34)
  s_barrier
  v_add_u32 v83, 0x1c000, v81
  v_xor_b32 v84, 32, v83
  ds_read_b64_tr_b16 a[112:113], v83 offset:0
  ds_read_b64_tr_b16 a[114:115], v83 offset:512
  ds_read_b64_tr_b16 a[116:117], v83 offset:8192
  ds_read_b64_tr_b16 a[118:119], v83 offset:8704
  ds_read_b64_tr_b16 a[120:121], v84 offset:0
  ds_read_b64_tr_b16 a[122:123], v84 offset:512
  ds_read_b64_tr_b16 a[124:125], v84 offset:8192
  ds_read_b64_tr_b16 a[126:127], v84 offset:8704
  s_waitcnt lgkmcnt(0)
  s_waitcnt vmcnt(30)
  s_barrier
  v_add_u32 v83, 0x20000, v81
  v_xor_b32 v84, 32, v83
  ds_read_b64_tr_b16 a[64:65], v83 offset:0
  ds_read_b64_tr_b16 a[66:67], v83 offset:512
  ds_read_b64_tr_b16 a[68:69], v83 offset:8192
  ds_read_b64_tr_b16 a[70:71], v83 offset:8704
  ds_read_b64_tr_b16 a[72:73], v84 offset:0
  ds_read_b64_tr_b16 a[74:75], v84 offset:512
  ds_read_b64_tr_b16 a[76:77], v84 offset:8192
  ds_read_b64_tr_b16 a[78:79], v84 offset:8704
  s_waitcnt lgkmcnt(0)
  s_waitcnt vmcnt(26)
  s_barrier
  ds_write_b128 v4, v[40:43] offset:0
  ds_write_b128 v4, v[44:47] offset:1024
  ds_write_b128 v4, v[48:51] offset:2048
  ds_write_b128 v4, v[52:55] offset:3072
  ds_write_b128 v4, v[56:59] offset:4096
  ds_write_b128 v4, v[60:63] offset:5120
  ds_write_b128 v4, v[64:67] offset:6144
  ds_write_b128 v4, v[68:71] offset:7168
  v_add_u32 v83, 0x24000, v81
  v_xor_b32 v84, 32, v83
  ds_read_b64_tr_b16 a[80:81], v83 offset:0
  ds_read_b64_tr_b16 a[82:83], v83 offset:512
  ds_read_b64_tr_b16 a[84:85], v83 offset:8192
  ds_read_b64_tr_b16 a[86:87], v83 offset:8704
  ds_read_b64_tr_b16 a[88:89], v84 offset:0
  ds_read_b64_tr_b16 a[90:91], v84 offset:512
  ds_read_b64_tr_b16 a[92:93], v84 offset:8192
  ds_read_b64_tr_b16 a[94:95], v84 offset:8704
  s_waitcnt lgkmcnt(0)
  s_waitcnt vmcnt(22)
  s_barrier
  ds_write_b128 v4, a[32:35] offset:8192
  ds_write_b128 v4, a[36:39] offset:9216
  ds_write_b128 v4, a[40:43] offset:10240
  ds_write_b128 v4, a[44:47] offset:11264
  ds_write_b128 v4, a[48:51] offset:12288
  ds_write_b128 v4, a[52:55] offset:13312
  ds_write_b128 v4, a[56:59] offset:14336
  ds_write_b128 v4, a[60:63] offset:15360
  ds_write_b128 v4, a[0:3] offset:16384
  ds_write_b128 v4, a[4:7] offset:17408
  ds_write_b128 v4, a[8:11] offset:18432
  ds_write_b128 v4, a[12:15] offset:19456
  ds_write_b128 v4, a[16:19] offset:20480
  ds_write_b128 v4, a[20:23] offset:21504
  ds_write_b128 v4, a[24:27] offset:22528
  ds_write_b128 v4, a[28:31] offset:23552
  s_waitcnt lgkmcnt(0)
  v_add_u32 v83, 0x0, v81
  v_xor_b32 v84, 32, v83
  ds_read_b64_tr_b16 a[32:33], v83 offset:0
  ds_read_b64_tr_b16 a[34:35], v83 offset:512
  ds_read_b64_tr_b16 a[36:37], v83 offset:8192
  ds_read_b64_tr_b16 a[38:39], v83 offset:8704
  ds_read_b64_tr_b16 a[40:41], v84 offset:0
  ds_read_b64_tr_b16 a[42:43], v84 offset:512
  ds_read_b64_tr_b16 a[44:45], v84 offset:8192
  ds_read_b64_tr_b16 a[46:47], v84 offset:8704
  s_waitcnt lgkmcnt(0)
  s_waitcnt vmcnt(18)
  s_barrier
  v_add_u32 v83, 0x4000, v81
  v_xor_b32 v84, 32, v83
  ds_read_b64_tr_b16 a[48:49], v83 offset:0
  ds_read_b64_tr_b16 a[50:51], v83 offset:512
  ds_read_b64_tr_b16 a[52:53], v83 offset:8192
  ds_read_b64_tr_b16 a[54:55], v83 offset:8704
  ds_read_b64_tr_b16 a[56:57], v84 offset:0
  ds_read_b64_tr_b16 a[58:59], v84 offset:512
  ds_read_b64_tr_b16 a[60:61], v84 offset:8192
  ds_read_b64_tr_b16 a[62:63], v84 offset:8704
  s_waitcnt lgkmcnt(0)
  s_waitcnt vmcnt(8)
  s_barrier
  v_add_u32 v83, 0x8000, v81
  v_xor_b32 v84, 32, v83
  ds_read_b64_tr_b16 a[0:1], v83 offset:0
  ds_read_b64_tr_b16 a[2:3], v83 offset:512
  ds_read_b64_tr_b16 a[4:5], v83 offset:8192
  ds_read_b64_tr_b16 a[6:7], v83 offset:8704
  ds_read_b64_tr_b16 a[8:9], v84 offset:0
  ds_read_b64_tr_b16 a[10:11], v84 offset:512
  ds_read_b64_tr_b16 a[12:13], v84 offset:8192
  ds_read_b64_tr_b16 a[14:15], v84 offset:8704
  s_waitcnt lgkmcnt(0)
  s_waitcnt vmcnt(4)
  s_barrier
  v_add_u32 v83, 0xc000, v81
  v_xor_b32 v84, 32, v83
  ds_read_b64_tr_b16 a[16:17], v83 offset:0
  ds_read_b64_tr_b16 a[18:19], v83 offset:512
  ds_read_b64_tr_b16 a[20:21], v83 offset:8192
  ds_read_b64_tr_b16 a[22:23], v83 offset:8704
  ds_read_b64_tr_b16 a[24:25], v84 offset:0
  ds_read_b64_tr_b16 a[26:27], v84 offset:512
  ds_read_b64_tr_b16 a[28:29], v84 offset:8192
  ds_read_b64_tr_b16 a[30:31], v84 offset:8704
  s_waitcnt lgkmcnt(0)
  s_barrier
L_wdone:
  s_mov_b32 s15, 0
L_E_chk:
  s_waitcnt vmcnt(0)
  v_min_u32 v32, v32, v34
  v_cmp_gt_u32 vcc, 32, v32
  s_cbranch_vccnz L_E_retry
  s_cmp_lg_u32 s80, 0
  s_cselect_b32 s14, 0, 1
  s_add_u32 s27, s14, 2
  s_sub_u32 s27, s27, s80
  v_cmp_gt_u32 vcc, s27, v11
  s_and_b32 vcc_lo, vcc_lo, 0x15
  s_cbranch_scc1 L_E_retry
  s_mul_i32 s27, s14, 24576
  s_add_u32 s22, s22, s27
  s_lshl_b32 s27, s14, 13
  s_add_u32 s79, s24, s27
  s_mov_b32 s24, 0x4ff0000
  s_cmp_lg_u32 s80, 0
  s_cbranch_scc1 L_E_even
  s_sub_u32 s23, s25, s23
  s_mov_b64 exec, s[32:33]
  v_xor_b32 v5, 0xe000, v5
  s_mov_b64 exec, -1
L_E_even:
  buffer_load_dwordx4 v[64:67], v0, s[4:7], s16 offen offset:0 sc1
  buffer_load_dwordx4 v[68:71], v0, s[4:7], s16 offen offset:1024 sc1
  s_mov_b32 m0, s23
  s_nop 0
  buffer_load_dwordx4 v0, s[4:7], s22 offen offset:0 sc1 lds
  buffer_load_dwordx4 v0, s[4:7], s22 offen offset:1024 sc1 lds
  buffer_load_dwordx4 v0, s[4:7], s22 offen offset:2048 sc1 lds
  buffer_load_dwordx4 v0, s[4:7], s22 offen offset:3072 sc1 lds
  s_add_u32 m0, s23, 4096
  s_add_u32 s26, s22, 4096
  buffer_load_dwordx4 v0, s[4:7], s26 offen offset:0 sc1 lds
  buffer_load_dwordx4 v0, s[4:7], s26 offen offset:1024 sc1 lds
  s_add_u32 s22, s22, 24576
  s_sub_u32 s23, s25, s23
  v_readfirstlane_b32 s28, v33
  v_lshrrev_b32 v16, 4, v0
  v_add_u32 v18, s13, v16
  v_cmp_lt_u32 vcc, 32, v18
  v_mov_b32 v19, 0xf149f2ca
  s_mul_i32 s27, s13, 272
  v_lshl_add_u32 v20, v16, 2, s27
  v_cndmask_b32 v18, 0, v19, vcc
  ds_write_b32 v20, v18 offset:10496
  v_mfma_f32_32x32x8_bf16 v[72:87], v[2:3], v[2:3], 0
  v_mfma_f32_16x16x16_bf16 v[88:91], v[2:3], v[2:3], 0
  v_mfma_f32_16x16x16_bf16 v[92:95], v[2:3], v[2:3], 0
  ds_read_b128 v[32:35], v4 offset:0
  ds_read_b128 v[36:39], v4 offset:1024
  ds_read_b128 v[40:43], v4 offset:2048
  ds_read_b128 v[44:47], v4 offset:3072
  ds_read_b128 v[48:51], v4 offset:4096
  ds_read_b128 v[52:55], v4 offset:5120
  ds_read_b128 v[56:59], v4 offset:6144
  ds_read_b128 v[60:63], v4 offset:7168
  s_mov_b32 s99, 0
  s_mov_b32 s15, 0
  s_waitcnt lgkmcnt(0)
  s_cmp_eq_u32 s80, 0
  s_cbranch_scc1 L_E_main
  s_cmp_ge_u32 s28, 32
  s_cbranch_scc1 L_C_have0
  s_branch L_B_have0
L_E_main:
  s_waitcnt vmcnt(6)
  v_bitop3_b32 v6, v64, v68, 1 bitop3:0xa8
  v_cmp_ne_u32 vcc, 0, v6
  s_cbranch_vccz L_E_got
  s_cmp_ge_u32 s28, 32
  s_cbranch_scc1 L_F_f2x1
  s_branch L_S_f2x1
L_E_got:
  s_cmp_ge_u32 s28, 32
  s_cbranch_scc1 L_F_ownY1
  s_branch L_S_ownY1
L_E_retry:
  buffer_load_dword v32, off, s[48:51], 0 offset:16 sc1
  buffer_load_dword v34, off, s[48:51], s29 sc1
  s_mul_i32 s27, s80, 72
  buffer_load_dword v33, off, s[48:51], s27 sc1
  s_mov_b64 exec, 0x3f
  buffer_load_dword v11, v0, s[4:7], s58 offen sc1
  s_mov_b64 exec, -1
  s_add_u32 s15, s15, 1
  s_cmp_lt_u32 s15, 0x80000
  s_cbranch_scc1 L_E_chk
  s_branch L_end
L_F_f2x0:
  buffer_load_dwordx4 v[24:27], v0, s[4:7], s16 offen sc1
  buffer_load_dwordx4 v[28:31], v0, s[4:7], s16 offen offset:1024 sc1
  s_waitcnt vmcnt(2)
  v_bitop3_b32 v6, v64, v68, 1 bitop3:0x2a
  v_cmp_ne_u32 vcc, 0, v6
  s_cbranch_vccz L_F_ownY0
  s_add_u32 s15, s15, 1
  s_cmp_ge_u32 s15, 0x80000
  s_cbranch_scc1 L_F_ownY0
  buffer_load_dwordx4 v[64:67], v0, s[4:7], s16 offen sc1
  buffer_load_dwordx4 v[68:71], v0, s[4:7], s16 offen offset:1024 sc1
  s_waitcnt vmcnt(2)
  s_branch L_F_chk0
L_F_ownY0:
  s_add_u32 s98, s98, 1
  s_waitcnt lgkmcnt(2)
  v_smfmac_f32_16x16x64_bf16 v[88:91], v[64:67], v[32:39], v15
  ds_write_b64 v1, v[64:65] offset:0
  v_smfmac_f32_16x16x64_bf16 v[92:95], v[64:67], v[40:47], v15
  ds_write_b64 v1, v[66:67] offset:8
  v_smfmac_f32_16x16x64_bf16 v[88:91], v[68:71], v[48:55], v15
  ds_write_b64 v1, v[68:69] offset:1024
  v_smfmac_f32_16x16x64_bf16 v[72:75], v[64:67], v[96:103], v15
  ds_write_b64 v1, v[70:71] offset:1032
  v_smfmac_f32_16x16x64_bf16 v[76:79], v[64:67], v[104:111], v15
  v_xor_b32 v39, 0x800, v1
  v_smfmac_f32_16x16x64_bf16 v[72:75], v[68:71], v[112:119], v15
  v_xor_b32 v47, 0x1000, v1
  v_smfmac_f32_16x16x64_bf16 v[76:79], v[68:71], v[120:127], v15
  v_xor_b32 v55, 0x1800, v1
  v_smfmac_f32_16x16x64_bf16 v[80:83], v[64:67], a[0:7], v15
  s_waitcnt lgkmcnt(0)
  s_barrier
  ds_read_b128 v[32:35], v39 offset:0
  ds_read_b128 v[36:39], v39 offset:1024
  v_smfmac_f32_16x16x64_bf16 v[84:87], v[64:67], a[8:15], v15
  s_mov_b32 m0, s23
  s_nop 0
  buffer_load_dwordx4 v0, s[4:7], s22 offen offset:0 sc1 lds
  ds_read_b128 v[40:43], v47 offset:0
  ds_read_b128 v[44:47], v47 offset:1024
  v_smfmac_f32_16x16x64_bf16 v[80:83], v[68:71], a[16:23], v15
  ds_read_b128 v[48:51], v55 offset:0
  ds_read_b128 v[52:55], v55 offset:1024
  v_smfmac_f32_16x16x64_bf16 v[84:87], v[68:71], a[24:31], v15
  v_smfmac_f32_16x16x64_bf16 v[92:95], v[68:71], v[56:63], v15
  buffer_load_dwordx4 v0, s[4:7], s22 offen offset:1024 sc1 lds
  s_branch L_F_rest0
L_F_fp0:
  s_sub_u32 s27, s14, 1
  s_mov_b64 exec, 1
  v_mov_b32 v6, s27
  buffer_store_dword v6, off, s[4:7], s59 sc1
  s_mov_b64 exec, -1
  s_branch L_F_fpr0
L_F_fl0:
  s_mov_b64 exec, 0x3f
  buffer_load_dword v11, v0, s[4:7], s58 offen sc1
  s_mov_b64 exec, -1
  s_branch L_F_flr0
L_F_xq0:
  s_add_u32 s27, s14, 2
  s_min_u32 s27, s27, 64
  v_cmp_gt_u32 vcc, 64, v11
  s_and_b32 s97, vcc_lo, 0x15
  v_cmp_gt_u32 vcc, s27, v11
  s_and_b32 vcc_lo, vcc_lo, 0x15
  s_cbranch_scc0 L_F_xok0
  s_mov_b64 exec, 0x3f
  buffer_load_dword v11, v0, s[4:7], s58 offen sc1
  s_mov_b64 exec, -1
  s_waitcnt vmcnt(0)
  s_add_u32 s15, s15, 1
  s_cmp_lt_u32 s15, 0x80000
  s_cbranch_scc1 L_F_xq0
  s_branch L_F_xok0
L_F_f1x0:
  s_add_u32 s99, s99, 1
  buffer_load_dwordx4 v[56:59], v0, s[4:7], s20 offen sc1
  buffer_load_dwordx4 v[60:63], v0, s[4:7], s21 offen sc1
  s_waitcnt vmcnt(2)
  v_mfma_f32_16x16x32_bf16 v[92:95], v[88:91], v[64:67], 0
  v_mfma_f32_16x16x32_bf16 v[92:95], v[88:91], v[68:71], v[92:95]
  v_bitop3_b32 v6, v64, v68, 1 bitop3:0xa8
  v_cmp_ne_u32 vcc, 0, v6
  s_cbranch_vccz L_F_tail0
  s_add_u32 s15, s15, 1
  s_cmp_ge_u32 s15, 0x80000
  s_cbranch_scc1 L_F_tail0
  buffer_load_dwordx4 v[64:67], v0, s[4:7], s20 offen sc1
  buffer_load_dwordx4 v[68:71], v0, s[4:7], s21 offen sc1
  s_branch L_F_red0
L_F_f2x1:
  buffer_load_dwordx4 v[24:27], v0, s[4:7], s16 offen sc1
  buffer_load_dwordx4 v[28:31], v0, s[4:7], s16 offen offset:1024 sc1
  s_waitcnt vmcnt(2)
  v_bitop3_b32 v6, v64, v68, 1 bitop3:0xa8
  v_cmp_ne_u32 vcc, 0, v6
  s_cbranch_vccz L_F_ownY1
  s_add_u32 s15, s15, 1
  s_cmp_ge_u32 s15, 0x80000
  s_cbranch_scc1 L_F_ownY1
  buffer_load_dwordx4 v[64:67], v0, s[4:7], s16 offen sc1
  buffer_load_dwordx4 v[68:71], v0, s[4:7], s16 offen offset:1024 sc1
  s_waitcnt vmcnt(2)
  s_branch L_F_chk1
L_F_ownY1:
  s_add_u32 s98, s98, 1
  s_waitcnt lgkmcnt(2)
  v_smfmac_f32_16x16x64_bf16 v[88:91], v[64:67], v[32:39], v15
  ds_write_b64 v1, v[64:65] offset:0
  v_smfmac_f32_16x16x64_bf16 v[92:95], v[64:67], v[40:47], v15
  ds_write_b64 v1, v[66:67] offset:8
  v_smfmac_f32_16x16x64_bf16 v[88:91], v[68:71], v[48:55], v15
  ds_write_b64 v1, v[68:69] offset:1024
  v_smfmac_f32_16x16x64_bf16 v[72:75], v[64:67], v[96:103], v15
  ds_write_b64 v1, v[70:71] offset:1032
  v_smfmac_f32_16x16x64_bf16 v[76:79], v[64:67], v[104:111], v15
  v_xor_b32 v39, 0x800, v1
  v_smfmac_f32_16x16x64_bf16 v[72:75], v[68:71], v[112:119], v15
  v_xor_b32 v47, 0x1000, v1
  v_smfmac_f32_16x16x64_bf16 v[76:79], v[68:71], v[120:127], v15
  v_xor_b32 v55, 0x1800, v1
  v_smfmac_f32_16x16x64_bf16 v[80:83], v[64:67], a[0:7], v15
  s_waitcnt lgkmcnt(0)
  s_barrier
  ds_read_b128 v[32:35], v39 offset:0
  ds_read_b128 v[36:39], v39 offset:1024
  v_smfmac_f32_16x16x64_bf16 v[84:87], v[64:67], a[8:15], v15
  s_mov_b32 m0, s23
  s_nop 0
  buffer_load_dwordx4 v0, s[4:7], s22 offen offset:0 sc1 lds
  ds_read_b128 v[40:43], v47 offset:0
  ds_read_b128 v[44:47], v47 offset:1024
  v_smfmac_f32_16x16x64_bf16 v[80:83], v[68:71], a[16:23], v15
  ds_read_b128 v[48:51], v55 offset:0
  ds_read_b128 v[52:55], v55 offset:1024
  v_smfmac_f32_16x16x64_bf16 v[84:87], v[68:71], a[24:31], v15
  v_smfmac_f32_16x16x64_bf16 v[92:95], v[68:71], v[56:63], v15
  buffer_load_dwordx4 v0, s[4:7], s22 offen offset:1024 sc1 lds
  s_branch L_F_rest1
L_F_fp1:
  s_sub_u32 s27, s14, 1
  s_mov_b64 exec, 1
  v_mov_b32 v6, s27
  buffer_store_dword v6, off, s[4:7], s59 sc1
  s_mov_b64 exec, -1
  s_branch L_F_fpr1
L_F_fl1:
  s_mov_b64 exec, 0x3f
  buffer_load_dword v11, v0, s[4:7], s58 offen sc1
  s_mov_b64 exec, -1
  s_branch L_F_flr1
L_F_xq1:
  s_add_u32 s27, s14, 2
  s_min_u32 s27, s27, 64
  v_cmp_gt_u32 vcc, 64, v11
  s_and_b32 s97, vcc_lo, 0x15
  v_cmp_gt_u32 vcc, s27, v11
  s_and_b32 vcc_lo, vcc_lo, 0x15
  s_cbranch_scc0 L_F_xok1
  s_mov_b64 exec, 0x3f
  buffer_load_dword v11, v0, s[4:7], s58 offen sc1
  s_mov_b64 exec, -1
  s_waitcnt vmcnt(0)
  s_add_u32 s15, s15, 1
  s_cmp_lt_u32 s15, 0x80000
  s_cbranch_scc1 L_F_xq1
  s_branch L_F_xok1
L_F_x01:
  s_waitcnt vmcnt(7)
  s_branch L_F_x0r1
L_F_f1x1:
  s_add_u32 s99, s99, 1
  buffer_load_dwordx4 v[56:59], v0, s[4:7], s20 offen sc1
  buffer_load_dwordx4 v[60:63], v0, s[4:7], s21 offen sc1
  s_waitcnt vmcnt(2)
  v_mfma_f32_16x16x32_bf16 v[92:95], v[88:91], v[64:67], 0
  v_mfma_f32_16x16x32_bf16 v[92:95], v[88:91], v[68:71], v[92:95]
  v_bitop3_b32 v6, v64, v68, 1 bitop3:0x2a
  v_cmp_ne_u32 vcc, 0, v6
  s_cbranch_vccz L_F_tail1
  s_add_u32 s15, s15, 1
  s_cmp_ge_u32 s15, 0x80000
  s_cbranch_scc1 L_F_tail1
  buffer_load_dwordx4 v[64:67], v0, s[4:7], s20 offen sc1
  buffer_load_dwordx4 v[68:71], v0, s[4:7], s21 offen sc1
  s_branch L_F_red1
.p2align 6
L_F_chk0:
  v_bitop3_b32 v6, v24, v28, 1 bitop3:0x2a
  v_cmp_ne_u32 vcc, 0, v6
  s_cbranch_vccnz L_F_f2x0
L_F_have0:
  s_waitcnt lgkmcnt(2)
  v_smfmac_f32_16x16x64_bf16 v[88:91], v[24:27], v[32:39], v15
  ds_write_b64 v1, v[24:25] offset:0
  v_smfmac_f32_16x16x64_bf16 v[92:95], v[24:27], v[40:47], v15
  ds_write_b64 v1, v[26:27] offset:8
  v_smfmac_f32_16x16x64_bf16 v[88:91], v[28:31], v[48:55], v15
  ds_write_b64 v1, v[28:29] offset:1024
  v_smfmac_f32_16x16x64_bf16 v[72:75], v[24:27], v[96:103], v15
  ds_write_b64 v1, v[30:31] offset:1032
  v_smfmac_f32_16x16x64_bf16 v[76:79], v[24:27], v[104:111], v15
  v_xor_b32 v39, 0x800, v1
  v_smfmac_f32_16x16x64_bf16 v[72:75], v[28:31], v[112:119], v15
  v_xor_b32 v47, 0x1000, v1
  v_smfmac_f32_16x16x64_bf16 v[76:79], v[28:31], v[120:127], v15
  v_xor_b32 v55, 0x1800, v1
  v_smfmac_f32_16x16x64_bf16 v[80:83], v[24:27], a[0:7], v15
  s_waitcnt lgkmcnt(0)
  s_barrier
  ds_read_b128 v[32:35], v39 offset:0
  ds_read_b128 v[36:39], v39 offset:1024
  v_smfmac_f32_16x16x64_bf16 v[84:87], v[24:27], a[8:15], v15
  s_mov_b32 m0, s23
  s_nop 0
  buffer_load_dwordx4 v0, s[4:7], s22 offen offset:0 sc1 lds
  ds_read_b128 v[40:43], v47 offset:0
  ds_read_b128 v[44:47], v47 offset:1024
  v_smfmac_f32_16x16x64_bf16 v[80:83], v[28:31], a[16:23], v15
  ds_read_b128 v[48:51], v55 offset:0
  ds_read_b128 v[52:55], v55 offset:1024
  v_smfmac_f32_16x16x64_bf16 v[84:87], v[28:31], a[24:31], v15
  v_smfmac_f32_16x16x64_bf16 v[92:95], v[28:31], v[56:63], v15
  buffer_load_dwordx4 v0, s[4:7], s22 offen offset:1024 sc1 lds
L_F_rest0:
  s_waitcnt lgkmcnt(5)
  v_smfmac_f32_16x16x64_bf16 v[72:75], v[32:35], v[128:135], v15
  v_smfmac_f32_16x16x64_bf16 v[76:79], v[32:35], v[136:143], v15
  s_waitcnt lgkmcnt(4)
  v_smfmac_f32_16x16x64_bf16 v[72:75], v[36:39], v[144:151], v15
  buffer_load_dwordx4 v0, s[4:7], s22 offen offset:2048 sc1 lds
  v_smfmac_f32_16x16x64_bf16 v[76:79], v[36:39], v[152:159], v15
  s_waitcnt lgkmcnt(3)
  v_smfmac_f32_16x16x64_bf16 v[72:75], v[40:43], v[160:167], v15
  ds_read_b128 v[56:59], v4 offset:8192
  v_smfmac_f32_16x16x64_bf16 v[76:79], v[40:43], v[168:175], v15
  buffer_load_dwordx4 v0, s[4:7], s22 offen offset:3072 sc1 lds
  s_waitcnt vmcnt(4)
  s_bitcmp1_b64 s[82:83], s14
  s_cbranch_scc1 L_F_fp0
L_F_fpr0:
  s_cmp_lg_u32 s97, 0
  s_cbranch_scc1 L_F_fl0
L_F_flr0:
  ds_read_b128 v[60:63], v4 offset:9216
  s_waitcnt lgkmcnt(4)
  v_smfmac_f32_16x16x64_bf16 v[72:75], v[44:47], v[176:183], v15
  ds_read_b128 v[24:27], v4 offset:10240
  v_smfmac_f32_16x16x64_bf16 v[76:79], v[44:47], v[184:191], v15
  buffer_store_dwordx4 v[20:23], v14, s[4:7], s24 offen sc1
  ds_read_b128 v[28:31], v4 offset:11264
  s_waitcnt lgkmcnt(5)
  v_smfmac_f32_16x16x64_bf16 v[72:75], v[48:51], v[192:199], v15
  ds_read_b128 v[64:67], v4 offset:12288
  v_smfmac_f32_16x16x64_bf16 v[76:79], v[48:51], v[200:207], v15
  ds_read_b128 v[68:71], v4 offset:13312
  s_waitcnt lgkmcnt(6)
  v_smfmac_f32_16x16x64_bf16 v[72:75], v[52:55], v[208:215], v15
  v_xor_b32 v6, 1024, v14
  buffer_store_dwordx4 v[16:19], v6, s[4:7], s24 offen sc1
  s_mov_b32 s24, s79
  s_add_u32 s79, s79, 8192
  ds_read_b128 v[16:19], v4 offset:14336
  v_smfmac_f32_16x16x64_bf16 v[76:79], v[52:55], v[216:223], v15
  ds_read_b128 v[20:23], v4 offset:15360
  v_smfmac_f32_16x16x64_bf16 v[80:83], v[40:43], a[64:71], v15
  s_nop 1
  v_smfmac_f32_16x16x64_bf16 v[84:87], v[40:43], a[72:79], v15
  s_add_u32 m0, s23, 4096
  s_add_u32 s26, s22, 4096
  buffer_load_dwordx4 v0, s[4:7], s26 offen offset:0 sc1 lds
  s_nop 1
  v_smfmac_f32_16x16x64_bf16 v[80:83], v[44:47], a[80:87], v15
  s_nop 1
  v_smfmac_f32_16x16x64_bf16 v[84:87], v[44:47], a[88:95], v15
  v_add_f32 v72, v72, v74
  v_add_f32 v73, v73, v75
  v_add_f32 v76, v76, v78
  v_add_f32 v77, v77, v79
  v_smfmac_f32_16x16x64_bf16 v[80:83], v[48:51], a[96:103], v15
  v_cvt_pk_bf16_f32 v72, v72, v73
  v_cvt_pk_bf16_f32 v76, v76, v77
  ds_write2st64_b32 v8, v72, v76 offset0:0 offset1:1
  v_smfmac_f32_16x16x64_bf16 v[84:87], v[48:51], a[104:111], v15
  buffer_load_dwordx4 v0, s[4:7], s26 offen offset:1024 sc1 lds
  s_add_u32 s22, s22, 24576
  s_sub_u32 s23, s25, s23
  v_smfmac_f32_16x16x64_bf16 v[80:83], v[52:55], a[112:119], v15
  ds_read_b128 v[72:75], v10 offset:0
  v_smfmac_f32_16x16x64_bf16 v[84:87], v[52:55], a[120:127], v15
  ds_read_b128 v[76:79], v10 offset:16
  v_smfmac_f32_16x16x64_bf16 v[80:83], v[32:35], a[32:39], v15
  v_smfmac_f32_16x16x64_bf16 v[84:87], v[32:35], a[40:47], v15
  v_smfmac_f32_16x16x64_bf16 v[80:83], v[36:39], a[48:55], v15
  s_waitcnt lgkmcnt(2)
  s_barrier
  v_smfmac_f32_16x16x64_bf16 v[84:87], v[36:39], a[56:63], v15
  v_smfmac_f32_16x16x64_bf16 v[88:91], v[40:43], v[56:63], v15
  s_nop 2
  v_smfmac_f32_16x16x64_bf16 v[92:95], v[40:43], v[24:31], v15
  s_nop 0
  v_add_f32 v80, v80, v82
  v_add_f32 v81, v81, v83
  v_smfmac_f32_16x16x64_bf16 v[88:91], v[44:47], v[64:71], v15
  v_add_f32 v84, v84, v86
  v_add_f32 v85, v85, v87
  v_cvt_pk_bf16_f32 v86, v80, v81
  v_cvt_pk_bf16_f32 v87, v84, v85
  ds_write2st64_b32 v9, v86, v87 offset0:0 offset1:1
  ds_read_b128 v[56:59], v0 offset:24576
  v_smfmac_f32_16x16x64_bf16 v[92:95], v[44:47], v[16:23], v15
  ds_read_b128 v[60:63], v0 offset:25600
  v_smfmac_f32_16x16x64_bf16 v[88:91], v[48:51], a[128:135], v15
  ds_read_b64_tr_b16 v[40:41], v5 offset:0
  ds_read_b64_tr_b16 v[42:43], v5 offset:64
  v_smfmac_f32_16x16x64_bf16 v[92:95], v[48:51], a[144:151], v15
  ds_read_b128 v[24:27], v0 offset:26624
  v_smfmac_f32_16x16x64_bf16 v[88:91], v[52:55], a[232:239], v15
  ds_read_b64_tr_b16 v[44:45], v5 offset:512
  ds_read_b64_tr_b16 v[46:47], v5 offset:576
  v_smfmac_f32_16x16x64_bf16 v[92:95], v[52:55], a[248:255], v15
  ds_read_b128 v[28:31], v0 offset:27648
  s_waitcnt lgkmcnt(8)
  s_barrier
  v_smfmac_f32_16x16x64_bf16 v[88:91], v[32:35], v[224:231], v15
  ds_read_b64_tr_b16 v[48:49], v5 offset:1024
  ds_read_b64_tr_b16 v[50:51], v5 offset:1088
  v_smfmac_f32_16x16x64_bf16 v[92:95], v[32:35], v[232:239], v15
  ds_read_b128 v[64:67], v0 offset:28672
  v_smfmac_f32_16x16x64_bf16 v[88:91], v[36:39], v[240:247], v15
  ds_read_b128 v[68:71], v0 offset:29696
  v_smfmac_f32_16x16x64_bf16 v[92:95], v[36:39], v[248:255], v15
  ds_read_b64_tr_b16 v[52:53], v5 offset:1536
  ds_read_b64_tr_b16 v[54:55], v5 offset:1600
  v_mfma_f32_16x16x16_bf16 v[80:83], v[2:3], v[2:3], 0
  ds_read_b128 v[16:19], v0 offset:30720
  s_waitcnt lgkmcnt(7)
  v_mfma_f32_16x16x32_bf16 v[72:75], v[56:59], v[40:43], v[72:75]
  ds_read_b128 v[20:23], v0 offset:31744
  v_mfma_f32_16x16x32_bf16 v[76:79], v[60:63], v[40:43], v[76:79]
  ds_read_b64_tr_b16 v[32:33], v7 offset:0
  ds_read_b64_tr_b16 v[34:35], v7 offset:128
  v_mfma_f32_16x16x32_bf16 v[72:75], v[24:27], v[44:47], v[72:75]
  ds_read_b64_tr_b16 v[36:37], v7 offset:1024
  ds_read_b64_tr_b16 v[38:39], v7 offset:1152
  v_mfma_f32_16x16x32_bf16 v[76:79], v[28:31], v[44:47], v[76:79]
  ds_read_b128 v[56:59], v1 offset:32768
  s_waitcnt lgkmcnt(9)
  v_mfma_f32_16x16x32_bf16 v[72:75], v[64:67], v[48:51], v[72:75]
  ds_read_b128 v[60:63], v1 offset:33792
  v_mfma_f32_16x16x32_bf16 v[76:79], v[68:71], v[48:51], v[76:79]
  s_waitcnt lgkmcnt(6)
  v_mfma_f32_16x16x32_bf16 v[72:75], v[16:19], v[52:55], v[72:75]
  ds_read_b128 v[64:67], v4 offset:18432
  v_mfma_f32_16x16x32_bf16 v[76:79], v[20:23], v[52:55], v[76:79]
  ds_read_b128 v[68:71], v4 offset:19456
  s_waitcnt lgkmcnt(4)
  v_smfmac_f32_16x16x64_bf16 v[80:83], v[32:35], v[40:47], v15
  v_smfmac_f32_16x16x64_bf16 v[80:83], v[36:39], v[48:55], v15
  v_mfma_f32_32x32x8_bf16 v[24:39], v[2:3], v[2:3], 0
  v_add_f32 v88, v88, v90
  v_add_f32 v89, v89, v91
  v_add_f32 v92, v92, v94
  v_add_f32 v93, v93, v95
  v_max3_f32 v84, v72, v73, v74
  v_max3_f32 v85, v75, v76, v77
  v_max3_f32 v84, v84, v78, v79
  v_add_f32 v80, v80, v82
  v_add_f32 v81, v81, v83
  v_max3_f32 v84, v84, v85, v80
  v_max_f32 v84, v84, v81
  v_mov_b32 v85, v84
  v_mfma_f32_32x32x8_bf16 v[40:55], v[2:3], v[2:3], 0
  v_cvt_pk_bf16_f32 v88, v88, v89
  v_permlane16_swap_b32 v85, v84
  v_max_f32 v84, v84, v85
  v_mov_b32 v85, v84
  v_cvt_pk_bf16_f32 v89, v92, v93
  v_lshrrev_b32 v90, 2, v1
  v_permlane32_swap_b32 v85, v84
  ds_write2st64_b32 v90, v88, v89 offset0:56 offset1:57
  v_max_f32 v84, v84, v85
  v_mul_f32 v86, s34, v84
  v_pk_fma_f32 v[72:73], v[72:73], s[34:35], v[86:87] op_sel_hi:[1,1,0] neg_lo:[0,0,1] neg_hi:[0,0,1]
  v_pk_fma_f32 v[74:75], v[74:75], s[34:35], v[86:87] op_sel_hi:[1,1,0] neg_lo:[0,0,1] neg_hi:[0,0,1]
  v_pk_fma_f32 v[76:77], v[76:77], s[34:35], v[86:87] op_sel_hi:[1,1,0] neg_lo:[0,0,1] neg_hi:[0,0,1]
  v_pk_fma_f32 v[78:79], v[78:79], s[34:35], v[86:87] op_sel_hi:[1,1,0] neg_lo:[0,0,1] neg_hi:[0,0,1]
  v_pk_fma_f32 v[80:81], v[80:81], s[34:35], v[86:87] op_sel_hi:[1,1,0] neg_lo:[0,0,1] neg_hi:[0,0,1]
  v_exp_f32 v72, v72
  v_exp_f32 v73, v73
  v_exp_f32 v74, v74
  v_exp_f32 v75, v75
  v_exp_f32 v76, v76
  v_exp_f32 v77, v77
  v_exp_f32 v78, v78
  v_exp_f32 v79, v79
  v_exp_f32 v80, v80
  v_exp_f32 v81, v81
  v_pk_add_f32 v[84:85], v[72:73], v[74:75]
  v_pk_add_f32 v[86:87], v[76:77], v[78:79]
  v_cvt_pk_bf16_f32 v72, v72, v73
  v_cvt_pk_bf16_f32 v73, v74, v75
  v_cvt_pk_bf16_f32 v74, v76, v77
  v_cvt_pk_bf16_f32 v75, v78, v79
  v_pk_add_f32 v[84:85], v[84:85], v[80:81]
  v_cvt_pk_bf16_f32 v76, v80, v81
  v_pk_add_f32 v[84:85], v[84:85], v[86:87]
  s_waitcnt lgkmcnt(1)
  v_mfma_f32_16x16x32_bf16 v[16:19], v[56:59], v[72:75], 0
  v_mov_b32 v77, 0
  v_mov_b32 v78, 0
  v_mfma_f32_16x16x32_bf16 v[20:23], v[60:63], v[72:75], 0
  v_mov_b32 v79, v76
  v_add_f32 v84, v84, v85
  v_mfma_f32_16x16x16_bf16 v[16:19], v[88:89], v[76:77], v[16:19]
  v_mov_b32 v85, v84
  v_mfma_f32_16x16x16_bf16 v[20:23], v[88:89], v[78:79], v[20:23]
  s_nop 0
  v_permlane16_swap_b32 v85, v84
  v_add_f32 v84, v84, v85
  v_mov_b32 v85, v84
  s_nop 1
  v_permlane32_swap_b32 v85, v84
  v_add_f32 v84, v84, v85
  v_rcp_f32 v84, v84
  s_nop 0
  v_pk_mul_f32 v[16:17], v[16:17], v[84:85] op_sel_hi:[1,0]
  v_pk_mul_f32 v[18:19], v[18:19], v[84:85] op_sel_hi:[1,0]
  v_pk_mul_f32 v[20:21], v[20:21], v[84:85] op_sel_hi:[1,0]
  v_pk_mul_f32 v[22:23], v[22:23], v[84:85] op_sel_hi:[1,0]
  v_cvt_pk_bf16_f32 v80, v16, v17
  v_cvt_pk_bf16_f32 v81, v18, v19
  v_cvt_pk_bf16_f32 v82, v20, v21
  v_cvt_pk_bf16_f32 v83, v22, v23
  s_mov_b64 exec, s[30:31]
  ds_write_b128 v14, v[80:83] offset:0
  s_mov_b64 exec, -1
  s_waitcnt lgkmcnt(0)
  s_barrier
  ds_read_b128 v[16:19], v0 offset:0
  ds_read_b128 v[20:23], v0 offset:1024
  ds_read_b128 v[56:59], v4 offset:16384
  ds_read_b128 v[60:63], v4 offset:17408
  s_waitcnt lgkmcnt(3)
  v_smfmac_f32_16x16x64_bf16 v[28:31], v[16:19], v[64:71], v15
  v_smfmac_f32_16x16x64_bf16 v[32:35], v[16:19], a[160:167], v15
  ds_read_b128 v[64:67], v4 offset:22528
  v_smfmac_f32_16x16x64_bf16 v[36:39], v[16:19], a[176:183], v15
  ds_read_b128 v[68:71], v4 offset:23552
  s_waitcnt lgkmcnt(2)
  v_smfmac_f32_16x16x64_bf16 v[24:27], v[16:19], v[56:63], v15
  v_smfmac_f32_16x16x64_bf16 v[24:27], v[20:23], a[136:143], v15
  ds_read_b128 v[56:59], v4 offset:20480
  v_smfmac_f32_16x16x64_bf16 v[28:31], v[20:23], a[152:159], v15
  ds_read_b128 v[60:63], v4 offset:21504
  v_smfmac_f32_16x16x64_bf16 v[32:35], v[20:23], a[168:175], v15
  v_smfmac_f32_16x16x64_bf16 v[36:39], v[20:23], a[184:191], v15
  v_smfmac_f32_16x16x64_bf16 v[40:43], v[16:19], a[192:199], v15
  v_smfmac_f32_16x16x64_bf16 v[40:43], v[20:23], a[200:207], v15
  s_nop 0
  v_smfmac_f32_16x16x64_bf16 v[44:47], v[16:19], a[208:215], v15
  v_add_f32 v24, v24, v26
  v_add_f32 v25, v25, v27
  v_cvt_pk_bf16_f32 v24, v24, v25
  v_smfmac_f32_16x16x64_bf16 v[44:47], v[20:23], a[216:223], v15
  v_add_f32 v28, v28, v30
  v_add_f32 v29, v29, v31
  v_cvt_pk_bf16_f32 v25, v28, v29
  v_smfmac_f32_16x16x64_bf16 v[48:51], v[16:19], a[224:231], v15
  v_add_f32 v32, v32, v34
  v_add_f32 v33, v33, v35
  v_cvt_pk_bf16_f32 v26, v32, v33
  v_smfmac_f32_16x16x64_bf16 v[52:55], v[16:19], a[240:247], v15
  v_add_f32 v36, v36, v38
  v_add_f32 v37, v37, v39
  v_cvt_pk_bf16_f32 v27, v36, v37
  v_and_b32 v24, -2, v24
  s_waitcnt lgkmcnt(0)
  v_smfmac_f32_16x16x64_bf16 v[48:51], v[20:23], v[56:63], v15
  buffer_store_dwordx4 v[24:27], v12, s[4:7], s18 offen
  v_smfmac_f32_16x16x64_bf16 v[52:55], v[20:23], v[64:71], v15
  v_add_f32 v40, v40, v42
  v_add_f32 v41, v41, v43
  v_cvt_pk_bf16_f32 v40, v40, v41
  v_and_b32 v40, -2, v40
  v_add_f32 v44, v44, v46
  v_add_f32 v45, v45, v47
  v_cvt_pk_bf16_f32 v41, v44, v45
  v_pk_add_f32 v[48:49], v[48:49], v[50:51]
  v_cvt_pk_bf16_f32 v42, v48, v49
  v_pk_add_f32 v[52:53], v[52:53], v[54:55]
  v_cvt_pk_bf16_f32 v43, v52, v53
  buffer_store_dwordx4 v[40:43], v12, s[4:7], s19 offen
L_F_offpv0:
  v_lshrrev_b32 v51, 2, v1
  v_xor_b32 v48, 0x800, v1
  v_xor_b32 v49, 0x1000, v1
  v_xor_b32 v50, 0x1800, v1
  ds_read_b128 v[24:27], v48 offset:32768
  ds_read_b128 v[28:31], v48 offset:33792
  v_xor_b32 v52, 0x200, v51
  ds_read2st64_b32 v[52:53], v52 offset0:56 offset1:57
  ds_read_b128 v[32:35], v49 offset:32768
  ds_read_b128 v[36:39], v49 offset:33792
  v_xor_b32 v54, 0x400, v51
  ds_read2st64_b32 v[54:55], v54 offset0:56 offset1:57
  v_mov_b32 v92, 0x3f80
  v_mov_b32 v93, 0x3f800000
  v_cndmask_b32 v92, 0, v92, s[44:45]
  v_cndmask_b32 v92, v92, v93, s[46:47]
  v_cndmask_b32 v88, 0, v92, s[36:37]
  v_cndmask_b32 v89, 0, v92, s[38:39]
  v_cndmask_b32 v90, 0, v92, s[40:41]
  v_cndmask_b32 v91, 0, v92, s[42:43]
  s_waitcnt lgkmcnt(3)
  v_mfma_f32_16x16x32_bf16 v[40:43], v[24:27], v[72:75], 0
  v_mfma_f32_16x16x32_bf16 v[44:47], v[28:31], v[72:75], 0
  v_mfma_f32_16x16x16_bf16 v[40:43], v[52:53], v[76:77], v[40:43]
  v_mfma_f32_16x16x16_bf16 v[44:47], v[52:53], v[78:79], v[44:47]
  ds_read_b128 v[24:27], v50 offset:32768
  ds_read_b128 v[28:31], v50 offset:33792
  v_xor_b32 v52, 0x600, v51
  ds_read2st64_b32 v[52:53], v52 offset0:56 offset1:57
  s_waitcnt lgkmcnt(3)
  v_mfma_f32_16x16x32_bf16 v[16:19], v[32:35], v[72:75], 0
  v_mfma_f32_16x16x32_bf16 v[20:23], v[36:39], v[72:75], 0
  v_mfma_f32_16x16x16_bf16 v[16:19], v[54:55], v[76:77], v[16:19]
  v_mfma_f32_16x16x16_bf16 v[20:23], v[54:55], v[78:79], v[20:23]
  buffer_load_dwordx4 v[56:59], v0, s[4:7], s20 offen sc1
  buffer_load_dwordx4 v[60:63], v0, s[4:7], s21 offen sc1
  v_cndmask_b32 v51, -1, -2, s[2:3]
  s_waitcnt lgkmcnt(0)
  v_mfma_f32_16x16x32_bf16 v[32:35], v[24:27], v[72:75], 0
  v_mfma_f32_16x16x32_bf16 v[36:39], v[28:31], v[72:75], 0
  v_mfma_f32_16x16x16_bf16 v[32:35], v[52:53], v[76:77], v[32:35]
  v_mfma_f32_16x16x16_bf16 v[36:39], v[52:53], v[78:79], v[36:39]
  buffer_load_dwordx4 v[64:67], v0, s[4:7], s20 offen sc1
  buffer_load_dwordx4 v[68:71], v0, s[4:7], s21 offen sc1
L_F_red0:
  s_waitcnt vmcnt(2)
  v_mfma_f32_16x16x32_bf16 v[92:95], v[88:91], v[56:59], 0
  v_mfma_f32_16x16x32_bf16 v[92:95], v[88:91], v[60:63], v[92:95]
  v_bitop3_b32 v6, v56, v60, 1 bitop3:0xa8
  v_cmp_ne_u32 vcc, 0, v6
  s_cbranch_vccnz L_F_f1x0
L_F_tail0:
  s_nop 4
  v_add_f32_dpp v92, v92, v92 row_ror:4 row_mask:0xf bank_mask:0xf
  v_add_f32_dpp v93, v93, v93 row_ror:4 row_mask:0xf bank_mask:0xf
  v_add_f32_dpp v94, v94, v94 row_ror:4 row_mask:0xf bank_mask:0xf
  v_add_f32_dpp v95, v95, v95 row_ror:4 row_mask:0xf bank_mask:0xf
  v_add_f32_dpp v92, v92, v92 row_ror:8 row_mask:0xf bank_mask:0xf
  v_add_f32_dpp v93, v93, v93 row_ror:8 row_mask:0xf bank_mask:0xf
  v_add_f32_dpp v94, v94, v94 row_ror:8 row_mask:0xf bank_mask:0xf
  v_add_f32_dpp v95, v95, v95 row_ror:8 row_mask:0xf bank_mask:0xf
  v_cvt_pk_bf16_f32 v92, v92, v93
  v_cvt_pk_bf16_f32 v93, v94, v95
  v_and_b32 v92, v51, v92
  buffer_store_dwordx2 v[92:93], v13, s[4:7], s17 offen
L_F_w20:
  v_pk_mul_f32 v[40:41], v[40:41], v[84:85] op_sel_hi:[1,0]
  v_pk_mul_f32 v[42:43], v[42:43], v[84:85] op_sel_hi:[1,0]
  v_pk_mul_f32 v[44:45], v[44:45], v[84:85] op_sel_hi:[1,0]
  v_pk_mul_f32 v[46:47], v[46:47], v[84:85] op_sel_hi:[1,0]
  v_cvt_pk_bf16_f32 v40, v40, v41
  v_cvt_pk_bf16_f32 v41, v42, v43
  v_cvt_pk_bf16_f32 v42, v44, v45
  v_cvt_pk_bf16_f32 v43, v46, v47
  v_pk_mul_f32 v[16:17], v[16:17], v[84:85] op_sel_hi:[1,0]
  v_pk_mul_f32 v[18:19], v[18:19], v[84:85] op_sel_hi:[1,0]
  v_pk_mul_f32 v[20:21], v[20:21], v[84:85] op_sel_hi:[1,0]
  v_pk_mul_f32 v[22:23], v[22:23], v[84:85] op_sel_hi:[1,0]
  v_cvt_pk_bf16_f32 v16, v16, v17
  v_cvt_pk_bf16_f32 v17, v18, v19
  v_cvt_pk_bf16_f32 v18, v20, v21
  v_cvt_pk_bf16_f32 v19, v22, v23
  v_mov_b32_dpp v80, v40 row_ror:8 row_mask:0xf bank_mask:0x3
  v_mov_b32_dpp v81, v41 row_ror:8 row_mask:0xf bank_mask:0x3
  v_mov_b32_dpp v82, v42 row_ror:8 row_mask:0xf bank_mask:0x3
  v_mov_b32_dpp v83, v43 row_ror:8 row_mask:0xf bank_mask:0x3
  v_pk_mul_f32 v[32:33], v[32:33], v[84:85] op_sel_hi:[1,0]
  v_pk_mul_f32 v[34:35], v[34:35], v[84:85] op_sel_hi:[1,0]
  v_pk_mul_f32 v[36:37], v[36:37], v[84:85] op_sel_hi:[1,0]
  v_pk_mul_f32 v[38:39], v[38:39], v[84:85] op_sel_hi:[1,0]
  v_cvt_pk_bf16_f32 v32, v32, v33
  v_cvt_pk_bf16_f32 v33, v34, v35
  v_cvt_pk_bf16_f32 v34, v36, v37
  v_cvt_pk_bf16_f32 v35, v38, v39
  v_mov_b32 v88, 0
  v_mov_b32 v89, 0
  v_mov_b32 v90, 0
  v_mov_b32 v91, 0
  v_mov_b32 v92, 0
  v_mov_b32 v93, 0
  v_mov_b32 v94, 0
  v_mov_b32 v95, 0
  s_mov_b64 exec, s[32:33]
  v_xor_b32 v5, 0xe000, v5
  s_mov_b64 exec, -1
  buffer_load_dwordx4 v[24:27], v0, s[4:7], s16 offen sc1
  buffer_load_dwordx4 v[28:31], v0, s[4:7], s16 offen offset:1024 sc1
L_F_nx20:
  v_mov_b32 v20, v80
  v_mov_b32 v21, v81
  v_mov_b32 v22, v82
  v_mov_b32 v23, v83
  v_mov_b32_dpp v16, v32 row_ror:8 row_mask:0xf bank_mask:0x3
  v_mov_b32_dpp v17, v33 row_ror:8 row_mask:0xf bank_mask:0x3
  v_mov_b32_dpp v18, v34 row_ror:8 row_mask:0xf bank_mask:0x3
  v_mov_b32_dpp v19, v35 row_ror:8 row_mask:0xf bank_mask:0x3
  v_mov_b32 v72, 0
  v_mov_b32 v73, 0
  v_mov_b32 v74, 0
  v_mov_b32 v75, 0
  v_mov_b32 v76, 0
  v_mov_b32 v77, 0
  v_mov_b32 v78, 0
  v_mov_b32 v79, 0
  v_mov_b32 v80, 0
  v_mov_b32 v81, 0
  v_mov_b32 v82, 0
  v_mov_b32 v83, 0
  v_mov_b32 v84, 0
  v_mov_b32 v85, 0
  v_mov_b32 v86, 0
  v_mov_b32 v87, 0
  ds_read_b128 v[32:35], v4 offset:0
  ds_read_b128 v[36:39], v4 offset:1024
  ds_read_b128 v[40:43], v4 offset:2048
  ds_read_b128 v[44:47], v4 offset:3072
  ds_read_b128 v[48:51], v4 offset:4096
  ds_read_b128 v[52:55], v4 offset:5120
  buffer_load_dwordx4 v[64:67], v0, s[4:7], s16 offen sc1
  buffer_load_dwordx4 v[68:71], v0, s[4:7], s16 offen offset:1024 sc1
  s_add_u32 s14, s14, 1
  s_cmp_lg_u32 s97, 0
  s_cbranch_scc1 L_F_xq0
L_F_xok0:
  s_waitcnt vmcnt(2)
L_F_fpd0:
  ds_read_b128 v[56:59], v4 offset:6144
  ds_read_b128 v[60:63], v4 offset:7168
L_F_chk1:
  v_bitop3_b32 v6, v24, v28, 1 bitop3:0xa8
  v_cmp_ne_u32 vcc, 0, v6
  s_cbranch_vccnz L_F_f2x1
L_F_have1:
  s_waitcnt lgkmcnt(2)
  v_smfmac_f32_16x16x64_bf16 v[88:91], v[24:27], v[32:39], v15
  ds_write_b64 v1, v[24:25] offset:0
  v_smfmac_f32_16x16x64_bf16 v[92:95], v[24:27], v[40:47], v15
  ds_write_b64 v1, v[26:27] offset:8
  v_smfmac_f32_16x16x64_bf16 v[88:91], v[28:31], v[48:55], v15
  ds_write_b64 v1, v[28:29] offset:1024
  v_smfmac_f32_16x16x64_bf16 v[72:75], v[24:27], v[96:103], v15
  ds_write_b64 v1, v[30:31] offset:1032
  v_smfmac_f32_16x16x64_bf16 v[76:79], v[24:27], v[104:111], v15
  v_xor_b32 v39, 0x800, v1
  v_smfmac_f32_16x16x64_bf16 v[72:75], v[28:31], v[112:119], v15
  v_xor_b32 v47, 0x1000, v1
  v_smfmac_f32_16x16x64_bf16 v[76:79], v[28:31], v[120:127], v15
  v_xor_b32 v55, 0x1800, v1
  v_smfmac_f32_16x16x64_bf16 v[80:83], v[24:27], a[0:7], v15
  s_waitcnt lgkmcnt(0)
  s_barrier
  ds_read_b128 v[32:35], v39 offset:0
  ds_read_b128 v[36:39], v39 offset:1024
  v_smfmac_f32_16x16x64_bf16 v[84:87], v[24:27], a[8:15], v15
  s_mov_b32 m0, s23
  s_nop 0
  buffer_load_dwordx4 v0, s[4:7], s22 offen offset:0 sc1 lds
  ds_read_b128 v[40:43], v47 offset:0
  ds_read_b128 v[44:47], v47 offset:1024
  v_smfmac_f32_16x16x64_bf16 v[80:83], v[28:31], a[16:23], v15
  ds_read_b128 v[48:51], v55 offset:0
  ds_read_b128 v[52:55], v55 offset:1024
  v_smfmac_f32_16x16x64_bf16 v[84:87], v[28:31], a[24:31], v15
  v_smfmac_f32_16x16x64_bf16 v[92:95], v[28:31], v[56:63], v15
  buffer_load_dwordx4 v0, s[4:7], s22 offen offset:1024 sc1 lds
L_F_rest1:
  s_waitcnt lgkmcnt(5)
  v_smfmac_f32_16x16x64_bf16 v[72:75], v[32:35], v[128:135], v15
  v_smfmac_f32_16x16x64_bf16 v[76:79], v[32:35], v[136:143], v15
  s_waitcnt lgkmcnt(4)
  v_smfmac_f32_16x16x64_bf16 v[72:75], v[36:39], v[144:151], v15
  buffer_load_dwordx4 v0, s[4:7], s22 offen offset:2048 sc1 lds
  v_smfmac_f32_16x16x64_bf16 v[76:79], v[36:39], v[152:159], v15
  s_waitcnt lgkmcnt(3)
  v_smfmac_f32_16x16x64_bf16 v[72:75], v[40:43], v[160:167], v15
  ds_read_b128 v[56:59], v4 offset:8192
  v_smfmac_f32_16x16x64_bf16 v[76:79], v[40:43], v[168:175], v15
  buffer_load_dwordx4 v0, s[4:7], s22 offen offset:3072 sc1 lds
  s_waitcnt vmcnt(4)
  s_bitcmp1_b64 s[82:83], s14
  s_cbranch_scc1 L_F_fp1
L_F_fpr1:
  s_cmp_lg_u32 s97, 0
  s_cbranch_scc1 L_F_fl1
L_F_flr1:
  ds_read_b128 v[60:63], v4 offset:9216
  s_waitcnt lgkmcnt(4)
  v_smfmac_f32_16x16x64_bf16 v[72:75], v[44:47], v[176:183], v15
  ds_read_b128 v[24:27], v4 offset:10240
  v_smfmac_f32_16x16x64_bf16 v[76:79], v[44:47], v[184:191], v15
  buffer_store_dwordx4 v[20:23], v14, s[4:7], s24 offen sc1
  ds_read_b128 v[28:31], v4 offset:11264
  s_waitcnt lgkmcnt(5)
  v_smfmac_f32_16x16x64_bf16 v[72:75], v[48:51], v[192:199], v15
  ds_read_b128 v[64:67], v4 offset:12288
  v_smfmac_f32_16x16x64_bf16 v[76:79], v[48:51], v[200:207], v15
  ds_read_b128 v[68:71], v4 offset:13312
  s_waitcnt lgkmcnt(6)
  v_smfmac_f32_16x16x64_bf16 v[72:75], v[52:55], v[208:215], v15
  v_xor_b32 v6, 1024, v14
  buffer_store_dwordx4 v[16:19], v6, s[4:7], s24 offen sc1
  s_mov_b32 s24, s79
  s_add_u32 s79, s79, 8192
  ds_read_b128 v[16:19], v4 offset:14336
  v_smfmac_f32_16x16x64_bf16 v[76:79], v[52:55], v[216:223], v15
  ds_read_b128 v[20:23], v4 offset:15360
  v_smfmac_f32_16x16x64_bf16 v[80:83], v[40:43], a[64:71], v15
  s_nop 1
  v_smfmac_f32_16x16x64_bf16 v[84:87], v[40:43], a[72:79], v15
  s_add_u32 m0, s23, 4096
  s_add_u32 s26, s22, 4096
  buffer_load_dwordx4 v0, s[4:7], s26 offen offset:0 sc1 lds
  s_nop 1
  v_smfmac_f32_16x16x64_bf16 v[80:83], v[44:47], a[80:87], v15
  s_nop 1
  v_smfmac_f32_16x16x64_bf16 v[84:87], v[44:47], a[88:95], v15
  v_add_f32 v72, v72, v74
  v_add_f32 v73, v73, v75
  v_add_f32 v76, v76, v78
  v_add_f32 v77, v77, v79
  v_smfmac_f32_16x16x64_bf16 v[80:83], v[48:51], a[96:103], v15
  v_cvt_pk_bf16_f32 v72, v72, v73
  v_cvt_pk_bf16_f32 v76, v76, v77
  ds_write2st64_b32 v8, v72, v76 offset0:0 offset1:1
  v_smfmac_f32_16x16x64_bf16 v[84:87], v[48:51], a[104:111], v15
  buffer_load_dwordx4 v0, s[4:7], s26 offen offset:1024 sc1 lds
  s_add_u32 s22, s22, 24576
  s_sub_u32 s23, s25, s23
  v_smfmac_f32_16x16x64_bf16 v[80:83], v[52:55], a[112:119], v15
  ds_read_b128 v[72:75], v10 offset:0
  v_smfmac_f32_16x16x64_bf16 v[84:87], v[52:55], a[120:127], v15
  ds_read_b128 v[76:79], v10 offset:16
  v_smfmac_f32_16x16x64_bf16 v[80:83], v[32:35], a[32:39], v15
  v_smfmac_f32_16x16x64_bf16 v[84:87], v[32:35], a[40:47], v15
  v_smfmac_f32_16x16x64_bf16 v[80:83], v[36:39], a[48:55], v15
  s_cmp_eq_u32 s14, 1
  s_cbranch_scc1 L_F_x01
L_F_x0r1:
  s_waitcnt lgkmcnt(2)
  s_barrier
  v_smfmac_f32_16x16x64_bf16 v[84:87], v[36:39], a[56:63], v15
  v_smfmac_f32_16x16x64_bf16 v[88:91], v[40:43], v[56:63], v15
  s_nop 2
  v_smfmac_f32_16x16x64_bf16 v[92:95], v[40:43], v[24:31], v15
  s_nop 0
  v_add_f32 v80, v80, v82
  v_add_f32 v81, v81, v83
  v_smfmac_f32_16x16x64_bf16 v[88:91], v[44:47], v[64:71], v15
  v_add_f32 v84, v84, v86
  v_add_f32 v85, v85, v87
  v_cvt_pk_bf16_f32 v86, v80, v81
  v_cvt_pk_bf16_f32 v87, v84, v85
  ds_write2st64_b32 v9, v86, v87 offset0:0 offset1:1
  ds_read_b128 v[56:59], v0 offset:49152
  v_smfmac_f32_16x16x64_bf16 v[92:95], v[44:47], v[16:23], v15
  ds_read_b128 v[60:63], v0 offset:50176
  v_smfmac_f32_16x16x64_bf16 v[88:91], v[48:51], a[128:135], v15
  ds_read_b64_tr_b16 v[40:41], v5 offset:0
  ds_read_b64_tr_b16 v[42:43], v5 offset:64
  v_smfmac_f32_16x16x64_bf16 v[92:95], v[48:51], a[144:151], v15
  ds_read_b128 v[24:27], v0 offset:51200
  v_smfmac_f32_16x16x64_bf16 v[88:91], v[52:55], a[232:239], v15
  ds_read_b64_tr_b16 v[44:45], v5 offset:512
  ds_read_b64_tr_b16 v[46:47], v5 offset:576
  v_smfmac_f32_16x16x64_bf16 v[92:95], v[52:55], a[248:255], v15
  ds_read_b128 v[28:31], v0 offset:52224
  s_waitcnt lgkmcnt(8)
  s_barrier
  v_smfmac_f32_16x16x64_bf16 v[88:91], v[32:35], v[224:231], v15
  ds_read_b64_tr_b16 v[48:49], v5 offset:1024
  ds_read_b64_tr_b16 v[50:51], v5 offset:1088
  v_smfmac_f32_16x16x64_bf16 v[92:95], v[32:35], v[232:239], v15
  ds_read_b128 v[64:67], v0 offset:53248
  v_smfmac_f32_16x16x64_bf16 v[88:91], v[36:39], v[240:247], v15
  ds_read_b128 v[68:71], v0 offset:54272
  v_smfmac_f32_16x16x64_bf16 v[92:95], v[36:39], v[248:255], v15
  ds_read_b64_tr_b16 v[52:53], v5 offset:1536
  ds_read_b64_tr_b16 v[54:55], v5 offset:1600
  v_mfma_f32_16x16x16_bf16 v[80:83], v[2:3], v[2:3], 0
  ds_read_b128 v[16:19], v0 offset:55296
  s_waitcnt lgkmcnt(7)
  v_mfma_f32_16x16x32_bf16 v[72:75], v[56:59], v[40:43], v[72:75]
  ds_read_b128 v[20:23], v0 offset:56320
  v_mfma_f32_16x16x32_bf16 v[76:79], v[60:63], v[40:43], v[76:79]
  ds_read_b64_tr_b16 v[32:33], v7 offset:0
  ds_read_b64_tr_b16 v[34:35], v7 offset:128
  v_mfma_f32_16x16x32_bf16 v[72:75], v[24:27], v[44:47], v[72:75]
  ds_read_b64_tr_b16 v[36:37], v7 offset:1024
  ds_read_b64_tr_b16 v[38:39], v7 offset:1152
  v_mfma_f32_16x16x32_bf16 v[76:79], v[28:31], v[44:47], v[76:79]
  ds_read_b128 v[56:59], v1 offset:57344
  s_waitcnt lgkmcnt(9)
  v_mfma_f32_16x16x32_bf16 v[72:75], v[64:67], v[48:51], v[72:75]
  ds_read_b128 v[60:63], v1 offset:58368
  v_mfma_f32_16x16x32_bf16 v[76:79], v[68:71], v[48:51], v[76:79]
  s_waitcnt lgkmcnt(6)
  v_mfma_f32_16x16x32_bf16 v[72:75], v[16:19], v[52:55], v[72:75]
  ds_read_b128 v[64:67], v4 offset:18432
  v_mfma_f32_16x16x32_bf16 v[76:79], v[20:23], v[52:55], v[76:79]
  ds_read_b128 v[68:71], v4 offset:19456
  s_waitcnt lgkmcnt(4)
  v_smfmac_f32_16x16x64_bf16 v[80:83], v[32:35], v[40:47], v15
  v_smfmac_f32_16x16x64_bf16 v[80:83], v[36:39], v[48:55], v15
  v_mfma_f32_32x32x8_bf16 v[24:39], v[2:3], v[2:3], 0
  v_add_f32 v88, v88, v90
  v_add_f32 v89, v89, v91
  v_add_f32 v92, v92, v94
  v_add_f32 v93, v93, v95
  v_max3_f32 v84, v72, v73, v74
  v_max3_f32 v85, v75, v76, v77
  v_max3_f32 v84, v84, v78, v79
  v_add_f32 v80, v80, v82
  v_add_f32 v81, v81, v83
  v_max3_f32 v84, v84, v85, v80
  v_max_f32 v84, v84, v81
  v_mov_b32 v85, v84
  v_mfma_f32_32x32x8_bf16 v[40:55], v[2:3], v[2:3], 0
  v_cvt_pk_bf16_f32 v88, v88, v89
  v_permlane16_swap_b32 v85, v84
  v_max_f32 v84, v84, v85
  v_mov_b32 v85, v84
  v_cvt_pk_bf16_f32 v89, v92, v93
  v_lshrrev_b32 v90, 2, v1
  v_permlane32_swap_b32 v85, v84
  ds_write2st64_b32 v90, v88, v89 offset0:56 offset1:57
  v_max_f32 v84, v84, v85
  v_mul_f32 v86, s34, v84
  v_pk_fma_f32 v[72:73], v[72:73], s[34:35], v[86:87] op_sel_hi:[1,1,0] neg_lo:[0,0,1] neg_hi:[0,0,1]
  v_pk_fma_f32 v[74:75], v[74:75], s[34:35], v[86:87] op_sel_hi:[1,1,0] neg_lo:[0,0,1] neg_hi:[0,0,1]
  v_pk_fma_f32 v[76:77], v[76:77], s[34:35], v[86:87] op_sel_hi:[1,1,0] neg_lo:[0,0,1] neg_hi:[0,0,1]
  v_pk_fma_f32 v[78:79], v[78:79], s[34:35], v[86:87] op_sel_hi:[1,1,0] neg_lo:[0,0,1] neg_hi:[0,0,1]
  v_pk_fma_f32 v[80:81], v[80:81], s[34:35], v[86:87] op_sel_hi:[1,1,0] neg_lo:[0,0,1] neg_hi:[0,0,1]
  v_exp_f32 v72, v72
  v_exp_f32 v73, v73
  v_exp_f32 v74, v74
  v_exp_f32 v75, v75
  v_exp_f32 v76, v76
  v_exp_f32 v77, v77
  v_exp_f32 v78, v78
  v_exp_f32 v79, v79
  v_exp_f32 v80, v80
  v_exp_f32 v81, v81
  v_pk_add_f32 v[84:85], v[72:73], v[74:75]
  v_pk_add_f32 v[86:87], v[76:77], v[78:79]
  v_cvt_pk_bf16_f32 v72, v72, v73
  v_cvt_pk_bf16_f32 v73, v74, v75
  v_cvt_pk_bf16_f32 v74, v76, v77
  v_cvt_pk_bf16_f32 v75, v78, v79
  v_pk_add_f32 v[84:85], v[84:85], v[80:81]
  v_cvt_pk_bf16_f32 v76, v80, v81
  v_pk_add_f32 v[84:85], v[84:85], v[86:87]
  s_waitcnt lgkmcnt(1)
  v_mfma_f32_16x16x32_bf16 v[16:19], v[56:59], v[72:75], 0
  v_mov_b32 v77, 0
  v_mov_b32 v78, 0
  v_mfma_f32_16x16x32_bf16 v[20:23], v[60:63], v[72:75], 0
  v_mov_b32 v79, v76
  v_add_f32 v84, v84, v85
  v_mfma_f32_16x16x16_bf16 v[16:19], v[88:89], v[76:77], v[16:19]
  v_mov_b32 v85, v84
  v_mfma_f32_16x16x16_bf16 v[20:23], v[88:89], v[78:79], v[20:23]
  s_nop 0
  v_permlane16_swap_b32 v85, v84
  v_add_f32 v84, v84, v85
  v_mov_b32 v85, v84
  s_nop 1
  v_permlane32_swap_b32 v85, v84
  v_add_f32 v84, v84, v85
  v_rcp_f32 v84, v84
  s_nop 0
  v_pk_mul_f32 v[16:17], v[16:17], v[84:85] op_sel_hi:[1,0]
  v_pk_mul_f32 v[18:19], v[18:19], v[84:85] op_sel_hi:[1,0]
  v_pk_mul_f32 v[20:21], v[20:21], v[84:85] op_sel_hi:[1,0]
  v_pk_mul_f32 v[22:23], v[22:23], v[84:85] op_sel_hi:[1,0]
  v_cvt_pk_bf16_f32 v80, v16, v17
  v_cvt_pk_bf16_f32 v81, v18, v19
  v_cvt_pk_bf16_f32 v82, v20, v21
  v_cvt_pk_bf16_f32 v83, v22, v23
  s_mov_b64 exec, s[30:31]
  ds_write_b128 v14, v[80:83] offset:0
  s_mov_b64 exec, -1
  s_waitcnt lgkmcnt(0)
  s_barrier
  ds_read_b128 v[16:19], v0 offset:0
  ds_read_b128 v[20:23], v0 offset:1024
  ds_read_b128 v[56:59], v4 offset:16384
  ds_read_b128 v[60:63], v4 offset:17408
  s_cmp_eq_u32 s14, 63
  s_cbranch_scc1 L_F_offpv1
  s_waitcnt lgkmcnt(3)
  v_smfmac_f32_16x16x64_bf16 v[28:31], v[16:19], v[64:71], v15
  v_smfmac_f32_16x16x64_bf16 v[32:35], v[16:19], a[160:167], v15
  ds_read_b128 v[64:67], v4 offset:22528
  v_smfmac_f32_16x16x64_bf16 v[36:39], v[16:19], a[176:183], v15
  ds_read_b128 v[68:71], v4 offset:23552
  s_waitcnt lgkmcnt(2)
  v_smfmac_f32_16x16x64_bf16 v[24:27], v[16:19], v[56:63], v15
  v_smfmac_f32_16x16x64_bf16 v[24:27], v[20:23], a[136:143], v15
  ds_read_b128 v[56:59], v4 offset:20480
  v_smfmac_f32_16x16x64_bf16 v[28:31], v[20:23], a[152:159], v15
  ds_read_b128 v[60:63], v4 offset:21504
  v_smfmac_f32_16x16x64_bf16 v[32:35], v[20:23], a[168:175], v15
  v_smfmac_f32_16x16x64_bf16 v[36:39], v[20:23], a[184:191], v15
  v_smfmac_f32_16x16x64_bf16 v[40:43], v[16:19], a[192:199], v15
  v_smfmac_f32_16x16x64_bf16 v[40:43], v[20:23], a[200:207], v15
  s_nop 0
  v_smfmac_f32_16x16x64_bf16 v[44:47], v[16:19], a[208:215], v15
  v_add_f32 v24, v24, v26
  v_add_f32 v25, v25, v27
  v_cvt_pk_bf16_f32 v24, v24, v25
  v_smfmac_f32_16x16x64_bf16 v[44:47], v[20:23], a[216:223], v15
  v_add_f32 v28, v28, v30
  v_add_f32 v29, v29, v31
  v_cvt_pk_bf16_f32 v25, v28, v29
  v_smfmac_f32_16x16x64_bf16 v[48:51], v[16:19], a[224:231], v15
  v_add_f32 v32, v32, v34
  v_add_f32 v33, v33, v35
  v_cvt_pk_bf16_f32 v26, v32, v33
  v_smfmac_f32_16x16x64_bf16 v[52:55], v[16:19], a[240:247], v15
  v_add_f32 v36, v36, v38
  v_add_f32 v37, v37, v39
  v_cvt_pk_bf16_f32 v27, v36, v37
  v_or_b32 v24, 1, v24
  s_waitcnt lgkmcnt(0)
  v_smfmac_f32_16x16x64_bf16 v[48:51], v[20:23], v[56:63], v15
  buffer_store_dwordx4 v[24:27], v12, s[4:7], s18 offen
  v_smfmac_f32_16x16x64_bf16 v[52:55], v[20:23], v[64:71], v15
  v_add_f32 v40, v40, v42
  v_add_f32 v41, v41, v43
  v_cvt_pk_bf16_f32 v40, v40, v41
  v_or_b32 v40, 1, v40
  v_add_f32 v44, v44, v46
  v_add_f32 v45, v45, v47
  v_cvt_pk_bf16_f32 v41, v44, v45
  v_pk_add_f32 v[48:49], v[48:49], v[50:51]
  v_cvt_pk_bf16_f32 v42, v48, v49
  v_pk_add_f32 v[52:53], v[52:53], v[54:55]
  v_cvt_pk_bf16_f32 v43, v52, v53
  buffer_store_dwordx4 v[40:43], v12, s[4:7], s19 offen
L_F_offpv1:
  v_lshrrev_b32 v51, 2, v1
  v_xor_b32 v48, 0x800, v1
  v_xor_b32 v49, 0x1000, v1
  v_xor_b32 v50, 0x1800, v1
  ds_read_b128 v[24:27], v48 offset:57344
  ds_read_b128 v[28:31], v48 offset:58368
  v_xor_b32 v52, 0x200, v51
  ds_read2st64_b32 v[52:53], v52 offset0:56 offset1:57
  ds_read_b128 v[32:35], v49 offset:57344
  ds_read_b128 v[36:39], v49 offset:58368
  v_xor_b32 v54, 0x400, v51
  ds_read2st64_b32 v[54:55], v54 offset0:56 offset1:57
  v_mov_b32 v92, 0x3f80
  v_mov_b32 v93, 0x3f800000
  v_cndmask_b32 v92, 0, v92, s[44:45]
  v_cndmask_b32 v92, v92, v93, s[46:47]
  v_cndmask_b32 v88, 0, v92, s[36:37]
  v_cndmask_b32 v89, 0, v92, s[38:39]
  v_cndmask_b32 v90, 0, v92, s[40:41]
  v_cndmask_b32 v91, 0, v92, s[42:43]
  s_waitcnt lgkmcnt(3)
  v_mfma_f32_16x16x32_bf16 v[40:43], v[24:27], v[72:75], 0
  v_mfma_f32_16x16x32_bf16 v[44:47], v[28:31], v[72:75], 0
  v_mfma_f32_16x16x16_bf16 v[40:43], v[52:53], v[76:77], v[40:43]
  v_mfma_f32_16x16x16_bf16 v[44:47], v[52:53], v[78:79], v[44:47]
  ds_read_b128 v[24:27], v50 offset:57344
  ds_read_b128 v[28:31], v50 offset:58368
  v_xor_b32 v52, 0x600, v51
  ds_read2st64_b32 v[52:53], v52 offset0:56 offset1:57
  s_waitcnt lgkmcnt(3)
  v_mfma_f32_16x16x32_bf16 v[16:19], v[32:35], v[72:75], 0
  v_mfma_f32_16x16x32_bf16 v[20:23], v[36:39], v[72:75], 0
  v_mfma_f32_16x16x16_bf16 v[16:19], v[54:55], v[76:77], v[16:19]
  v_mfma_f32_16x16x16_bf16 v[20:23], v[54:55], v[78:79], v[20:23]
  s_cmp_eq_u32 s14, 63
  s_cbranch_scc1 L_F_np01
  buffer_load_dwordx4 v[56:59], v0, s[4:7], s20 offen sc1
  buffer_load_dwordx4 v[60:63], v0, s[4:7], s21 offen sc1
L_F_np01:
  v_cndmask_b32 v51, 0, 1, s[2:3]
  s_waitcnt lgkmcnt(0)
  v_mfma_f32_16x16x32_bf16 v[32:35], v[24:27], v[72:75], 0
  v_mfma_f32_16x16x32_bf16 v[36:39], v[28:31], v[72:75], 0
  v_mfma_f32_16x16x16_bf16 v[32:35], v[52:53], v[76:77], v[32:35]
  v_mfma_f32_16x16x16_bf16 v[36:39], v[52:53], v[78:79], v[36:39]
  s_cmp_eq_u32 s14, 63
  s_cbranch_scc1 L_F_np11
  buffer_load_dwordx4 v[64:67], v0, s[4:7], s20 offen sc1
  buffer_load_dwordx4 v[68:71], v0, s[4:7], s21 offen sc1
L_F_np11:
  s_cmp_eq_u32 s14, 63
  s_cbranch_scc1 L_F_w21
L_F_red1:
  s_waitcnt vmcnt(2)
  v_mfma_f32_16x16x32_bf16 v[92:95], v[88:91], v[56:59], 0
  v_mfma_f32_16x16x32_bf16 v[92:95], v[88:91], v[60:63], v[92:95]
  v_bitop3_b32 v6, v56, v60, 1 bitop3:0x2a
  v_cmp_ne_u32 vcc, 0, v6
  s_cbranch_vccnz L_F_f1x1
L_F_tail1:
  s_nop 4
  v_add_f32_dpp v92, v92, v92 row_ror:4 row_mask:0xf bank_mask:0xf
  v_add_f32_dpp v93, v93, v93 row_ror:4 row_mask:0xf bank_mask:0xf
  v_add_f32_dpp v94, v94, v94 row_ror:4 row_mask:0xf bank_mask:0xf
  v_add_f32_dpp v95, v95, v95 row_ror:4 row_mask:0xf bank_mask:0xf
  v_add_f32_dpp v92, v92, v92 row_ror:8 row_mask:0xf bank_mask:0xf
  v_add_f32_dpp v93, v93, v93 row_ror:8 row_mask:0xf bank_mask:0xf
  v_add_f32_dpp v94, v94, v94 row_ror:8 row_mask:0xf bank_mask:0xf
  v_add_f32_dpp v95, v95, v95 row_ror:8 row_mask:0xf bank_mask:0xf
  v_cvt_pk_bf16_f32 v92, v92, v93
  v_cvt_pk_bf16_f32 v93, v94, v95
  v_or_b32 v92, v51, v92
  buffer_store_dwordx2 v[92:93], v13, s[4:7], s17 offen
L_F_w21:
  v_pk_mul_f32 v[40:41], v[40:41], v[84:85] op_sel_hi:[1,0]
  v_pk_mul_f32 v[42:43], v[42:43], v[84:85] op_sel_hi:[1,0]
  v_pk_mul_f32 v[44:45], v[44:45], v[84:85] op_sel_hi:[1,0]
  v_pk_mul_f32 v[46:47], v[46:47], v[84:85] op_sel_hi:[1,0]
  v_cvt_pk_bf16_f32 v40, v40, v41
  v_cvt_pk_bf16_f32 v41, v42, v43
  v_cvt_pk_bf16_f32 v42, v44, v45
  v_cvt_pk_bf16_f32 v43, v46, v47
  v_pk_mul_f32 v[16:17], v[16:17], v[84:85] op_sel_hi:[1,0]
  v_pk_mul_f32 v[18:19], v[18:19], v[84:85] op_sel_hi:[1,0]
  v_pk_mul_f32 v[20:21], v[20:21], v[84:85] op_sel_hi:[1,0]
  v_pk_mul_f32 v[22:23], v[22:23], v[84:85] op_sel_hi:[1,0]
  v_cvt_pk_bf16_f32 v16, v16, v17
  v_cvt_pk_bf16_f32 v17, v18, v19
  v_cvt_pk_bf16_f32 v18, v20, v21
  v_cvt_pk_bf16_f32 v19, v22, v23
  v_mov_b32_dpp v80, v40 row_ror:8 row_mask:0xf bank_mask:0x3
  v_mov_b32_dpp v81, v41 row_ror:8 row_mask:0xf bank_mask:0x3
  v_mov_b32_dpp v82, v42 row_ror:8 row_mask:0xf bank_mask:0x3
  v_mov_b32_dpp v83, v43 row_ror:8 row_mask:0xf bank_mask:0x3
  v_pk_mul_f32 v[32:33], v[32:33], v[84:85] op_sel_hi:[1,0]
  v_pk_mul_f32 v[34:35], v[34:35], v[84:85] op_sel_hi:[1,0]
  v_pk_mul_f32 v[36:37], v[36:37], v[84:85] op_sel_hi:[1,0]
  v_pk_mul_f32 v[38:39], v[38:39], v[84:85] op_sel_hi:[1,0]
  v_cvt_pk_bf16_f32 v32, v32, v33
  v_cvt_pk_bf16_f32 v33, v34, v35
  v_cvt_pk_bf16_f32 v34, v36, v37
  v_cvt_pk_bf16_f32 v35, v38, v39
  v_mov_b32 v88, 0
  v_mov_b32 v89, 0
  v_mov_b32 v90, 0
  v_mov_b32 v91, 0
  v_mov_b32 v92, 0
  v_mov_b32 v93, 0
  v_mov_b32 v94, 0
  v_mov_b32 v95, 0
  s_mov_b64 exec, s[32:33]
  v_xor_b32 v5, 0xe000, v5
  s_mov_b64 exec, -1
  s_cmp_eq_u32 s14, 63
  s_cbranch_scc1 L_F_nx21
  buffer_load_dwordx4 v[24:27], v0, s[4:7], s16 offen sc1
  buffer_load_dwordx4 v[28:31], v0, s[4:7], s16 offen offset:1024 sc1
L_F_nx21:
  v_mov_b32 v20, v80
  v_mov_b32 v21, v81
  v_mov_b32 v22, v82
  v_mov_b32 v23, v83
  v_mov_b32_dpp v16, v32 row_ror:8 row_mask:0xf bank_mask:0x3
  v_mov_b32_dpp v17, v33 row_ror:8 row_mask:0xf bank_mask:0x3
  v_mov_b32_dpp v18, v34 row_ror:8 row_mask:0xf bank_mask:0x3
  v_mov_b32_dpp v19, v35 row_ror:8 row_mask:0xf bank_mask:0x3
  s_cmp_eq_u32 s14, 63
  s_cbranch_scc1 L_F_last
  v_mov_b32 v72, 0
  v_mov_b32 v73, 0
  v_mov_b32 v74, 0
  v_mov_b32 v75, 0
  v_mov_b32 v76, 0
  v_mov_b32 v77, 0
  v_mov_b32 v78, 0
  v_mov_b32 v79, 0
  v_mov_b32 v80, 0
  v_mov_b32 v81, 0
  v_mov_b32 v82, 0
  v_mov_b32 v83, 0
  v_mov_b32 v84, 0
  v_mov_b32 v85, 0
  v_mov_b32 v86, 0
  v_mov_b32 v87, 0
  ds_read_b128 v[32:35], v4 offset:0
  ds_read_b128 v[36:39], v4 offset:1024
  ds_read_b128 v[40:43], v4 offset:2048
  ds_read_b128 v[44:47], v4 offset:3072
  ds_read_b128 v[48:51], v4 offset:4096
  ds_read_b128 v[52:55], v4 offset:5120
  buffer_load_dwordx4 v[64:67], v0, s[4:7], s16 offen sc1
  buffer_load_dwordx4 v[68:71], v0, s[4:7], s16 offen offset:1024 sc1
  s_add_u32 s14, s14, 1
  s_cmp_lg_u32 s97, 0
  s_cbranch_scc1 L_F_xq1
L_F_xok1:
  s_waitcnt vmcnt(2)
L_F_fpd1:
  ds_read_b128 v[56:59], v4 offset:6144
  ds_read_b128 v[60:63], v4 offset:7168
  s_branch L_F_chk0
L_F_last:
  buffer_store_dwordx4 v[20:23], v14, s[4:7], s24 offen sc1
  v_xor_b32 v6, 1024, v14
  buffer_store_dwordx4 v[16:19], v6, s[4:7], s24 offen sc1
  s_mov_b32 s24, s79
  s_add_u32 s79, s79, 8192
  s_waitcnt vmcnt(0)
  s_barrier
  s_cmp_lg_u32 s13, 0
  s_cbranch_scc1 L_recend
  v_mov_b32 v11, 64
  s_mov_b64 exec, 1
  buffer_store_dword v11, off, s[4:7], s59 sc1
  s_branch L_recend
L_S_f2x0:
  buffer_load_dwordx4 v[24:27], v0, s[4:7], s16 offen sc1
  buffer_load_dwordx4 v[28:31], v0, s[4:7], s16 offen offset:1024 sc1
  s_waitcnt vmcnt(2)
  v_bitop3_b32 v6, v64, v68, 1 bitop3:0x2a
  v_cmp_ne_u32 vcc, 0, v6
  s_cbranch_vccz L_S_ownY0
  s_add_u32 s15, s15, 1
  s_cmp_ge_u32 s15, 0x80000
  s_cbranch_scc1 L_S_ownY0
  buffer_load_dwordx4 v[64:67], v0, s[4:7], s16 offen sc1
  buffer_load_dwordx4 v[68:71], v0, s[4:7], s16 offen offset:1024 sc1
  s_waitcnt vmcnt(2)
  s_branch L_S_chk0
L_S_ownY0:
  s_add_u32 s98, s98, 1
  s_waitcnt lgkmcnt(2)
  v_smfmac_f32_16x16x64_bf16 v[88:91], v[64:67], v[32:39], v15
  ds_write_b64 v1, v[64:65] offset:0
  v_smfmac_f32_16x16x64_bf16 v[92:95], v[64:67], v[40:47], v15
  ds_write_b64 v1, v[66:67] offset:8
  v_smfmac_f32_16x16x64_bf16 v[88:91], v[68:71], v[48:55], v15
  ds_write_b64 v1, v[68:69] offset:1024
  v_smfmac_f32_16x16x64_bf16 v[72:75], v[64:67], v[96:103], v15
  ds_write_b64 v1, v[70:71] offset:1032
  v_smfmac_f32_16x16x64_bf16 v[76:79], v[64:67], v[104:111], v15
  v_xor_b32 v39, 0x800, v1
  v_smfmac_f32_16x16x64_bf16 v[72:75], v[68:71], v[112:119], v15
  v_xor_b32 v47, 0x1000, v1
  v_smfmac_f32_16x16x64_bf16 v[76:79], v[68:71], v[120:127], v15
  v_xor_b32 v55, 0x1800, v1
  v_smfmac_f32_16x16x64_bf16 v[80:83], v[64:67], a[0:7], v15
  s_waitcnt lgkmcnt(0)
  s_barrier
  ds_read_b128 v[32:35], v39 offset:0
  ds_read_b128 v[36:39], v39 offset:1024
  v_smfmac_f32_16x16x64_bf16 v[84:87], v[64:67], a[8:15], v15
  s_mov_b32 m0, s23
  s_nop 0
  buffer_load_dwordx4 v0, s[4:7], s22 offen offset:0 sc1 lds
  ds_read_b128 v[40:43], v47 offset:0
  ds_read_b128 v[44:47], v47 offset:1024
  v_smfmac_f32_16x16x64_bf16 v[80:83], v[68:71], a[16:23], v15
  ds_read_b128 v[48:51], v55 offset:0
  ds_read_b128 v[52:55], v55 offset:1024
  v_smfmac_f32_16x16x64_bf16 v[84:87], v[68:71], a[24:31], v15
  v_smfmac_f32_16x16x64_bf16 v[92:95], v[68:71], v[56:63], v15
  buffer_load_dwordx4 v0, s[4:7], s22 offen offset:1024 sc1 lds
  s_branch L_S_rest0
L_S_fp0:
  s_sub_u32 s27, s14, 1
  s_mov_b64 exec, 1
  v_mov_b32 v6, s27
  buffer_store_dword v6, off, s[4:7], s59 sc1
  s_mov_b64 exec, -1
  s_branch L_S_fpr0
L_S_fl0:
  s_mov_b64 exec, 0x3f
  buffer_load_dword v11, v0, s[4:7], s58 offen sc1
  s_mov_b64 exec, -1
  s_branch L_S_flr0
L_S_xq0:
  s_add_u32 s27, s14, 2
  s_min_u32 s27, s27, 64
  v_cmp_gt_u32 vcc, 64, v11
  s_and_b32 s97, vcc_lo, 0x15
  v_cmp_gt_u32 vcc, s27, v11
  s_and_b32 vcc_lo, vcc_lo, 0x15
  s_cbranch_scc0 L_S_xok0
  s_mov_b64 exec, 0x3f
  buffer_load_dword v11, v0, s[4:7], s58 offen sc1
  s_mov_b64 exec, -1
  s_waitcnt vmcnt(0)
  s_add_u32 s15, s15, 1
  s_cmp_lt_u32 s15, 0x80000
  s_cbranch_scc1 L_S_xq0
  s_branch L_S_xok0
L_S_f1x0:
  s_add_u32 s99, s99, 1
  buffer_load_dwordx4 v[56:59], v0, s[4:7], s20 offen sc1
  buffer_load_dwordx4 v[60:63], v0, s[4:7], s21 offen sc1
  s_waitcnt vmcnt(2)
  v_mfma_f32_16x16x32_bf16 v[92:95], v[88:91], v[64:67], 0
  v_mfma_f32_16x16x32_bf16 v[92:95], v[88:91], v[68:71], v[92:95]
  v_bitop3_b32 v6, v64, v68, 1 bitop3:0xa8
  v_cmp_ne_u32 vcc, 0, v6
  s_cbranch_vccz L_S_tail0
  s_add_u32 s15, s15, 1
  s_cmp_ge_u32 s15, 0x80000
  s_cbranch_scc1 L_S_tail0
  buffer_load_dwordx4 v[64:67], v0, s[4:7], s20 offen sc1
  buffer_load_dwordx4 v[68:71], v0, s[4:7], s21 offen sc1
  s_branch L_S_red0
L_S_f2x1:
  buffer_load_dwordx4 v[24:27], v0, s[4:7], s16 offen sc1
  buffer_load_dwordx4 v[28:31], v0, s[4:7], s16 offen offset:1024 sc1
  s_waitcnt vmcnt(2)
  v_bitop3_b32 v6, v64, v68, 1 bitop3:0xa8
  v_cmp_ne_u32 vcc, 0, v6
  s_cbranch_vccz L_S_ownY1
  s_add_u32 s15, s15, 1
  s_cmp_ge_u32 s15, 0x80000
  s_cbranch_scc1 L_S_ownY1
  buffer_load_dwordx4 v[64:67], v0, s[4:7], s16 offen sc1
  buffer_load_dwordx4 v[68:71], v0, s[4:7], s16 offen offset:1024 sc1
  s_waitcnt vmcnt(2)
  s_branch L_S_chk1
L_S_ownY1:
  s_add_u32 s98, s98, 1
  s_waitcnt lgkmcnt(2)
  v_smfmac_f32_16x16x64_bf16 v[88:91], v[64:67], v[32:39], v15
  ds_write_b64 v1, v[64:65] offset:0
  v_smfmac_f32_16x16x64_bf16 v[92:95], v[64:67], v[40:47], v15
  ds_write_b64 v1, v[66:67] offset:8
  v_smfmac_f32_16x16x64_bf16 v[88:91], v[68:71], v[48:55], v15
  ds_write_b64 v1, v[68:69] offset:1024
  v_smfmac_f32_16x16x64_bf16 v[72:75], v[64:67], v[96:103], v15
  ds_write_b64 v1, v[70:71] offset:1032
  v_smfmac_f32_16x16x64_bf16 v[76:79], v[64:67], v[104:111], v15
  v_xor_b32 v39, 0x800, v1
  v_smfmac_f32_16x16x64_bf16 v[72:75], v[68:71], v[112:119], v15
  v_xor_b32 v47, 0x1000, v1
  v_smfmac_f32_16x16x64_bf16 v[76:79], v[68:71], v[120:127], v15
  v_xor_b32 v55, 0x1800, v1
  v_smfmac_f32_16x16x64_bf16 v[80:83], v[64:67], a[0:7], v15
  s_waitcnt lgkmcnt(0)
  s_barrier
  ds_read_b128 v[32:35], v39 offset:0
  ds_read_b128 v[36:39], v39 offset:1024
  v_smfmac_f32_16x16x64_bf16 v[84:87], v[64:67], a[8:15], v15
  s_mov_b32 m0, s23
  s_nop 0
  buffer_load_dwordx4 v0, s[4:7], s22 offen offset:0 sc1 lds
  ds_read_b128 v[40:43], v47 offset:0
  ds_read_b128 v[44:47], v47 offset:1024
  v_smfmac_f32_16x16x64_bf16 v[80:83], v[68:71], a[16:23], v15
  ds_read_b128 v[48:51], v55 offset:0
  ds_read_b128 v[52:55], v55 offset:1024
  v_smfmac_f32_16x16x64_bf16 v[84:87], v[68:71], a[24:31], v15
  v_smfmac_f32_16x16x64_bf16 v[92:95], v[68:71], v[56:63], v15
  buffer_load_dwordx4 v0, s[4:7], s22 offen offset:1024 sc1 lds
  s_branch L_S_rest1
L_S_fp1:
  s_sub_u32 s27, s14, 1
  s_mov_b64 exec, 1
  v_mov_b32 v6, s27
  buffer_store_dword v6, off, s[4:7], s59 sc1
  s_mov_b64 exec, -1
  s_branch L_S_fpr1
L_S_fl1:
  s_mov_b64 exec, 0x3f
  buffer_load_dword v11, v0, s[4:7], s58 offen sc1
  s_mov_b64 exec, -1
  s_branch L_S_flr1
L_S_xq1:
  s_add_u32 s27, s14, 2
  s_min_u32 s27, s27, 64
  v_cmp_gt_u32 vcc, 64, v11
  s_and_b32 s97, vcc_lo, 0x15
  v_cmp_gt_u32 vcc, s27, v11
  s_and_b32 vcc_lo, vcc_lo, 0x15
  s_cbranch_scc0 L_S_xok1
  s_mov_b64 exec, 0x3f
  buffer_load_dword v11, v0, s[4:7], s58 offen sc1
  s_mov_b64 exec, -1
  s_waitcnt vmcnt(0)
  s_add_u32 s15, s15, 1
  s_cmp_lt_u32 s15, 0x80000
  s_cbranch_scc1 L_S_xq1
  s_branch L_S_xok1
L_S_x01:
  s_waitcnt vmcnt(7)
  s_branch L_S_x0r1
L_S_f1x1:
  s_add_u32 s99, s99, 1
  buffer_load_dwordx4 v[56:59], v0, s[4:7], s20 offen sc1
  buffer_load_dwordx4 v[60:63], v0, s[4:7], s21 offen sc1
  s_waitcnt vmcnt(2)
  v_mfma_f32_16x16x32_bf16 v[92:95], v[88:91], v[64:67], 0
  v_mfma_f32_16x16x32_bf16 v[92:95], v[88:91], v[68:71], v[92:95]
  v_bitop3_b32 v6, v64, v68, 1 bitop3:0x2a
  v_cmp_ne_u32 vcc, 0, v6
  s_cbranch_vccz L_S_tail1
  s_add_u32 s15, s15, 1
  s_cmp_ge_u32 s15, 0x80000
  s_cbranch_scc1 L_S_tail1
  buffer_load_dwordx4 v[64:67], v0, s[4:7], s20 offen sc1
  buffer_load_dwordx4 v[68:71], v0, s[4:7], s21 offen sc1
  s_branch L_S_red1
.p2align 6
L_S_chk0:
  v_bitop3_b32 v6, v24, v28, 1 bitop3:0x2a
  v_cmp_ne_u32 vcc, 0, v6
  s_cbranch_vccnz L_S_f2x0
L_S_have0:
  s_waitcnt lgkmcnt(2)
  v_smfmac_f32_16x16x64_bf16 v[88:91], v[24:27], v[32:39], v15
  ds_write_b64 v1, v[24:25] offset:0
  v_smfmac_f32_16x16x64_bf16 v[92:95], v[24:27], v[40:47], v15
  ds_write_b64 v1, v[26:27] offset:8
  v_smfmac_f32_16x16x64_bf16 v[88:91], v[28:31], v[48:55], v15
  ds_write_b64 v1, v[28:29] offset:1024
  v_smfmac_f32_16x16x64_bf16 v[72:75], v[24:27], v[96:103], v15
  ds_write_b64 v1, v[30:31] offset:1032
  v_smfmac_f32_16x16x64_bf16 v[76:79], v[24:27], v[104:111], v15
  v_xor_b32 v39, 0x800, v1
  v_smfmac_f32_16x16x64_bf16 v[72:75], v[28:31], v[112:119], v15
  v_xor_b32 v47, 0x1000, v1
  v_smfmac_f32_16x16x64_bf16 v[76:79], v[28:31], v[120:127], v15
  v_xor_b32 v55, 0x1800, v1
  v_smfmac_f32_16x16x64_bf16 v[80:83], v[24:27], a[0:7], v15
  s_waitcnt lgkmcnt(0)
  s_barrier
  ds_read_b128 v[32:35], v39 offset:0
  ds_read_b128 v[36:39], v39 offset:1024
  v_smfmac_f32_16x16x64_bf16 v[84:87], v[24:27], a[8:15], v15
  s_mov_b32 m0, s23
  s_nop 0
  buffer_load_dwordx4 v0, s[4:7], s22 offen offset:0 sc1 lds
  ds_read_b128 v[40:43], v47 offset:0
  ds_read_b128 v[44:47], v47 offset:1024
  v_smfmac_f32_16x16x64_bf16 v[80:83], v[28:31], a[16:23], v15
  ds_read_b128 v[48:51], v55 offset:0
  ds_read_b128 v[52:55], v55 offset:1024
  v_smfmac_f32_16x16x64_bf16 v[84:87], v[28:31], a[24:31], v15
  v_smfmac_f32_16x16x64_bf16 v[92:95], v[28:31], v[56:63], v15
  buffer_load_dwordx4 v0, s[4:7], s22 offen offset:1024 sc1 lds
L_S_rest0:
  s_waitcnt lgkmcnt(5)
  v_smfmac_f32_16x16x64_bf16 v[72:75], v[32:35], v[128:135], v15
  v_smfmac_f32_16x16x64_bf16 v[76:79], v[32:35], v[136:143], v15
  s_waitcnt lgkmcnt(4)
  v_smfmac_f32_16x16x64_bf16 v[72:75], v[36:39], v[144:151], v15
  buffer_load_dwordx4 v0, s[4:7], s22 offen offset:2048 sc1 lds
  v_smfmac_f32_16x16x64_bf16 v[76:79], v[36:39], v[152:159], v15
  s_waitcnt lgkmcnt(3)
  v_smfmac_f32_16x16x64_bf16 v[72:75], v[40:43], v[160:167], v15
  ds_read_b128 v[56:59], v4 offset:8192
  v_smfmac_f32_16x16x64_bf16 v[76:79], v[40:43], v[168:175], v15
  buffer_load_dwordx4 v0, s[4:7], s22 offen offset:3072 sc1 lds
  s_waitcnt vmcnt(4)
  s_bitcmp1_b64 s[82:83], s14
  s_cbranch_scc1 L_S_fp0
L_S_fpr0:
  s_cmp_lg_u32 s97, 0
  s_cbranch_scc1 L_S_fl0
L_S_flr0:
  ds_read_b128 v[60:63], v4 offset:9216
  s_waitcnt lgkmcnt(4)
  v_smfmac_f32_16x16x64_bf16 v[72:75], v[44:47], v[176:183], v15
  ds_read_b128 v[24:27], v4 offset:10240
  v_smfmac_f32_16x16x64_bf16 v[76:79], v[44:47], v[184:191], v15
  buffer_store_dwordx4 v[20:23], v14, s[4:7], s24 offen sc1
  ds_read_b128 v[28:31], v4 offset:11264
  s_waitcnt lgkmcnt(5)
  v_smfmac_f32_16x16x64_bf16 v[72:75], v[48:51], v[192:199], v15
  ds_read_b128 v[64:67], v4 offset:12288
  v_smfmac_f32_16x16x64_bf16 v[76:79], v[48:51], v[200:207], v15
  ds_read_b128 v[68:71], v4 offset:13312
  s_waitcnt lgkmcnt(6)
  v_smfmac_f32_16x16x64_bf16 v[72:75], v[52:55], v[208:215], v15
  v_xor_b32 v6, 1024, v14
  buffer_store_dwordx4 v[16:19], v6, s[4:7], s24 offen sc1
  s_mov_b32 s24, s79
  s_add_u32 s79, s79, 8192
  ds_read_b128 v[16:19], v4 offset:14336
  v_smfmac_f32_16x16x64_bf16 v[76:79], v[52:55], v[216:223], v15
  ds_read_b128 v[20:23], v4 offset:15360
  v_smfmac_f32_16x16x64_bf16 v[80:83], v[40:43], a[64:71], v15
  s_nop 1
  v_smfmac_f32_16x16x64_bf16 v[84:87], v[40:43], a[72:79], v15
  s_add_u32 m0, s23, 4096
  s_add_u32 s26, s22, 4096
  buffer_load_dwordx4 v0, s[4:7], s26 offen offset:0 sc1 lds
  s_nop 1
  v_smfmac_f32_16x16x64_bf16 v[80:83], v[44:47], a[80:87], v15
  s_nop 1
  v_smfmac_f32_16x16x64_bf16 v[84:87], v[44:47], a[88:95], v15
  v_add_f32 v72, v72, v74
  v_add_f32 v73, v73, v75
  v_add_f32 v76, v76, v78
  v_add_f32 v77, v77, v79
  v_smfmac_f32_16x16x64_bf16 v[80:83], v[48:51], a[96:103], v15
  v_cvt_pk_bf16_f32 v72, v72, v73
  v_cvt_pk_bf16_f32 v76, v76, v77
  ds_write2st64_b32 v8, v72, v76 offset0:0 offset1:1
  v_smfmac_f32_16x16x64_bf16 v[84:87], v[48:51], a[104:111], v15
  buffer_load_dwordx4 v0, s[4:7], s26 offen offset:1024 sc1 lds
  s_add_u32 s22, s22, 24576
  s_sub_u32 s23, s25, s23
  v_smfmac_f32_16x16x64_bf16 v[80:83], v[52:55], a[112:119], v15
  ds_read_b128 v[72:75], v10 offset:0
  v_smfmac_f32_16x16x64_bf16 v[84:87], v[52:55], a[120:127], v15
  ds_read_b128 v[76:79], v10 offset:16
  v_smfmac_f32_16x16x64_bf16 v[80:83], v[32:35], a[32:39], v15
  v_smfmac_f32_16x16x64_bf16 v[84:87], v[32:35], a[40:47], v15
  v_smfmac_f32_16x16x64_bf16 v[80:83], v[36:39], a[48:55], v15
  s_waitcnt lgkmcnt(2)
  s_barrier
  v_smfmac_f32_16x16x64_bf16 v[84:87], v[36:39], a[56:63], v15
  v_smfmac_f32_16x16x64_bf16 v[88:91], v[40:43], v[56:63], v15
  s_nop 2
  v_smfmac_f32_16x16x64_bf16 v[92:95], v[40:43], v[24:31], v15
  s_nop 0
  v_add_f32 v80, v80, v82
  v_add_f32 v81, v81, v83
  v_smfmac_f32_16x16x64_bf16 v[88:91], v[44:47], v[64:71], v15
  v_add_f32 v84, v84, v86
  v_add_f32 v85, v85, v87
  v_cvt_pk_bf16_f32 v86, v80, v81
  v_cvt_pk_bf16_f32 v87, v84, v85
  ds_write2st64_b32 v9, v86, v87 offset0:0 offset1:1
  ds_read_b128 v[56:59], v0 offset:24576
  v_smfmac_f32_16x16x64_bf16 v[92:95], v[44:47], v[16:23], v15
  ds_read_b128 v[60:63], v0 offset:25600
  v_smfmac_f32_16x16x64_bf16 v[88:91], v[48:51], a[128:135], v15
  ds_read_b64_tr_b16 v[40:41], v5 offset:0
  ds_read_b64_tr_b16 v[42:43], v5 offset:64
  v_smfmac_f32_16x16x64_bf16 v[92:95], v[48:51], a[144:151], v15
  ds_read_b128 v[24:27], v0 offset:26624
  v_smfmac_f32_16x16x64_bf16 v[88:91], v[52:55], a[232:239], v15
  ds_read_b64_tr_b16 v[44:45], v5 offset:512
  ds_read_b64_tr_b16 v[46:47], v5 offset:576
  v_smfmac_f32_16x16x64_bf16 v[92:95], v[52:55], a[248:255], v15
  ds_read_b128 v[28:31], v0 offset:27648
  s_waitcnt lgkmcnt(8)
  s_barrier
  v_smfmac_f32_16x16x64_bf16 v[88:91], v[32:35], v[224:231], v15
  ds_read_b64_tr_b16 v[48:49], v5 offset:1024
  ds_read_b64_tr_b16 v[50:51], v5 offset:1088
  v_smfmac_f32_16x16x64_bf16 v[92:95], v[32:35], v[232:239], v15
  ds_read_b128 v[64:67], v0 offset:28672
  v_smfmac_f32_16x16x64_bf16 v[88:91], v[36:39], v[240:247], v15
  ds_read_b128 v[68:71], v0 offset:29696
  v_smfmac_f32_16x16x64_bf16 v[92:95], v[36:39], v[248:255], v15
  ds_read_b64_tr_b16 v[52:53], v5 offset:1536
  ds_read_b64_tr_b16 v[54:55], v5 offset:1600
  v_mfma_f32_16x16x16_bf16 v[80:83], v[2:3], v[2:3], 0
  ds_read_b128 v[16:19], v0 offset:30720
  s_waitcnt lgkmcnt(7)
  v_mfma_f32_16x16x32_bf16 v[72:75], v[56:59], v[40:43], v[72:75]
  ds_read_b128 v[20:23], v0 offset:31744
  v_mfma_f32_16x16x32_bf16 v[76:79], v[60:63], v[40:43], v[76:79]
  ds_read_b64_tr_b16 v[32:33], v7 offset:0
  ds_read_b64_tr_b16 v[34:35], v7 offset:128
  v_mfma_f32_16x16x32_bf16 v[72:75], v[24:27], v[44:47], v[72:75]
  ds_read_b64_tr_b16 v[36:37], v7 offset:1024
  ds_read_b64_tr_b16 v[38:39], v7 offset:1152
  v_mfma_f32_16x16x32_bf16 v[76:79], v[28:31], v[44:47], v[76:79]
  ds_read_b128 v[56:59], v1 offset:32768
  s_waitcnt lgkmcnt(9)
  v_mfma_f32_16x16x32_bf16 v[72:75], v[64:67], v[48:51], v[72:75]
  ds_read_b128 v[60:63], v1 offset:33792
  v_mfma_f32_16x16x32_bf16 v[76:79], v[68:71], v[48:51], v[76:79]
  s_waitcnt lgkmcnt(6)
  v_mfma_f32_16x16x32_bf16 v[72:75], v[16:19], v[52:55], v[72:75]
  ds_read_b128 v[64:67], v4 offset:18432
  v_mfma_f32_16x16x32_bf16 v[76:79], v[20:23], v[52:55], v[76:79]
  ds_read_b128 v[68:71], v4 offset:19456
  s_waitcnt lgkmcnt(4)
  v_smfmac_f32_16x16x64_bf16 v[80:83], v[32:35], v[40:47], v15
  v_smfmac_f32_16x16x64_bf16 v[80:83], v[36:39], v[48:55], v15
  v_mfma_f32_32x32x8_bf16 v[24:39], v[2:3], v[2:3], 0
  v_add_f32 v88, v88, v90
  v_add_f32 v89, v89, v91
  v_add_f32 v92, v92, v94
  v_add_f32 v93, v93, v95
  v_max3_f32 v84, v72, v73, v74
  v_max3_f32 v85, v75, v76, v77
  v_max3_f32 v84, v84, v78, v79
  v_add_f32 v80, v80, v82
  v_add_f32 v81, v81, v83
  v_max3_f32 v84, v84, v85, v80
  v_max_f32 v84, v84, v81
  v_mov_b32 v85, v84
  v_mfma_f32_32x32x8_bf16 v[40:55], v[2:3], v[2:3], 0
  v_cvt_pk_bf16_f32 v88, v88, v89
  v_permlane16_swap_b32 v85, v84
  v_max_f32 v84, v84, v85
  v_mov_b32 v85, v84
  v_cvt_pk_bf16_f32 v89, v92, v93
  v_lshrrev_b32 v90, 2, v1
  v_permlane32_swap_b32 v85, v84
  ds_write2st64_b32 v90, v88, v89 offset0:56 offset1:57
  v_max_f32 v84, v84, v85
  v_mul_f32 v86, s34, v84
  v_pk_fma_f32 v[72:73], v[72:73], s[34:35], v[86:87] op_sel_hi:[1,1,0] neg_lo:[0,0,1] neg_hi:[0,0,1]
  v_pk_fma_f32 v[74:75], v[74:75], s[34:35], v[86:87] op_sel_hi:[1,1,0] neg_lo:[0,0,1] neg_hi:[0,0,1]
  v_pk_fma_f32 v[76:77], v[76:77], s[34:35], v[86:87] op_sel_hi:[1,1,0] neg_lo:[0,0,1] neg_hi:[0,0,1]
  v_pk_fma_f32 v[78:79], v[78:79], s[34:35], v[86:87] op_sel_hi:[1,1,0] neg_lo:[0,0,1] neg_hi:[0,0,1]
  v_pk_fma_f32 v[80:81], v[80:81], s[34:35], v[86:87] op_sel_hi:[1,1,0] neg_lo:[0,0,1] neg_hi:[0,0,1]
  v_exp_f32 v72, v72
  v_exp_f32 v73, v73
  v_exp_f32 v74, v74
  v_exp_f32 v75, v75
  v_exp_f32 v76, v76
  v_exp_f32 v77, v77
  v_exp_f32 v78, v78
  v_exp_f32 v79, v79
  v_exp_f32 v80, v80
  v_exp_f32 v81, v81
  v_pk_add_f32 v[84:85], v[72:73], v[74:75]
  v_pk_add_f32 v[86:87], v[76:77], v[78:79]
  v_cvt_pk_bf16_f32 v72, v72, v73
  v_cvt_pk_bf16_f32 v73, v74, v75
  v_cvt_pk_bf16_f32 v74, v76, v77
  v_cvt_pk_bf16_f32 v75, v78, v79
  v_pk_add_f32 v[84:85], v[84:85], v[80:81]
  v_cvt_pk_bf16_f32 v76, v80, v81
  v_pk_add_f32 v[84:85], v[84:85], v[86:87]
  s_waitcnt lgkmcnt(1)
  v_mfma_f32_16x16x32_bf16 v[16:19], v[56:59], v[72:75], 0
  v_mov_b32 v77, 0
  v_mov_b32 v78, 0
  v_mfma_f32_16x16x32_bf16 v[20:23], v[60:63], v[72:75], 0
  v_mov_b32 v79, v76
  v_add_f32 v84, v84, v85
  v_mfma_f32_16x16x16_bf16 v[16:19], v[88:89], v[76:77], v[16:19]
  v_mov_b32 v85, v84
  v_mfma_f32_16x16x16_bf16 v[20:23], v[88:89], v[78:79], v[20:23]
  s_nop 0
  v_permlane16_swap_b32 v85, v84
  v_add_f32 v84, v84, v85
  v_mov_b32 v85, v84
  s_nop 1
  v_permlane32_swap_b32 v85, v84
  v_add_f32 v84, v84, v85
  v_rcp_f32 v84, v84
  s_nop 0
  v_pk_mul_f32 v[16:17], v[16:17], v[84:85] op_sel_hi:[1,0]
  v_pk_mul_f32 v[18:19], v[18:19], v[84:85] op_sel_hi:[1,0]
  v_pk_mul_f32 v[20:21], v[20:21], v[84:85] op_sel_hi:[1,0]
  v_pk_mul_f32 v[22:23], v[22:23], v[84:85] op_sel_hi:[1,0]
  v_cvt_pk_bf16_f32 v80, v16, v17
  v_cvt_pk_bf16_f32 v81, v18, v19
  v_cvt_pk_bf16_f32 v82, v20, v21
  v_cvt_pk_bf16_f32 v83, v22, v23
  s_mov_b64 exec, s[30:31]
  ds_write_b128 v14, v[80:83] offset:0
  s_mov_b64 exec, -1
  s_waitcnt lgkmcnt(0)
  s_barrier
  ds_read_b128 v[16:19], v0 offset:0
  ds_read_b128 v[20:23], v0 offset:1024
  ds_read_b128 v[56:59], v4 offset:16384
  ds_read_b128 v[60:63], v4 offset:17408
  s_waitcnt lgkmcnt(3)
  v_smfmac_f32_16x16x64_bf16 v[28:31], v[16:19], v[64:71], v15
  v_smfmac_f32_16x16x64_bf16 v[32:35], v[16:19], a[160:167], v15
  ds_read_b128 v[64:67], v4 offset:22528
  v_smfmac_f32_16x16x64_bf16 v[36:39], v[16:19], a[176:183], v15
  ds_read_b128 v[68:71], v4 offset:23552
  s_waitcnt lgkmcnt(2)
  v_smfmac_f32_16x16x64_bf16 v[24:27], v[16:19], v[56:63], v15
  v_smfmac_f32_16x16x64_bf16 v[24:27], v[20:23], a[136:143], v15
  ds_read_b128 v[56:59], v4 offset:20480
  v_smfmac_f32_16x16x64_bf16 v[28:31], v[20:23], a[152:159], v15
  ds_read_b128 v[60:63], v4 offset:21504
  v_smfmac_f32_16x16x64_bf16 v[32:35], v[20:23], a[168:175], v15
  v_smfmac_f32_16x16x64_bf16 v[36:39], v[20:23], a[184:191], v15
  v_smfmac_f32_16x16x64_bf16 v[40:43], v[16:19], a[192:199], v15
  v_smfmac_f32_16x16x64_bf16 v[40:43], v[20:23], a[200:207], v15
  s_nop 0
  v_smfmac_f32_16x16x64_bf16 v[44:47], v[16:19], a[208:215], v15
  v_add_f32 v24, v24, v26
  v_add_f32 v25, v25, v27
  v_cvt_pk_bf16_f32 v24, v24, v25
  v_smfmac_f32_16x16x64_bf16 v[44:47], v[20:23], a[216:223], v15
  v_add_f32 v28, v28, v30
  v_add_f32 v29, v29, v31
  v_cvt_pk_bf16_f32 v25, v28, v29
  v_smfmac_f32_16x16x64_bf16 v[48:51], v[16:19], a[224:231], v15
  v_add_f32 v32, v32, v34
  v_add_f32 v33, v33, v35
  v_cvt_pk_bf16_f32 v26, v32, v33
  v_smfmac_f32_16x16x64_bf16 v[52:55], v[16:19], a[240:247], v15
  v_add_f32 v36, v36, v38
  v_add_f32 v37, v37, v39
  v_cvt_pk_bf16_f32 v27, v36, v37
  v_and_b32 v24, -2, v24
  s_waitcnt lgkmcnt(0)
  v_smfmac_f32_16x16x64_bf16 v[48:51], v[20:23], v[56:63], v15
  buffer_store_dwordx4 v[24:27], v12, s[4:7], s18 offen sc1
  v_smfmac_f32_16x16x64_bf16 v[52:55], v[20:23], v[64:71], v15
  v_add_f32 v40, v40, v42
  v_add_f32 v41, v41, v43
  v_cvt_pk_bf16_f32 v40, v40, v41
  v_and_b32 v40, -2, v40
  v_add_f32 v44, v44, v46
  v_add_f32 v45, v45, v47
  v_cvt_pk_bf16_f32 v41, v44, v45
  v_pk_add_f32 v[48:49], v[48:49], v[50:51]
  v_cvt_pk_bf16_f32 v42, v48, v49
  v_pk_add_f32 v[52:53], v[52:53], v[54:55]
  v_cvt_pk_bf16_f32 v43, v52, v53
  buffer_store_dwordx4 v[40:43], v12, s[4:7], s19 offen sc1
L_S_offpv0:
  v_lshrrev_b32 v51, 2, v1
  v_xor_b32 v48, 0x800, v1
  v_xor_b32 v49, 0x1000, v1
  v_xor_b32 v50, 0x1800, v1
  ds_read_b128 v[24:27], v48 offset:32768
  ds_read_b128 v[28:31], v48 offset:33792
  v_xor_b32 v52, 0x200, v51
  ds_read2st64_b32 v[52:53], v52 offset0:56 offset1:57
  ds_read_b128 v[32:35], v49 offset:32768
  ds_read_b128 v[36:39], v49 offset:33792
  v_xor_b32 v54, 0x400, v51
  ds_read2st64_b32 v[54:55], v54 offset0:56 offset1:57
  v_mov_b32 v92, 0x3f80
  v_mov_b32 v93, 0x3f800000
  v_cndmask_b32 v92, 0, v92, s[44:45]
  v_cndmask_b32 v92, v92, v93, s[46:47]
  v_cndmask_b32 v88, 0, v92, s[36:37]
  v_cndmask_b32 v89, 0, v92, s[38:39]
  v_cndmask_b32 v90, 0, v92, s[40:41]
  v_cndmask_b32 v91, 0, v92, s[42:43]
  s_waitcnt lgkmcnt(3)
  v_mfma_f32_16x16x32_bf16 v[40:43], v[24:27], v[72:75], 0
  v_mfma_f32_16x16x32_bf16 v[44:47], v[28:31], v[72:75], 0
  v_mfma_f32_16x16x16_bf16 v[40:43], v[52:53], v[76:77], v[40:43]
  v_mfma_f32_16x16x16_bf16 v[44:47], v[52:53], v[78:79], v[44:47]
  ds_read_b128 v[24:27], v50 offset:32768
  ds_read_b128 v[28:31], v50 offset:33792
  v_xor_b32 v52, 0x600, v51
  ds_read2st64_b32 v[52:53], v52 offset0:56 offset1:57
  s_waitcnt lgkmcnt(3)
  v_mfma_f32_16x16x32_bf16 v[16:19], v[32:35], v[72:75], 0
  v_mfma_f32_16x16x32_bf16 v[20:23], v[36:39], v[72:75], 0
  v_mfma_f32_16x16x16_bf16 v[16:19], v[54:55], v[76:77], v[16:19]
  v_mfma_f32_16x16x16_bf16 v[20:23], v[54:55], v[78:79], v[20:23]
  buffer_load_dwordx4 v[56:59], v0, s[4:7], s20 offen sc1
  buffer_load_dwordx4 v[60:63], v0, s[4:7], s21 offen sc1
  v_cndmask_b32 v51, -1, -2, s[2:3]
  s_waitcnt lgkmcnt(0)
  v_mfma_f32_16x16x32_bf16 v[32:35], v[24:27], v[72:75], 0
  v_mfma_f32_16x16x32_bf16 v[36:39], v[28:31], v[72:75], 0
  v_mfma_f32_16x16x16_bf16 v[32:35], v[52:53], v[76:77], v[32:35]
  v_mfma_f32_16x16x16_bf16 v[36:39], v[52:53], v[78:79], v[36:39]
  buffer_load_dwordx4 v[64:67], v0, s[4:7], s20 offen sc1
  buffer_load_dwordx4 v[68:71], v0, s[4:7], s21 offen sc1
L_S_red0:
  s_waitcnt vmcnt(2)
  v_mfma_f32_16x16x32_bf16 v[92:95], v[88:91], v[56:59], 0
  v_mfma_f32_16x16x32_bf16 v[92:95], v[88:91], v[60:63], v[92:95]
  v_bitop3_b32 v6, v56, v60, 1 bitop3:0xa8
  v_cmp_ne_u32 vcc, 0, v6
  s_cbranch_vccnz L_S_f1x0
L_S_tail0:
  s_nop 4
  v_add_f32_dpp v92, v92, v92 row_ror:4 row_mask:0xf bank_mask:0xf
  v_add_f32_dpp v93, v93, v93 row_ror:4 row_mask:0xf bank_mask:0xf
  v_add_f32_dpp v94, v94, v94 row_ror:4 row_mask:0xf bank_mask:0xf
  v_add_f32_dpp v95, v95, v95 row_ror:4 row_mask:0xf bank_mask:0xf
  v_add_f32_dpp v92, v92, v92 row_ror:8 row_mask:0xf bank_mask:0xf
  v_add_f32_dpp v93, v93, v93 row_ror:8 row_mask:0xf bank_mask:0xf
  v_add_f32_dpp v94, v94, v94 row_ror:8 row_mask:0xf bank_mask:0xf
  v_add_f32_dpp v95, v95, v95 row_ror:8 row_mask:0xf bank_mask:0xf
  v_cvt_pk_bf16_f32 v92, v92, v93
  v_cvt_pk_bf16_f32 v93, v94, v95
  v_and_b32 v92, v51, v92
  buffer_store_dwordx2 v[92:93], v13, s[4:7], s17 offen sc1
L_S_w20:
  v_pk_mul_f32 v[40:41], v[40:41], v[84:85] op_sel_hi:[1,0]
  v_pk_mul_f32 v[42:43], v[42:43], v[84:85] op_sel_hi:[1,0]
  v_pk_mul_f32 v[44:45], v[44:45], v[84:85] op_sel_hi:[1,0]
  v_pk_mul_f32 v[46:47], v[46:47], v[84:85] op_sel_hi:[1,0]
  v_cvt_pk_bf16_f32 v40, v40, v41
  v_cvt_pk_bf16_f32 v41, v42, v43
  v_cvt_pk_bf16_f32 v42, v44, v45
  v_cvt_pk_bf16_f32 v43, v46, v47
  v_pk_mul_f32 v[16:17], v[16:17], v[84:85] op_sel_hi:[1,0]
  v_pk_mul_f32 v[18:19], v[18:19], v[84:85] op_sel_hi:[1,0]
  v_pk_mul_f32 v[20:21], v[20:21], v[84:85] op_sel_hi:[1,0]
  v_pk_mul_f32 v[22:23], v[22:23], v[84:85] op_sel_hi:[1,0]
  v_cvt_pk_bf16_f32 v16, v16, v17
  v_cvt_pk_bf16_f32 v17, v18, v19
  v_cvt_pk_bf16_f32 v18, v20, v21
  v_cvt_pk_bf16_f32 v19, v22, v23
  v_mov_b32_dpp v80, v40 row_ror:8 row_mask:0xf bank_mask:0x3
  v_mov_b32_dpp v81, v41 row_ror:8 row_mask:0xf bank_mask:0x3
  v_mov_b32_dpp v82, v42 row_ror:8 row_mask:0xf bank_mask:0x3
  v_mov_b32_dpp v83, v43 row_ror:8 row_mask:0xf bank_mask:0x3
  v_pk_mul_f32 v[32:33], v[32:33], v[84:85] op_sel_hi:[1,0]
  v_pk_mul_f32 v[34:35], v[34:35], v[84:85] op_sel_hi:[1,0]
  v_pk_mul_f32 v[36:37], v[36:37], v[84:85] op_sel_hi:[1,0]
  v_pk_mul_f32 v[38:39], v[38:39], v[84:85] op_sel_hi:[1,0]
  v_cvt_pk_bf16_f32 v32, v32, v33
  v_cvt_pk_bf16_f32 v33, v34, v35
  v_cvt_pk_bf16_f32 v34, v36, v37
  v_cvt_pk_bf16_f32 v35, v38, v39
  v_mov_b32 v88, 0
  v_mov_b32 v89, 0
  v_mov_b32 v90, 0
  v_mov_b32 v91, 0
  v_mov_b32 v92, 0
  v_mov_b32 v93, 0
  v_mov_b32 v94, 0
  v_mov_b32 v95, 0
  s_mov_b64 exec, s[32:33]
  v_xor_b32 v5, 0xe000, v5
  s_mov_b64 exec, -1
  buffer_load_dwordx4 v[24:27], v0, s[4:7], s16 offen sc1
  buffer_load_dwordx4 v[28:31], v0, s[4:7], s16 offen offset:1024 sc1
L_S_nx20:
  v_mov_b32 v20, v80
  v_mov_b32 v21, v81
  v_mov_b32 v22, v82
  v_mov_b32 v23, v83
  v_mov_b32_dpp v16, v32 row_ror:8 row_mask:0xf bank_mask:0x3
  v_mov_b32_dpp v17, v33 row_ror:8 row_mask:0xf bank_mask:0x3
  v_mov_b32_dpp v18, v34 row_ror:8 row_mask:0xf bank_mask:0x3
  v_mov_b32_dpp v19, v35 row_ror:8 row_mask:0xf bank_mask:0x3
  v_mov_b32 v72, 0
  v_mov_b32 v73, 0
  v_mov_b32 v74, 0
  v_mov_b32 v75, 0
  v_mov_b32 v76, 0
  v_mov_b32 v77, 0
  v_mov_b32 v78, 0
  v_mov_b32 v79, 0
  v_mov_b32 v80, 0
  v_mov_b32 v81, 0
  v_mov_b32 v82, 0
  v_mov_b32 v83, 0
  v_mov_b32 v84, 0
  v_mov_b32 v85, 0
  v_mov_b32 v86, 0
  v_mov_b32 v87, 0
  ds_read_b128 v[32:35], v4 offset:0
  ds_read_b128 v[36:39], v4 offset:1024
  ds_read_b128 v[40:43], v4 offset:2048
  ds_read_b128 v[44:47], v4 offset:3072
  ds_read_b128 v[48:51], v4 offset:4096
  ds_read_b128 v[52:55], v4 offset:5120
  buffer_load_dwordx4 v[64:67], v0, s[4:7], s16 offen sc1
  buffer_load_dwordx4 v[68:71], v0, s[4:7], s16 offen offset:1024 sc1
  s_add_u32 s14, s14, 1
  s_cmp_lg_u32 s97, 0
  s_cbranch_scc1 L_S_xq0
L_S_xok0:
  s_waitcnt vmcnt(2)
L_S_fpd0:
  ds_read_b128 v[56:59], v4 offset:6144
  ds_read_b128 v[60:63], v4 offset:7168
L_S_chk1:
  v_bitop3_b32 v6, v24, v28, 1 bitop3:0xa8
  v_cmp_ne_u32 vcc, 0, v6
  s_cbranch_vccnz L_S_f2x1
L_S_have1:
  s_waitcnt lgkmcnt(2)
  v_smfmac_f32_16x16x64_bf16 v[88:91], v[24:27], v[32:39], v15
  ds_write_b64 v1, v[24:25] offset:0
  v_smfmac_f32_16x16x64_bf16 v[92:95], v[24:27], v[40:47], v15
  ds_write_b64 v1, v[26:27] offset:8
  v_smfmac_f32_16x16x64_bf16 v[88:91], v[28:31], v[48:55], v15
  ds_write_b64 v1, v[28:29] offset:1024
  v_smfmac_f32_16x16x64_bf16 v[72:75], v[24:27], v[96:103], v15
  ds_write_b64 v1, v[30:31] offset:1032
  v_smfmac_f32_16x16x64_bf16 v[76:79], v[24:27], v[104:111], v15
  v_xor_b32 v39, 0x800, v1
  v_smfmac_f32_16x16x64_bf16 v[72:75], v[28:31], v[112:119], v15
  v_xor_b32 v47, 0x1000, v1
  v_smfmac_f32_16x16x64_bf16 v[76:79], v[28:31], v[120:127], v15
  v_xor_b32 v55, 0x1800, v1
  v_smfmac_f32_16x16x64_bf16 v[80:83], v[24:27], a[0:7], v15
  s_waitcnt lgkmcnt(0)
  s_barrier
  ds_read_b128 v[32:35], v39 offset:0
  ds_read_b128 v[36:39], v39 offset:1024
  v_smfmac_f32_16x16x64_bf16 v[84:87], v[24:27], a[8:15], v15
  s_mov_b32 m0, s23
  s_nop 0
  buffer_load_dwordx4 v0, s[4:7], s22 offen offset:0 sc1 lds
  ds_read_b128 v[40:43], v47 offset:0
  ds_read_b128 v[44:47], v47 offset:1024
  v_smfmac_f32_16x16x64_bf16 v[80:83], v[28:31], a[16:23], v15
  ds_read_b128 v[48:51], v55 offset:0
  ds_read_b128 v[52:55], v55 offset:1024
  v_smfmac_f32_16x16x64_bf16 v[84:87], v[28:31], a[24:31], v15
  v_smfmac_f32_16x16x64_bf16 v[92:95], v[28:31], v[56:63], v15
  buffer_load_dwordx4 v0, s[4:7], s22 offen offset:1024 sc1 lds
L_S_rest1:
  s_waitcnt lgkmcnt(5)
  v_smfmac_f32_16x16x64_bf16 v[72:75], v[32:35], v[128:135], v15
  v_smfmac_f32_16x16x64_bf16 v[76:79], v[32:35], v[136:143], v15
  s_waitcnt lgkmcnt(4)
  v_smfmac_f32_16x16x64_bf16 v[72:75], v[36:39], v[144:151], v15
  buffer_load_dwordx4 v0, s[4:7], s22 offen offset:2048 sc1 lds
  v_smfmac_f32_16x16x64_bf16 v[76:79], v[36:39], v[152:159], v15
  s_waitcnt lgkmcnt(3)
  v_smfmac_f32_16x16x64_bf16 v[72:75], v[40:43], v[160:167], v15
  ds_read_b128 v[56:59], v4 offset:8192
  v_smfmac_f32_16x16x64_bf16 v[76:79], v[40:43], v[168:175], v15
  buffer_load_dwordx4 v0, s[4:7], s22 offen offset:3072 sc1 lds
  s_waitcnt vmcnt(4)
  s_bitcmp1_b64 s[82:83], s14
  s_cbranch_scc1 L_S_fp1
L_S_fpr1:
  s_cmp_lg_u32 s97, 0
  s_cbranch_scc1 L_S_fl1
L_S_flr1:
  ds_read_b128 v[60:63], v4 offset:9216
  s_waitcnt lgkmcnt(4)
  v_smfmac_f32_16x16x64_bf16 v[72:75], v[44:47], v[176:183], v15
  ds_read_b128 v[24:27], v4 offset:10240
  v_smfmac_f32_16x16x64_bf16 v[76:79], v[44:47], v[184:191], v15
  buffer_store_dwordx4 v[20:23], v14, s[4:7], s24 offen sc1
  ds_read_b128 v[28:31], v4 offset:11264
  s_waitcnt lgkmcnt(5)
  v_smfmac_f32_16x16x64_bf16 v[72:75], v[48:51], v[192:199], v15
  ds_read_b128 v[64:67], v4 offset:12288
  v_smfmac_f32_16x16x64_bf16 v[76:79], v[48:51], v[200:207], v15
  ds_read_b128 v[68:71], v4 offset:13312
  s_waitcnt lgkmcnt(6)
  v_smfmac_f32_16x16x64_bf16 v[72:75], v[52:55], v[208:215], v15
  v_xor_b32 v6, 1024, v14
  buffer_store_dwordx4 v[16:19], v6, s[4:7], s24 offen sc1
  s_mov_b32 s24, s79
  s_add_u32 s79, s79, 8192
  ds_read_b128 v[16:19], v4 offset:14336
  v_smfmac_f32_16x16x64_bf16 v[76:79], v[52:55], v[216:223], v15
  ds_read_b128 v[20:23], v4 offset:15360
  v_smfmac_f32_16x16x64_bf16 v[80:83], v[40:43], a[64:71], v15
  s_nop 1
  v_smfmac_f32_16x16x64_bf16 v[84:87], v[40:43], a[72:79], v15
  s_add_u32 m0, s23, 4096
  s_add_u32 s26, s22, 4096
  buffer_load_dwordx4 v0, s[4:7], s26 offen offset:0 sc1 lds
  s_nop 1
  v_smfmac_f32_16x16x64_bf16 v[80:83], v[44:47], a[80:87], v15
  s_nop 1
  v_smfmac_f32_16x16x64_bf16 v[84:87], v[44:47], a[88:95], v15
  v_add_f32 v72, v72, v74
  v_add_f32 v73, v73, v75
  v_add_f32 v76, v76, v78
  v_add_f32 v77, v77, v79
  v_smfmac_f32_16x16x64_bf16 v[80:83], v[48:51], a[96:103], v15
  v_cvt_pk_bf16_f32 v72, v72, v73
  v_cvt_pk_bf16_f32 v76, v76, v77
  ds_write2st64_b32 v8, v72, v76 offset0:0 offset1:1
  v_smfmac_f32_16x16x64_bf16 v[84:87], v[48:51], a[104:111], v15
  buffer_load_dwordx4 v0, s[4:7], s26 offen offset:1024 sc1 lds
  s_add_u32 s22, s22, 24576
  s_sub_u32 s23, s25, s23
  v_smfmac_f32_16x16x64_bf16 v[80:83], v[52:55], a[112:119], v15
  ds_read_b128 v[72:75], v10 offset:0
  v_smfmac_f32_16x16x64_bf16 v[84:87], v[52:55], a[120:127], v15
  ds_read_b128 v[76:79], v10 offset:16
  v_smfmac_f32_16x16x64_bf16 v[80:83], v[32:35], a[32:39], v15
  v_smfmac_f32_16x16x64_bf16 v[84:87], v[32:35], a[40:47], v15
  v_smfmac_f32_16x16x64_bf16 v[80:83], v[36:39], a[48:55], v15
  s_cmp_eq_u32 s14, 1
  s_cbranch_scc1 L_S_x01
L_S_x0r1:
  s_waitcnt lgkmcnt(2)
  s_barrier
  v_smfmac_f32_16x16x64_bf16 v[84:87], v[36:39], a[56:63], v15
  v_smfmac_f32_16x16x64_bf16 v[88:91], v[40:43], v[56:63], v15
  s_nop 2
  v_smfmac_f32_16x16x64_bf16 v[92:95], v[40:43], v[24:31], v15
  s_nop 0
  v_add_f32 v80, v80, v82
  v_add_f32 v81, v81, v83
  v_smfmac_f32_16x16x64_bf16 v[88:91], v[44:47], v[64:71], v15
  v_add_f32 v84, v84, v86
  v_add_f32 v85, v85, v87
  v_cvt_pk_bf16_f32 v86, v80, v81
  v_cvt_pk_bf16_f32 v87, v84, v85
  ds_write2st64_b32 v9, v86, v87 offset0:0 offset1:1
  ds_read_b128 v[56:59], v0 offset:49152
  v_smfmac_f32_16x16x64_bf16 v[92:95], v[44:47], v[16:23], v15
  ds_read_b128 v[60:63], v0 offset:50176
  v_smfmac_f32_16x16x64_bf16 v[88:91], v[48:51], a[128:135], v15
  ds_read_b64_tr_b16 v[40:41], v5 offset:0
  ds_read_b64_tr_b16 v[42:43], v5 offset:64
  v_smfmac_f32_16x16x64_bf16 v[92:95], v[48:51], a[144:151], v15
  ds_read_b128 v[24:27], v0 offset:51200
  v_smfmac_f32_16x16x64_bf16 v[88:91], v[52:55], a[232:239], v15
  ds_read_b64_tr_b16 v[44:45], v5 offset:512
  ds_read_b64_tr_b16 v[46:47], v5 offset:576
  v_smfmac_f32_16x16x64_bf16 v[92:95], v[52:55], a[248:255], v15
  ds_read_b128 v[28:31], v0 offset:52224
  s_waitcnt lgkmcnt(8)
  s_barrier
  v_smfmac_f32_16x16x64_bf16 v[88:91], v[32:35], v[224:231], v15
  ds_read_b64_tr_b16 v[48:49], v5 offset:1024
  ds_read_b64_tr_b16 v[50:51], v5 offset:1088
  v_smfmac_f32_16x16x64_bf16 v[92:95], v[32:35], v[232:239], v15
  ds_read_b128 v[64:67], v0 offset:53248
  v_smfmac_f32_16x16x64_bf16 v[88:91], v[36:39], v[240:247], v15
  ds_read_b128 v[68:71], v0 offset:54272
  v_smfmac_f32_16x16x64_bf16 v[92:95], v[36:39], v[248:255], v15
  ds_read_b64_tr_b16 v[52:53], v5 offset:1536
  ds_read_b64_tr_b16 v[54:55], v5 offset:1600
  v_mfma_f32_16x16x16_bf16 v[80:83], v[2:3], v[2:3], 0
  ds_read_b128 v[16:19], v0 offset:55296
  s_waitcnt lgkmcnt(7)
  v_mfma_f32_16x16x32_bf16 v[72:75], v[56:59], v[40:43], v[72:75]
  ds_read_b128 v[20:23], v0 offset:56320
  v_mfma_f32_16x16x32_bf16 v[76:79], v[60:63], v[40:43], v[76:79]
  ds_read_b64_tr_b16 v[32:33], v7 offset:0
  ds_read_b64_tr_b16 v[34:35], v7 offset:128
  v_mfma_f32_16x16x32_bf16 v[72:75], v[24:27], v[44:47], v[72:75]
  ds_read_b64_tr_b16 v[36:37], v7 offset:1024
  ds_read_b64_tr_b16 v[38:39], v7 offset:1152
  v_mfma_f32_16x16x32_bf16 v[76:79], v[28:31], v[44:47], v[76:79]
  ds_read_b128 v[56:59], v1 offset:57344
  s_waitcnt lgkmcnt(9)
  v_mfma_f32_16x16x32_bf16 v[72:75], v[64:67], v[48:51], v[72:75]
  ds_read_b128 v[60:63], v1 offset:58368
  v_mfma_f32_16x16x32_bf16 v[76:79], v[68:71], v[48:51], v[76:79]
  s_waitcnt lgkmcnt(6)
  v_mfma_f32_16x16x32_bf16 v[72:75], v[16:19], v[52:55], v[72:75]
  ds_read_b128 v[64:67], v4 offset:18432
  v_mfma_f32_16x16x32_bf16 v[76:79], v[20:23], v[52:55], v[76:79]
  ds_read_b128 v[68:71], v4 offset:19456
  s_waitcnt lgkmcnt(4)
  v_smfmac_f32_16x16x64_bf16 v[80:83], v[32:35], v[40:47], v15
  v_smfmac_f32_16x16x64_bf16 v[80:83], v[36:39], v[48:55], v15
  v_mfma_f32_32x32x8_bf16 v[24:39], v[2:3], v[2:3], 0
  v_add_f32 v88, v88, v90
  v_add_f32 v89, v89, v91
  v_add_f32 v92, v92, v94
  v_add_f32 v93, v93, v95
  v_max3_f32 v84, v72, v73, v74
  v_max3_f32 v85, v75, v76, v77
  v_max3_f32 v84, v84, v78, v79
  v_add_f32 v80, v80, v82
  v_add_f32 v81, v81, v83
  v_max3_f32 v84, v84, v85, v80
  v_max_f32 v84, v84, v81
  v_mov_b32 v85, v84
  v_mfma_f32_32x32x8_bf16 v[40:55], v[2:3], v[2:3], 0
  v_cvt_pk_bf16_f32 v88, v88, v89
  v_permlane16_swap_b32 v85, v84
  v_max_f32 v84, v84, v85
  v_mov_b32 v85, v84
  v_cvt_pk_bf16_f32 v89, v92, v93
  v_lshrrev_b32 v90, 2, v1
  v_permlane32_swap_b32 v85, v84
  ds_write2st64_b32 v90, v88, v89 offset0:56 offset1:57
  v_max_f32 v84, v84, v85
  v_mul_f32 v86, s34, v84
  v_pk_fma_f32 v[72:73], v[72:73], s[34:35], v[86:87] op_sel_hi:[1,1,0] neg_lo:[0,0,1] neg_hi:[0,0,1]
  v_pk_fma_f32 v[74:75], v[74:75], s[34:35], v[86:87] op_sel_hi:[1,1,0] neg_lo:[0,0,1] neg_hi:[0,0,1]
  v_pk_fma_f32 v[76:77], v[76:77], s[34:35], v[86:87] op_sel_hi:[1,1,0] neg_lo:[0,0,1] neg_hi:[0,0,1]
  v_pk_fma_f32 v[78:79], v[78:79], s[34:35], v[86:87] op_sel_hi:[1,1,0] neg_lo:[0,0,1] neg_hi:[0,0,1]
  v_pk_fma_f32 v[80:81], v[80:81], s[34:35], v[86:87] op_sel_hi:[1,1,0] neg_lo:[0,0,1] neg_hi:[0,0,1]
  v_exp_f32 v72, v72
  v_exp_f32 v73, v73
  v_exp_f32 v74, v74
  v_exp_f32 v75, v75
  v_exp_f32 v76, v76
  v_exp_f32 v77, v77
  v_exp_f32 v78, v78
  v_exp_f32 v79, v79
  v_exp_f32 v80, v80
  v_exp_f32 v81, v81
  v_pk_add_f32 v[84:85], v[72:73], v[74:75]
  v_pk_add_f32 v[86:87], v[76:77], v[78:79]
  v_cvt_pk_bf16_f32 v72, v72, v73
  v_cvt_pk_bf16_f32 v73, v74, v75
  v_cvt_pk_bf16_f32 v74, v76, v77
  v_cvt_pk_bf16_f32 v75, v78, v79
  v_pk_add_f32 v[84:85], v[84:85], v[80:81]
  v_cvt_pk_bf16_f32 v76, v80, v81
  v_pk_add_f32 v[84:85], v[84:85], v[86:87]
  s_waitcnt lgkmcnt(1)
  v_mfma_f32_16x16x32_bf16 v[16:19], v[56:59], v[72:75], 0
  v_mov_b32 v77, 0
  v_mov_b32 v78, 0
  v_mfma_f32_16x16x32_bf16 v[20:23], v[60:63], v[72:75], 0
  v_mov_b32 v79, v76
  v_add_f32 v84, v84, v85
  v_mfma_f32_16x16x16_bf16 v[16:19], v[88:89], v[76:77], v[16:19]
  v_mov_b32 v85, v84
  v_mfma_f32_16x16x16_bf16 v[20:23], v[88:89], v[78:79], v[20:23]
  s_nop 0
  v_permlane16_swap_b32 v85, v84
  v_add_f32 v84, v84, v85
  v_mov_b32 v85, v84
  s_nop 1
  v_permlane32_swap_b32 v85, v84
  v_add_f32 v84, v84, v85
  v_rcp_f32 v84, v84
  s_nop 0
  v_pk_mul_f32 v[16:17], v[16:17], v[84:85] op_sel_hi:[1,0]
  v_pk_mul_f32 v[18:19], v[18:19], v[84:85] op_sel_hi:[1,0]
  v_pk_mul_f32 v[20:21], v[20:21], v[84:85] op_sel_hi:[1,0]
  v_pk_mul_f32 v[22:23], v[22:23], v[84:85] op_sel_hi:[1,0]
  v_cvt_pk_bf16_f32 v80, v16, v17
  v_cvt_pk_bf16_f32 v81, v18, v19
  v_cvt_pk_bf16_f32 v82, v20, v21
  v_cvt_pk_bf16_f32 v83, v22, v23
  s_mov_b64 exec, s[30:31]
  ds_write_b128 v14, v[80:83] offset:0
  s_mov_b64 exec, -1
  s_waitcnt lgkmcnt(0)
  s_barrier
  ds_read_b128 v[16:19], v0 offset:0
  ds_read_b128 v[20:23], v0 offset:1024
  ds_read_b128 v[56:59], v4 offset:16384
  ds_read_b128 v[60:63], v4 offset:17408
  s_cmp_eq_u32 s14, 63
  s_cbranch_scc1 L_S_offpv1
  s_waitcnt lgkmcnt(3)
  v_smfmac_f32_16x16x64_bf16 v[28:31], v[16:19], v[64:71], v15
  v_smfmac_f32_16x16x64_bf16 v[32:35], v[16:19], a[160:167], v15
  ds_read_b128 v[64:67], v4 offset:22528
  v_smfmac_f32_16x16x64_bf16 v[36:39], v[16:19], a[176:183], v15
  ds_read_b128 v[68:71], v4 offset:23552
  s_waitcnt lgkmcnt(2)
  v_smfmac_f32_16x16x64_bf16 v[24:27], v[16:19], v[56:63], v15
  v_smfmac_f32_16x16x64_bf16 v[24:27], v[20:23], a[136:143], v15
  ds_read_b128 v[56:59], v4 offset:20480
  v_smfmac_f32_16x16x64_bf16 v[28:31], v[20:23], a[152:159], v15
  ds_read_b128 v[60:63], v4 offset:21504
  v_smfmac_f32_16x16x64_bf16 v[32:35], v[20:23], a[168:175], v15
  v_smfmac_f32_16x16x64_bf16 v[36:39], v[20:23], a[184:191], v15
  v_smfmac_f32_16x16x64_bf16 v[40:43], v[16:19], a[192:199], v15
  v_smfmac_f32_16x16x64_bf16 v[40:43], v[20:23], a[200:207], v15
  s_nop 0
  v_smfmac_f32_16x16x64_bf16 v[44:47], v[16:19], a[208:215], v15
  v_add_f32 v24, v24, v26
  v_add_f32 v25, v25, v27
  v_cvt_pk_bf16_f32 v24, v24, v25
  v_smfmac_f32_16x16x64_bf16 v[44:47], v[20:23], a[216:223], v15
  v_add_f32 v28, v28, v30
  v_add_f32 v29, v29, v31
  v_cvt_pk_bf16_f32 v25, v28, v29
  v_smfmac_f32_16x16x64_bf16 v[48:51], v[16:19], a[224:231], v15
  v_add_f32 v32, v32, v34
  v_add_f32 v33, v33, v35
  v_cvt_pk_bf16_f32 v26, v32, v33
  v_smfmac_f32_16x16x64_bf16 v[52:55], v[16:19], a[240:247], v15
  v_add_f32 v36, v36, v38
  v_add_f32 v37, v37, v39
  v_cvt_pk_bf16_f32 v27, v36, v37
  v_or_b32 v24, 1, v24
  s_waitcnt lgkmcnt(0)
  v_smfmac_f32_16x16x64_bf16 v[48:51], v[20:23], v[56:63], v15
  buffer_store_dwordx4 v[24:27], v12, s[4:7], s18 offen sc1
  v_smfmac_f32_16x16x64_bf16 v[52:55], v[20:23], v[64:71], v15
  v_add_f32 v40, v40, v42
  v_add_f32 v41, v41, v43
  v_cvt_pk_bf16_f32 v40, v40, v41
  v_or_b32 v40, 1, v40
  v_add_f32 v44, v44, v46
  v_add_f32 v45, v45, v47
  v_cvt_pk_bf16_f32 v41, v44, v45
  v_pk_add_f32 v[48:49], v[48:49], v[50:51]
  v_cvt_pk_bf16_f32 v42, v48, v49
  v_pk_add_f32 v[52:53], v[52:53], v[54:55]
  v_cvt_pk_bf16_f32 v43, v52, v53
  buffer_store_dwordx4 v[40:43], v12, s[4:7], s19 offen sc1
L_S_offpv1:
  v_lshrrev_b32 v51, 2, v1
  v_xor_b32 v48, 0x800, v1
  v_xor_b32 v49, 0x1000, v1
  v_xor_b32 v50, 0x1800, v1
  ds_read_b128 v[24:27], v48 offset:57344
  ds_read_b128 v[28:31], v48 offset:58368
  v_xor_b32 v52, 0x200, v51
  ds_read2st64_b32 v[52:53], v52 offset0:56 offset1:57
  ds_read_b128 v[32:35], v49 offset:57344
  ds_read_b128 v[36:39], v49 offset:58368
  v_xor_b32 v54, 0x400, v51
  ds_read2st64_b32 v[54:55], v54 offset0:56 offset1:57
  v_mov_b32 v92, 0x3f80
  v_mov_b32 v93, 0x3f800000
  v_cndmask_b32 v92, 0, v92, s[44:45]
  v_cndmask_b32 v92, v92, v93, s[46:47]
  v_cndmask_b32 v88, 0, v92, s[36:37]
  v_cndmask_b32 v89, 0, v92, s[38:39]
  v_cndmask_b32 v90, 0, v92, s[40:41]
  v_cndmask_b32 v91, 0, v92, s[42:43]
  s_waitcnt lgkmcnt(3)
  v_mfma_f32_16x16x32_bf16 v[40:43], v[24:27], v[72:75], 0
  v_mfma_f32_16x16x32_bf16 v[44:47], v[28:31], v[72:75], 0
  v_mfma_f32_16x16x16_bf16 v[40:43], v[52:53], v[76:77], v[40:43]
  v_mfma_f32_16x16x16_bf16 v[44:47], v[52:53], v[78:79], v[44:47]
  ds_read_b128 v[24:27], v50 offset:57344
  ds_read_b128 v[28:31], v50 offset:58368
  v_xor_b32 v52, 0x600, v51
  ds_read2st64_b32 v[52:53], v52 offset0:56 offset1:57
  s_waitcnt lgkmcnt(3)
  v_mfma_f32_16x16x32_bf16 v[16:19], v[32:35], v[72:75], 0
  v_mfma_f32_16x16x32_bf16 v[20:23], v[36:39], v[72:75], 0
  v_mfma_f32_16x16x16_bf16 v[16:19], v[54:55], v[76:77], v[16:19]
  v_mfma_f32_16x16x16_bf16 v[20:23], v[54:55], v[78:79], v[20:23]
  s_cmp_eq_u32 s14, 63
  s_cbranch_scc1 L_S_np01
  buffer_load_dwordx4 v[56:59], v0, s[4:7], s20 offen sc1
  buffer_load_dwordx4 v[60:63], v0, s[4:7], s21 offen sc1
L_S_np01:
  v_cndmask_b32 v51, 0, 1, s[2:3]
  s_waitcnt lgkmcnt(0)
  v_mfma_f32_16x16x32_bf16 v[32:35], v[24:27], v[72:75], 0
  v_mfma_f32_16x16x32_bf16 v[36:39], v[28:31], v[72:75], 0
  v_mfma_f32_16x16x16_bf16 v[32:35], v[52:53], v[76:77], v[32:35]
  v_mfma_f32_16x16x16_bf16 v[36:39], v[52:53], v[78:79], v[36:39]
  s_cmp_eq_u32 s14, 63
  s_cbranch_scc1 L_S_np11
  buffer_load_dwordx4 v[64:67], v0, s[4:7], s20 offen sc1
  buffer_load_dwordx4 v[68:71], v0, s[4:7], s21 offen sc1
L_S_np11:
  s_cmp_eq_u32 s14, 63
  s_cbranch_scc1 L_S_w21
L_S_red1:
  s_waitcnt vmcnt(2)
  v_mfma_f32_16x16x32_bf16 v[92:95], v[88:91], v[56:59], 0
  v_mfma_f32_16x16x32_bf16 v[92:95], v[88:91], v[60:63], v[92:95]
  v_bitop3_b32 v6, v56, v60, 1 bitop3:0x2a
  v_cmp_ne_u32 vcc, 0, v6
  s_cbranch_vccnz L_S_f1x1
L_S_tail1:
  s_nop 4
  v_add_f32_dpp v92, v92, v92 row_ror:4 row_mask:0xf bank_mask:0xf
  v_add_f32_dpp v93, v93, v93 row_ror:4 row_mask:0xf bank_mask:0xf
  v_add_f32_dpp v94, v94, v94 row_ror:4 row_mask:0xf bank_mask:0xf
  v_add_f32_dpp v95, v95, v95 row_ror:4 row_mask:0xf bank_mask:0xf
  v_add_f32_dpp v92, v92, v92 row_ror:8 row_mask:0xf bank_mask:0xf
  v_add_f32_dpp v93, v93, v93 row_ror:8 row_mask:0xf bank_mask:0xf
  v_add_f32_dpp v94, v94, v94 row_ror:8 row_mask:0xf bank_mask:0xf
  v_add_f32_dpp v95, v95, v95 row_ror:8 row_mask:0xf bank_mask:0xf
  v_cvt_pk_bf16_f32 v92, v92, v93
  v_cvt_pk_bf16_f32 v93, v94, v95
  v_or_b32 v92, v51, v92
  buffer_store_dwordx2 v[92:93], v13, s[4:7], s17 offen sc1
L_S_w21:
  v_pk_mul_f32 v[40:41], v[40:41], v[84:85] op_sel_hi:[1,0]
  v_pk_mul_f32 v[42:43], v[42:43], v[84:85] op_sel_hi:[1,0]
  v_pk_mul_f32 v[44:45], v[44:45], v[84:85] op_sel_hi:[1,0]
  v_pk_mul_f32 v[46:47], v[46:47], v[84:85] op_sel_hi:[1,0]
  v_cvt_pk_bf16_f32 v40, v40, v41
  v_cvt_pk_bf16_f32 v41, v42, v43
  v_cvt_pk_bf16_f32 v42, v44, v45
  v_cvt_pk_bf16_f32 v43, v46, v47
  v_pk_mul_f32 v[16:17], v[16:17], v[84:85] op_sel_hi:[1,0]
  v_pk_mul_f32 v[18:19], v[18:19], v[84:85] op_sel_hi:[1,0]
  v_pk_mul_f32 v[20:21], v[20:21], v[84:85] op_sel_hi:[1,0]
  v_pk_mul_f32 v[22:23], v[22:23], v[84:85] op_sel_hi:[1,0]
  v_cvt_pk_bf16_f32 v16, v16, v17
  v_cvt_pk_bf16_f32 v17, v18, v19
  v_cvt_pk_bf16_f32 v18, v20, v21
  v_cvt_pk_bf16_f32 v19, v22, v23
  v_mov_b32_dpp v80, v40 row_ror:8 row_mask:0xf bank_mask:0x3
  v_mov_b32_dpp v81, v41 row_ror:8 row_mask:0xf bank_mask:0x3
  v_mov_b32_dpp v82, v42 row_ror:8 row_mask:0xf bank_mask:0x3
  v_mov_b32_dpp v83, v43 row_ror:8 row_mask:0xf bank_mask:0x3
  v_pk_mul_f32 v[32:33], v[32:33], v[84:85] op_sel_hi:[1,0]
  v_pk_mul_f32 v[34:35], v[34:35], v[84:85] op_sel_hi:[1,0]
  v_pk_mul_f32 v[36:37], v[36:37], v[84:85] op_sel_hi:[1,0]
  v_pk_mul_f32 v[38:39], v[38:39], v[84:85] op_sel_hi:[1,0]
  v_cvt_pk_bf16_f32 v32, v32, v33
  v_cvt_pk_bf16_f32 v33, v34, v35
  v_cvt_pk_bf16_f32 v34, v36, v37
  v_cvt_pk_bf16_f32 v35, v38, v39
  v_mov_b32 v88, 0
  v_mov_b32 v89, 0
  v_mov_b32 v90, 0
  v_mov_b32 v91, 0
  v_mov_b32 v92, 0
  v_mov_b32 v93, 0
  v_mov_b32 v94, 0
  v_mov_b32 v95, 0
  s_mov_b64 exec, s[32:33]
  v_xor_b32 v5, 0xe000, v5
  s_mov_b64 exec, -1
  s_cmp_eq_u32 s14, 63
  s_cbranch_scc1 L_S_nx21
  buffer_load_dwordx4 v[24:27], v0, s[4:7], s16 offen sc1
  buffer_load_dwordx4 v[28:31], v0, s[4:7], s16 offen offset:1024 sc1
L_S_nx21:
  v_mov_b32 v20, v80
  v_mov_b32 v21, v81
  v_mov_b32 v22, v82
  v_mov_b32 v23, v83
  v_mov_b32_dpp v16, v32 row_ror:8 row_mask:0xf bank_mask:0x3
  v_mov_b32_dpp v17, v33 row_ror:8 row_mask:0xf bank_mask:0x3
  v_mov_b32_dpp v18, v34 row_ror:8 row_mask:0xf bank_mask:0x3
  v_mov_b32_dpp v19, v35 row_ror:8 row_mask:0xf bank_mask:0x3
  s_cmp_eq_u32 s14, 63
  s_cbranch_scc1 L_S_last
  v_mov_b32 v72, 0
  v_mov_b32 v73, 0
  v_mov_b32 v74, 0
  v_mov_b32 v75, 0
  v_mov_b32 v76, 0
  v_mov_b32 v77, 0
  v_mov_b32 v78, 0
  v_mov_b32 v79, 0
  v_mov_b32 v80, 0
  v_mov_b32 v81, 0
  v_mov_b32 v82, 0
  v_mov_b32 v83, 0
  v_mov_b32 v84, 0
  v_mov_b32 v85, 0
  v_mov_b32 v86, 0
  v_mov_b32 v87, 0
  ds_read_b128 v[32:35], v4 offset:0
  ds_read_b128 v[36:39], v4 offset:1024
  ds_read_b128 v[40:43], v4 offset:2048
  ds_read_b128 v[44:47], v4 offset:3072
  ds_read_b128 v[48:51], v4 offset:4096
  ds_read_b128 v[52:55], v4 offset:5120
  buffer_load_dwordx4 v[64:67], v0, s[4:7], s16 offen sc1
  buffer_load_dwordx4 v[68:71], v0, s[4:7], s16 offen offset:1024 sc1
  s_add_u32 s14, s14, 1
  s_cmp_lg_u32 s97, 0
  s_cbranch_scc1 L_S_xq1
L_S_xok1:
  s_waitcnt vmcnt(2)
L_S_fpd1:
  ds_read_b128 v[56:59], v4 offset:6144
  ds_read_b128 v[60:63], v4 offset:7168
  s_branch L_S_chk0
L_S_last:
  buffer_store_dwordx4 v[20:23], v14, s[4:7], s24 offen sc1
  v_xor_b32 v6, 1024, v14
  buffer_store_dwordx4 v[16:19], v6, s[4:7], s24 offen sc1
  s_mov_b32 s24, s79
  s_add_u32 s79, s79, 8192
  s_waitcnt vmcnt(0)
  s_barrier
  s_cmp_lg_u32 s13, 0
  s_cbranch_scc1 L_recend
  v_mov_b32 v11, 64
  s_mov_b64 exec, 1
  buffer_store_dword v11, off, s[4:7], s59 sc1
  s_branch L_recend
L_B_f2x0:
  buffer_load_dwordx4 v[24:27], v0, s[4:7], s16 offen sc1
  buffer_load_dwordx4 v[28:31], v0, s[4:7], s16 offen offset:1024 sc1
  s_waitcnt vmcnt(2)
  v_bitop3_b32 v6, v64, v68, 1 bitop3:0x2a
  v_cmp_ne_u32 vcc, 0, v6
  s_cbranch_vccz L_B_ownY0
  s_add_u32 s15, s15, 1
  s_cmp_ge_u32 s15, 0x80000
  s_cbranch_scc1 L_B_ownY0
  buffer_load_dwordx4 v[64:67], v0, s[4:7], s16 offen sc1
  buffer_load_dwordx4 v[68:71], v0, s[4:7], s16 offen offset:1024 sc1
  s_waitcnt vmcnt(2)
  s_branch L_B_chk0
L_B_ownY0:
  s_add_u32 s98, s98, 1
  s_waitcnt lgkmcnt(2)
  v_smfmac_f32_16x16x64_bf16 v[88:91], v[64:67], v[32:39], v15
  ds_write_b64 v1, v[64:65] offset:0
  v_smfmac_f32_16x16x64_bf16 v[92:95], v[64:67], v[40:47], v15
  ds_write_b64 v1, v[66:67] offset:8
  v_smfmac_f32_16x16x64_bf16 v[88:91], v[68:71], v[48:55], v15
  ds_write_b64 v1, v[68:69] offset:1024
  v_smfmac_f32_16x16x64_bf16 v[72:75], v[64:67], v[96:103], v15
  ds_write_b64 v1, v[70:71] offset:1032
  v_smfmac_f32_16x16x64_bf16 v[76:79], v[64:67], v[104:111], v15
  v_xor_b32 v39, 0x800, v1
  v_smfmac_f32_16x16x64_bf16 v[72:75], v[68:71], v[112:119], v15
  v_xor_b32 v47, 0x1000, v1
  v_smfmac_f32_16x16x64_bf16 v[76:79], v[68:71], v[120:127], v15
  v_xor_b32 v55, 0x1800, v1
  v_smfmac_f32_16x16x64_bf16 v[80:83], v[64:67], a[0:7], v15
  s_waitcnt lgkmcnt(0)
  s_barrier
  ds_read_b128 v[32:35], v39 offset:0
  ds_read_b128 v[36:39], v39 offset:1024
  v_smfmac_f32_16x16x64_bf16 v[84:87], v[64:67], a[8:15], v15
  s_mov_b32 m0, s23
  s_nop 0
  buffer_load_dwordx4 v0, s[4:7], s22 offen offset:0 sc1 lds
  ds_read_b128 v[40:43], v47 offset:0
  ds_read_b128 v[44:47], v47 offset:1024
  v_smfmac_f32_16x16x64_bf16 v[80:83], v[68:71], a[16:23], v15
  ds_read_b128 v[48:51], v55 offset:0
  ds_read_b128 v[52:55], v55 offset:1024
  v_smfmac_f32_16x16x64_bf16 v[84:87], v[68:71], a[24:31], v15
  v_smfmac_f32_16x16x64_bf16 v[92:95], v[68:71], v[56:63], v15
  buffer_load_dwordx4 v0, s[4:7], s22 offen offset:1024 sc1 lds
  s_branch L_B_rest0
L_B_x00:
  s_waitcnt vmcnt(7)
  s_branch L_B_x0r0
L_B_f1x0:
  s_add_u32 s99, s99, 1
  buffer_load_dwordx4 v[56:59], v0, s[4:7], s20 offen sc1
  buffer_load_dwordx4 v[60:63], v0, s[4:7], s21 offen sc1
  s_waitcnt vmcnt(2)
  v_mfma_f32_16x16x32_bf16 v[92:95], v[88:91], v[64:67], 0
  v_mfma_f32_16x16x32_bf16 v[92:95], v[88:91], v[68:71], v[92:95]
  v_bitop3_b32 v6, v64, v68, 1 bitop3:0xa8
  v_cmp_ne_u32 vcc, 0, v6
  s_cbranch_vccz L_B_tail0
  s_add_u32 s15, s15, 1
  s_cmp_ge_u32 s15, 0x80000
  s_cbranch_scc1 L_B_tail0
  buffer_load_dwordx4 v[64:67], v0, s[4:7], s20 offen sc1
  buffer_load_dwordx4 v[68:71], v0, s[4:7], s21 offen sc1
  s_branch L_B_red0
.p2align 6
L_B_chk0:
  v_bitop3_b32 v6, v24, v28, 1 bitop3:0x2a
  v_cmp_ne_u32 vcc, 0, v6
  s_cbranch_vccnz L_B_f2x0
L_B_have0:
  s_mul_i32 s27, s12, 6144
  s_add_u32 s27, s27, 0x13dfc0
  buffer_load_dword v72, v8, s[4:7], s27 offen offset:0 sc1
  buffer_load_dword v76, v8, s[4:7], s27 offen offset:256 sc1
  buffer_load_dword v86, v8, s[4:7], s27 offen offset:2048 sc1
  buffer_load_dword v87, v8, s[4:7], s27 offen offset:2304 sc1
  s_add_u32 s27, s27, 4096
  buffer_load_dword v32, v8, s[4:7], s27 offen offset:0 sc1
  buffer_load_dword v33, v8, s[4:7], s27 offen offset:256 sc1
  s_mov_b32 s24, s79
  s_waitcnt vmcnt(0)
  s_barrier
  v_lshlrev_b32 v88, 16, v32
  v_and_b32 v89, 0xffff0000, v32
  v_lshlrev_b32 v92, 16, v33
  v_and_b32 v93, 0xffff0000, v33
L_B_rest0:
  ds_write2st64_b32 v8, v72, v76 offset0:0 offset1:1
  ds_read_b128 v[72:75], v10 offset:0
  ds_read_b128 v[76:79], v10 offset:16
L_B_x0r0:
  s_waitcnt lgkmcnt(2)
  s_barrier
  ds_write2st64_b32 v9, v86, v87 offset0:0 offset1:1
  ds_read_b128 v[56:59], v0 offset:24576
  ds_read_b128 v[60:63], v0 offset:25600
  ds_read_b64_tr_b16 v[40:41], v5 offset:0
  ds_read_b64_tr_b16 v[42:43], v5 offset:64
  ds_read_b128 v[24:27], v0 offset:26624
  ds_read_b64_tr_b16 v[44:45], v5 offset:512
  ds_read_b64_tr_b16 v[46:47], v5 offset:576
  ds_read_b128 v[28:31], v0 offset:27648
  s_waitcnt lgkmcnt(8)
  s_barrier
  ds_read_b64_tr_b16 v[48:49], v5 offset:1024
  ds_read_b64_tr_b16 v[50:51], v5 offset:1088
  ds_read_b128 v[64:67], v0 offset:28672
  ds_read_b128 v[68:71], v0 offset:29696
  ds_read_b64_tr_b16 v[52:53], v5 offset:1536
  ds_read_b64_tr_b16 v[54:55], v5 offset:1600
  v_mfma_f32_16x16x16_bf16 v[80:83], v[2:3], v[2:3], 0
  ds_read_b128 v[16:19], v0 offset:30720
  s_waitcnt lgkmcnt(7)
  v_mfma_f32_16x16x32_bf16 v[72:75], v[56:59], v[40:43], v[72:75]
  ds_read_b128 v[20:23], v0 offset:31744
  v_mfma_f32_16x16x32_bf16 v[76:79], v[60:63], v[40:43], v[76:79]
  ds_read_b64_tr_b16 v[32:33], v7 offset:0
  ds_read_b64_tr_b16 v[34:35], v7 offset:128
  v_mfma_f32_16x16x32_bf16 v[72:75], v[24:27], v[44:47], v[72:75]
  ds_read_b64_tr_b16 v[36:37], v7 offset:1024
  ds_read_b64_tr_b16 v[38:39], v7 offset:1152
  v_mfma_f32_16x16x32_bf16 v[76:79], v[28:31], v[44:47], v[76:79]
  ds_read_b128 v[56:59], v1 offset:32768
  s_waitcnt lgkmcnt(9)
  v_mfma_f32_16x16x32_bf16 v[72:75], v[64:67], v[48:51], v[72:75]
  ds_read_b128 v[60:63], v1 offset:33792
  v_mfma_f32_16x16x32_bf16 v[76:79], v[68:71], v[48:51], v[76:79]
  s_waitcnt lgkmcnt(6)
  v_mfma_f32_16x16x32_bf16 v[72:75], v[16:19], v[52:55], v[72:75]
  ds_read_b128 v[64:67], v4 offset:18432
  v_mfma_f32_16x16x32_bf16 v[76:79], v[20:23], v[52:55], v[76:79]
  ds_read_b128 v[68:71], v4 offset:19456
  s_waitcnt lgkmcnt(4)
  v_smfmac_f32_16x16x64_bf16 v[80:83], v[32:35], v[40:47], v15
  v_smfmac_f32_16x16x64_bf16 v[80:83], v[36:39], v[48:55], v15
  v_mfma_f32_32x32x8_bf16 v[24:39], v[2:3], v[2:3], 0
  v_add_f32 v88, v88, v90
  v_add_f32 v89, v89, v91
  v_add_f32 v92, v92, v94
  v_add_f32 v93, v93, v95
  v_max3_f32 v84, v72, v73, v74
  v_max3_f32 v85, v75, v76, v77
  v_max3_f32 v84, v84, v78, v79
  v_add_f32 v80, v80, v82
  v_add_f32 v81, v81, v83
  v_max3_f32 v84, v84, v85, v80
  v_max_f32 v84, v84, v81
  v_mov_b32 v85, v84
  v_mfma_f32_32x32x8_bf16 v[40:55], v[2:3], v[2:3], 0
  v_cvt_pk_bf16_f32 v88, v88, v89
  v_permlane16_swap_b32 v85, v84
  v_max_f32 v84, v84, v85
  v_mov_b32 v85, v84
  v_cvt_pk_bf16_f32 v89, v92, v93
  v_lshrrev_b32 v90, 2, v1
  v_permlane32_swap_b32 v85, v84
  ds_write2st64_b32 v90, v88, v89 offset0:56 offset1:57
  v_max_f32 v84, v84, v85
  v_mul_f32 v86, s34, v84
  v_pk_fma_f32 v[72:73], v[72:73], s[34:35], v[86:87] op_sel_hi:[1,1,0] neg_lo:[0,0,1] neg_hi:[0,0,1]
  v_pk_fma_f32 v[74:75], v[74:75], s[34:35], v[86:87] op_sel_hi:[1,1,0] neg_lo:[0,0,1] neg_hi:[0,0,1]
  v_pk_fma_f32 v[76:77], v[76:77], s[34:35], v[86:87] op_sel_hi:[1,1,0] neg_lo:[0,0,1] neg_hi:[0,0,1]
  v_pk_fma_f32 v[78:79], v[78:79], s[34:35], v[86:87] op_sel_hi:[1,1,0] neg_lo:[0,0,1] neg_hi:[0,0,1]
  v_pk_fma_f32 v[80:81], v[80:81], s[34:35], v[86:87] op_sel_hi:[1,1,0] neg_lo:[0,0,1] neg_hi:[0,0,1]
  v_exp_f32 v72, v72
  v_exp_f32 v73, v73
  v_exp_f32 v74, v74
  v_exp_f32 v75, v75
  v_exp_f32 v76, v76
  v_exp_f32 v77, v77
  v_exp_f32 v78, v78
  v_exp_f32 v79, v79
  v_exp_f32 v80, v80
  v_exp_f32 v81, v81
  v_pk_add_f32 v[84:85], v[72:73], v[74:75]
  v_pk_add_f32 v[86:87], v[76:77], v[78:79]
  v_cvt_pk_bf16_f32 v72, v72, v73
  v_cvt_pk_bf16_f32 v73, v74, v75
  v_cvt_pk_bf16_f32 v74, v76, v77
  v_cvt_pk_bf16_f32 v75, v78, v79
  v_pk_add_f32 v[84:85], v[84:85], v[80:81]
  v_cvt_pk_bf16_f32 v76, v80, v81
  v_pk_add_f32 v[84:85], v[84:85], v[86:87]
  s_waitcnt lgkmcnt(1)
  v_mfma_f32_16x16x32_bf16 v[16:19], v[56:59], v[72:75], 0
  v_mov_b32 v77, 0
  v_mov_b32 v78, 0
  v_mfma_f32_16x16x32_bf16 v[20:23], v[60:63], v[72:75], 0
  v_mov_b32 v79, v76
  v_add_f32 v84, v84, v85
  v_mfma_f32_16x16x16_bf16 v[16:19], v[88:89], v[76:77], v[16:19]
  v_mov_b32 v85, v84
  v_mfma_f32_16x16x16_bf16 v[20:23], v[88:89], v[78:79], v[20:23]
  s_nop 0
  v_permlane16_swap_b32 v85, v84
  v_add_f32 v84, v84, v85
  v_mov_b32 v85, v84
  s_nop 1
  v_permlane32_swap_b32 v85, v84
  v_add_f32 v84, v84, v85
  v_rcp_f32 v84, v84
  s_nop 0
  v_pk_mul_f32 v[16:17], v[16:17], v[84:85] op_sel_hi:[1,0]
  v_pk_mul_f32 v[18:19], v[18:19], v[84:85] op_sel_hi:[1,0]
  v_pk_mul_f32 v[20:21], v[20:21], v[84:85] op_sel_hi:[1,0]
  v_pk_mul_f32 v[22:23], v[22:23], v[84:85] op_sel_hi:[1,0]
  v_cvt_pk_bf16_f32 v80, v16, v17
  v_cvt_pk_bf16_f32 v81, v18, v19
  v_cvt_pk_bf16_f32 v82, v20, v21
  v_cvt_pk_bf16_f32 v83, v22, v23
  s_mov_b64 exec, s[30:31]
  ds_write_b128 v14, v[80:83] offset:0
  s_mov_b64 exec, -1
  s_waitcnt lgkmcnt(0)
  s_barrier
  ds_read_b128 v[16:19], v0 offset:0
  ds_read_b128 v[20:23], v0 offset:1024
  ds_read_b128 v[56:59], v4 offset:16384
  ds_read_b128 v[60:63], v4 offset:17408
  s_waitcnt lgkmcnt(3)
  v_smfmac_f32_16x16x64_bf16 v[28:31], v[16:19], v[64:71], v15
  v_smfmac_f32_16x16x64_bf16 v[32:35], v[16:19], a[160:167], v15
  ds_read_b128 v[64:67], v4 offset:22528
  v_smfmac_f32_16x16x64_bf16 v[36:39], v[16:19], a[176:183], v15
  ds_read_b128 v[68:71], v4 offset:23552
  s_waitcnt lgkmcnt(2)
  v_smfmac_f32_16x16x64_bf16 v[24:27], v[16:19], v[56:63], v15
  v_smfmac_f32_16x16x64_bf16 v[24:27], v[20:23], a[136:143], v15
  ds_read_b128 v[56:59], v4 offset:20480
  v_smfmac_f32_16x16x64_bf16 v[28:31], v[20:23], a[152:159], v15
  ds_read_b128 v[60:63], v4 offset:21504
  v_smfmac_f32_16x16x64_bf16 v[32:35], v[20:23], a[168:175], v15
  v_smfmac_f32_16x16x64_bf16 v[36:39], v[20:23], a[184:191], v15
  v_smfmac_f32_16x16x64_bf16 v[40:43], v[16:19], a[192:199], v15
  v_smfmac_f32_16x16x64_bf16 v[40:43], v[20:23], a[200:207], v15
  s_nop 0
  v_smfmac_f32_16x16x64_bf16 v[44:47], v[16:19], a[208:215], v15
  v_add_f32 v24, v24, v26
  v_add_f32 v25, v25, v27
  v_cvt_pk_bf16_f32 v24, v24, v25
  v_smfmac_f32_16x16x64_bf16 v[44:47], v[20:23], a[216:223], v15
  v_add_f32 v28, v28, v30
  v_add_f32 v29, v29, v31
  v_cvt_pk_bf16_f32 v25, v28, v29
  v_smfmac_f32_16x16x64_bf16 v[48:51], v[16:19], a[224:231], v15
  v_add_f32 v32, v32, v34
  v_add_f32 v33, v33, v35
  v_cvt_pk_bf16_f32 v26, v32, v33
  v_smfmac_f32_16x16x64_bf16 v[52:55], v[16:19], a[240:247], v15
  v_add_f32 v36, v36, v38
  v_add_f32 v37, v37, v39
  v_cvt_pk_bf16_f32 v27, v36, v37
  v_and_b32 v24, -2, v24
  s_waitcnt lgkmcnt(0)
  v_smfmac_f32_16x16x64_bf16 v[48:51], v[20:23], v[56:63], v15
  buffer_store_dwordx4 v[24:27], v12, s[4:7], s18 offen sc1
  v_smfmac_f32_16x16x64_bf16 v[52:55], v[20:23], v[64:71], v15
  v_add_f32 v40, v40, v42
  v_add_f32 v41, v41, v43
  v_cvt_pk_bf16_f32 v40, v40, v41
  v_and_b32 v40, -2, v40
  v_add_f32 v44, v44, v46
  v_add_f32 v45, v45, v47
  v_cvt_pk_bf16_f32 v41, v44, v45
  v_pk_add_f32 v[48:49], v[48:49], v[50:51]
  v_cvt_pk_bf16_f32 v42, v48, v49
  v_pk_add_f32 v[52:53], v[52:53], v[54:55]
  v_cvt_pk_bf16_f32 v43, v52, v53
  buffer_store_dwordx4 v[40:43], v12, s[4:7], s19 offen sc1
L_B_offpv0:
  v_lshrrev_b32 v51, 2, v1
  v_xor_b32 v48, 0x800, v1
  v_xor_b32 v49, 0x1000, v1
  v_xor_b32 v50, 0x1800, v1
  ds_read_b128 v[24:27], v48 offset:32768
  ds_read_b128 v[28:31], v48 offset:33792
  v_xor_b32 v52, 0x200, v51
  ds_read2st64_b32 v[52:53], v52 offset0:56 offset1:57
  ds_read_b128 v[32:35], v49 offset:32768
  ds_read_b128 v[36:39], v49 offset:33792
  v_xor_b32 v54, 0x400, v51
  ds_read2st64_b32 v[54:55], v54 offset0:56 offset1:57
  v_mov_b32 v92, 0x3f80
  v_mov_b32 v93, 0x3f800000
  v_cndmask_b32 v92, 0, v92, s[44:45]
  v_cndmask_b32 v92, v92, v93, s[46:47]
  v_cndmask_b32 v88, 0, v92, s[36:37]
  v_cndmask_b32 v89, 0, v92, s[38:39]
  v_cndmask_b32 v90, 0, v92, s[40:41]
  v_cndmask_b32 v91, 0, v92, s[42:43]
  s_waitcnt lgkmcnt(3)
  v_mfma_f32_16x16x32_bf16 v[40:43], v[24:27], v[72:75], 0
  v_mfma_f32_16x16x32_bf16 v[44:47], v[28:31], v[72:75], 0
  v_mfma_f32_16x16x16_bf16 v[40:43], v[52:53], v[76:77], v[40:43]
  v_mfma_f32_16x16x16_bf16 v[44:47], v[52:53], v[78:79], v[44:47]
  ds_read_b128 v[24:27], v50 offset:32768
  ds_read_b128 v[28:31], v50 offset:33792
  v_xor_b32 v52, 0x600, v51
  ds_read2st64_b32 v[52:53], v52 offset0:56 offset1:57
  s_waitcnt lgkmcnt(3)
  v_mfma_f32_16x16x32_bf16 v[16:19], v[32:35], v[72:75], 0
  v_mfma_f32_16x16x32_bf16 v[20:23], v[36:39], v[72:75], 0
  v_mfma_f32_16x16x16_bf16 v[16:19], v[54:55], v[76:77], v[16:19]
  v_mfma_f32_16x16x16_bf16 v[20:23], v[54:55], v[78:79], v[20:23]
  buffer_load_dwordx4 v[56:59], v0, s[4:7], s20 offen sc1
  buffer_load_dwordx4 v[60:63], v0, s[4:7], s21 offen sc1
  v_cndmask_b32 v51, -1, -2, s[2:3]
  s_waitcnt lgkmcnt(0)
  v_mfma_f32_16x16x32_bf16 v[32:35], v[24:27], v[72:75], 0
  v_mfma_f32_16x16x32_bf16 v[36:39], v[28:31], v[72:75], 0
  v_mfma_f32_16x16x16_bf16 v[32:35], v[52:53], v[76:77], v[32:35]
  v_mfma_f32_16x16x16_bf16 v[36:39], v[52:53], v[78:79], v[36:39]
  buffer_load_dwordx4 v[64:67], v0, s[4:7], s20 offen sc1
  buffer_load_dwordx4 v[68:71], v0, s[4:7], s21 offen sc1
  s_cmp_eq_u32 s14, 0
  s_cselect_b32 s27, 0x4000, 0
  s_sub_u32 s17, s17, s27
L_B_red0:
  s_waitcnt vmcnt(2)
  v_mfma_f32_16x16x32_bf16 v[92:95], v[88:91], v[56:59], 0
  v_mfma_f32_16x16x32_bf16 v[92:95], v[88:91], v[60:63], v[92:95]
  v_bitop3_b32 v6, v56, v60, 1 bitop3:0xa8
  v_cmp_ne_u32 vcc, 0, v6
  s_cbranch_vccnz L_B_f1x0
L_B_tail0:
  s_nop 4
  v_add_f32_dpp v92, v92, v92 row_ror:4 row_mask:0xf bank_mask:0xf
  v_add_f32_dpp v93, v93, v93 row_ror:4 row_mask:0xf bank_mask:0xf
  v_add_f32_dpp v94, v94, v94 row_ror:4 row_mask:0xf bank_mask:0xf
  v_add_f32_dpp v95, v95, v95 row_ror:4 row_mask:0xf bank_mask:0xf
  v_add_f32_dpp v92, v92, v92 row_ror:8 row_mask:0xf bank_mask:0xf
  v_add_f32_dpp v93, v93, v93 row_ror:8 row_mask:0xf bank_mask:0xf
  v_add_f32_dpp v94, v94, v94 row_ror:8 row_mask:0xf bank_mask:0xf
  v_add_f32_dpp v95, v95, v95 row_ror:8 row_mask:0xf bank_mask:0xf
  v_cvt_pk_bf16_f32 v92, v92, v93
  v_cvt_pk_bf16_f32 v93, v94, v95
  v_and_b32 v92, v51, v92
  buffer_store_dwordx2 v[92:93], v13, s[4:7], s17 offen sc1
L_B_w20:
  v_pk_mul_f32 v[40:41], v[40:41], v[84:85] op_sel_hi:[1,0]
  v_pk_mul_f32 v[42:43], v[42:43], v[84:85] op_sel_hi:[1,0]
  v_pk_mul_f32 v[44:45], v[44:45], v[84:85] op_sel_hi:[1,0]
  v_pk_mul_f32 v[46:47], v[46:47], v[84:85] op_sel_hi:[1,0]
  v_cvt_pk_bf16_f32 v40, v40, v41
  v_cvt_pk_bf16_f32 v41, v42, v43
  v_cvt_pk_bf16_f32 v42, v44, v45
  v_cvt_pk_bf16_f32 v43, v46, v47
  v_pk_mul_f32 v[16:17], v[16:17], v[84:85] op_sel_hi:[1,0]
  v_pk_mul_f32 v[18:19], v[18:19], v[84:85] op_sel_hi:[1,0]
  v_pk_mul_f32 v[20:21], v[20:21], v[84:85] op_sel_hi:[1,0]
  v_pk_mul_f32 v[22:23], v[22:23], v[84:85] op_sel_hi:[1,0]
  v_cvt_pk_bf16_f32 v16, v16, v17
  v_cvt_pk_bf16_f32 v17, v18, v19
  v_cvt_pk_bf16_f32 v18, v20, v21
  v_cvt_pk_bf16_f32 v19, v22, v23
  v_mov_b32_dpp v80, v40 row_ror:8 row_mask:0xf bank_mask:0x3
  v_mov_b32_dpp v81, v41 row_ror:8 row_mask:0xf bank_mask:0x3
  v_mov_b32_dpp v82, v42 row_ror:8 row_mask:0xf bank_mask:0x3
  v_mov_b32_dpp v83, v43 row_ror:8 row_mask:0xf bank_mask:0x3
  v_pk_mul_f32 v[32:33], v[32:33], v[84:85] op_sel_hi:[1,0]
  v_pk_mul_f32 v[34:35], v[34:35], v[84:85] op_sel_hi:[1,0]
  v_pk_mul_f32 v[36:37], v[36:37], v[84:85] op_sel_hi:[1,0]
  v_pk_mul_f32 v[38:39], v[38:39], v[84:85] op_sel_hi:[1,0]
  v_cvt_pk_bf16_f32 v32, v32, v33
  v_cvt_pk_bf16_f32 v33, v34, v35
  v_cvt_pk_bf16_f32 v34, v36, v37
  v_cvt_pk_bf16_f32 v35, v38, v39
  v_mov_b32 v88, 0
  v_mov_b32 v89, 0
  v_mov_b32 v90, 0
  v_mov_b32 v91, 0
  v_mov_b32 v92, 0
  v_mov_b32 v93, 0
  v_mov_b32 v94, 0
  v_mov_b32 v95, 0
  s_mov_b64 exec, s[32:33]
  v_xor_b32 v5, 0xe000, v5
  s_mov_b64 exec, -1
  s_cmp_eq_u32 s14, 0
  s_cbranch_scc1 L_B_nx20
  buffer_load_dwordx4 v[24:27], v0, s[4:7], s16 offen sc1
  buffer_load_dwordx4 v[28:31], v0, s[4:7], s16 offen offset:1024 sc1
L_B_nx20:
  v_mov_b32 v20, v80
  v_mov_b32 v21, v81
  v_mov_b32 v22, v82
  v_mov_b32 v23, v83
  v_mov_b32_dpp v16, v32 row_ror:8 row_mask:0xf bank_mask:0x3
  v_mov_b32_dpp v17, v33 row_ror:8 row_mask:0xf bank_mask:0x3
  v_mov_b32_dpp v18, v34 row_ror:8 row_mask:0xf bank_mask:0x3
  v_mov_b32_dpp v19, v35 row_ror:8 row_mask:0xf bank_mask:0x3
  s_cmp_eq_u32 s14, 0
  s_cbranch_scc1 L_B_last
  v_mov_b32 v72, 0
  v_mov_b32 v73, 0
  v_mov_b32 v74, 0
  v_mov_b32 v75, 0
  v_mov_b32 v76, 0
  v_mov_b32 v77, 0
  v_mov_b32 v78, 0
  v_mov_b32 v79, 0
  v_mov_b32 v80, 0
  v_mov_b32 v81, 0
  v_mov_b32 v82, 0
  v_mov_b32 v83, 0
  v_mov_b32 v84, 0
  v_mov_b32 v85, 0
  v_mov_b32 v86, 0
  v_mov_b32 v87, 0
  ds_read_b128 v[32:35], v4 offset:0
  ds_read_b128 v[36:39], v4 offset:1024
  ds_read_b128 v[40:43], v4 offset:2048
  ds_read_b128 v[44:47], v4 offset:3072
  ds_read_b128 v[48:51], v4 offset:4096
  ds_read_b128 v[52:55], v4 offset:5120
  buffer_load_dwordx4 v[64:67], v0, s[4:7], s16 offen sc1
  buffer_load_dwordx4 v[68:71], v0, s[4:7], s16 offen offset:1024 sc1
  s_add_u32 s14, s14, 1
  s_waitcnt vmcnt(2)
L_B_fpd0:
  ds_read_b128 v[56:59], v4 offset:6144
  ds_read_b128 v[60:63], v4 offset:7168
L_B_last:
  buffer_store_dwordx4 v[20:23], v14, s[4:7], s24 offen sc1
  v_xor_b32 v6, 1024, v14
  buffer_store_dwordx4 v[16:19], v6, s[4:7], s24 offen sc1
  s_mov_b32 s24, s79
  s_add_u32 s79, s79, 8192
  s_waitcnt vmcnt(0)
  s_barrier
  s_branch L_tbdone
  s_cmp_lg_u32 s13, 0
  s_cbranch_scc1 L_tbdone
  v_mov_b32 v11, 64
  s_mov_b64 exec, 1
  buffer_store_dword v11, off, s[4:7], s59 sc1
  s_branch L_tbdone
L_C_f2x0:
  buffer_load_dwordx4 v[24:27], v0, s[4:7], s16 offen sc1
  buffer_load_dwordx4 v[28:31], v0, s[4:7], s16 offen offset:1024 sc1
  s_waitcnt vmcnt(2)
  v_bitop3_b32 v6, v64, v68, 1 bitop3:0x2a
  v_cmp_ne_u32 vcc, 0, v6
  s_cbranch_vccz L_C_ownY0
  s_add_u32 s15, s15, 1
  s_cmp_ge_u32 s15, 0x80000
  s_cbranch_scc1 L_C_ownY0
  buffer_load_dwordx4 v[64:67], v0, s[4:7], s16 offen sc1
  buffer_load_dwordx4 v[68:71], v0, s[4:7], s16 offen offset:1024 sc1
  s_waitcnt vmcnt(2)
  s_branch L_C_chk0
L_C_ownY0:
  s_add_u32 s98, s98, 1
  s_waitcnt lgkmcnt(2)
  v_smfmac_f32_16x16x64_bf16 v[88:91], v[64:67], v[32:39], v15
  ds_write_b64 v1, v[64:65] offset:0
  v_smfmac_f32_16x16x64_bf16 v[92:95], v[64:67], v[40:47], v15
  ds_write_b64 v1, v[66:67] offset:8
  v_smfmac_f32_16x16x64_bf16 v[88:91], v[68:71], v[48:55], v15
  ds_write_b64 v1, v[68:69] offset:1024
  v_smfmac_f32_16x16x64_bf16 v[72:75], v[64:67], v[96:103], v15
  ds_write_b64 v1, v[70:71] offset:1032
  v_smfmac_f32_16x16x64_bf16 v[76:79], v[64:67], v[104:111], v15
  v_xor_b32 v39, 0x800, v1
  v_smfmac_f32_16x16x64_bf16 v[72:75], v[68:71], v[112:119], v15
  v_xor_b32 v47, 0x1000, v1
  v_smfmac_f32_16x16x64_bf16 v[76:79], v[68:71], v[120:127], v15
  v_xor_b32 v55, 0x1800, v1
  v_smfmac_f32_16x16x64_bf16 v[80:83], v[64:67], a[0:7], v15
  s_waitcnt lgkmcnt(0)
  s_barrier
  ds_read_b128 v[32:35], v39 offset:0
  ds_read_b128 v[36:39], v39 offset:1024
  v_smfmac_f32_16x16x64_bf16 v[84:87], v[64:67], a[8:15], v15
  s_mov_b32 m0, s23
  s_nop 0
  buffer_load_dwordx4 v0, s[4:7], s22 offen offset:0 sc1 lds
  ds_read_b128 v[40:43], v47 offset:0
  ds_read_b128 v[44:47], v47 offset:1024
  v_smfmac_f32_16x16x64_bf16 v[80:83], v[68:71], a[16:23], v15
  ds_read_b128 v[48:51], v55 offset:0
  ds_read_b128 v[52:55], v55 offset:1024
  v_smfmac_f32_16x16x64_bf16 v[84:87], v[68:71], a[24:31], v15
  v_smfmac_f32_16x16x64_bf16 v[92:95], v[68:71], v[56:63], v15
  buffer_load_dwordx4 v0, s[4:7], s22 offen offset:1024 sc1 lds
  s_branch L_C_rest0
L_C_x00:
  s_waitcnt vmcnt(7)
  s_branch L_C_x0r0
L_C_f1x0:
  s_add_u32 s99, s99, 1
  buffer_load_dwordx4 v[56:59], v0, s[4:7], s20 offen sc1
  buffer_load_dwordx4 v[60:63], v0, s[4:7], s21 offen sc1
  s_waitcnt vmcnt(2)
  v_mfma_f32_16x16x32_bf16 v[92:95], v[88:91], v[64:67], 0
  v_mfma_f32_16x16x32_bf16 v[92:95], v[88:91], v[68:71], v[92:95]
  v_bitop3_b32 v6, v64, v68, 1 bitop3:0xa8
  v_cmp_ne_u32 vcc, 0, v6
  s_cbranch_vccz L_C_tail0
  s_add_u32 s15, s15, 1
  s_cmp_ge_u32 s15, 0x80000
  s_cbranch_scc1 L_C_tail0
  buffer_load_dwordx4 v[64:67], v0, s[4:7], s20 offen sc1
  buffer_load_dwordx4 v[68:71], v0, s[4:7], s21 offen sc1
  s_branch L_C_red0
.p2align 6
L_C_chk0:
  v_bitop3_b32 v6, v24, v28, 1 bitop3:0x2a
  v_cmp_ne_u32 vcc, 0, v6
  s_cbranch_vccnz L_C_f2x0
L_C_have0:
  s_mul_i32 s27, s12, 6144
  s_add_u32 s27, s27, 0x13dfc0
  buffer_load_dword v72, v8, s[4:7], s27 offen offset:0 sc1
  buffer_load_dword v76, v8, s[4:7], s27 offen offset:256 sc1
  buffer_load_dword v86, v8, s[4:7], s27 offen offset:2048 sc1
  buffer_load_dword v87, v8, s[4:7], s27 offen offset:2304 sc1
  s_add_u32 s27, s27, 4096
  buffer_load_dword v32, v8, s[4:7], s27 offen offset:0 sc1
  buffer_load_dword v33, v8, s[4:7], s27 offen offset:256 sc1
  s_mov_b32 s24, s79
  s_waitcnt vmcnt(0)
  s_barrier
  v_lshlrev_b32 v88, 16, v32
  v_and_b32 v89, 0xffff0000, v32
  v_lshlrev_b32 v92, 16, v33
  v_and_b32 v93, 0xffff0000, v33
L_C_rest0:
  ds_write2st64_b32 v8, v72, v76 offset0:0 offset1:1
  ds_read_b128 v[72:75], v10 offset:0
  ds_read_b128 v[76:79], v10 offset:16
L_C_x0r0:
  s_waitcnt lgkmcnt(2)
  s_barrier
  ds_write2st64_b32 v9, v86, v87 offset0:0 offset1:1
  ds_read_b128 v[56:59], v0 offset:24576
  ds_read_b128 v[60:63], v0 offset:25600
  ds_read_b64_tr_b16 v[40:41], v5 offset:0
  ds_read_b64_tr_b16 v[42:43], v5 offset:64
  ds_read_b128 v[24:27], v0 offset:26624
  ds_read_b64_tr_b16 v[44:45], v5 offset:512
  ds_read_b64_tr_b16 v[46:47], v5 offset:576
  ds_read_b128 v[28:31], v0 offset:27648
  s_waitcnt lgkmcnt(8)
  s_barrier
  ds_read_b64_tr_b16 v[48:49], v5 offset:1024
  ds_read_b64_tr_b16 v[50:51], v5 offset:1088
  ds_read_b128 v[64:67], v0 offset:28672
  ds_read_b128 v[68:71], v0 offset:29696
  ds_read_b64_tr_b16 v[52:53], v5 offset:1536
  ds_read_b64_tr_b16 v[54:55], v5 offset:1600
  v_mfma_f32_16x16x16_bf16 v[80:83], v[2:3], v[2:3], 0
  ds_read_b128 v[16:19], v0 offset:30720
  s_waitcnt lgkmcnt(7)
  v_mfma_f32_16x16x32_bf16 v[72:75], v[56:59], v[40:43], v[72:75]
  ds_read_b128 v[20:23], v0 offset:31744
  v_mfma_f32_16x16x32_bf16 v[76:79], v[60:63], v[40:43], v[76:79]
  ds_read_b64_tr_b16 v[32:33], v7 offset:0
  ds_read_b64_tr_b16 v[34:35], v7 offset:128
  v_mfma_f32_16x16x32_bf16 v[72:75], v[24:27], v[44:47], v[72:75]
  ds_read_b64_tr_b16 v[36:37], v7 offset:1024
  ds_read_b64_tr_b16 v[38:39], v7 offset:1152
  v_mfma_f32_16x16x32_bf16 v[76:79], v[28:31], v[44:47], v[76:79]
  ds_read_b128 v[56:59], v1 offset:32768
  s_waitcnt lgkmcnt(9)
  v_mfma_f32_16x16x32_bf16 v[72:75], v[64:67], v[48:51], v[72:75]
  ds_read_b128 v[60:63], v1 offset:33792
  v_mfma_f32_16x16x32_bf16 v[76:79], v[68:71], v[48:51], v[76:79]
  s_waitcnt lgkmcnt(6)
  v_mfma_f32_16x16x32_bf16 v[72:75], v[16:19], v[52:55], v[72:75]
  ds_read_b128 v[64:67], v4 offset:18432
  v_mfma_f32_16x16x32_bf16 v[76:79], v[20:23], v[52:55], v[76:79]
  ds_read_b128 v[68:71], v4 offset:19456
  s_waitcnt lgkmcnt(4)
  v_smfmac_f32_16x16x64_bf16 v[80:83], v[32:35], v[40:47], v15
  v_smfmac_f32_16x16x64_bf16 v[80:83], v[36:39], v[48:55], v15
  v_mfma_f32_32x32x8_bf16 v[24:39], v[2:3], v[2:3], 0
  v_add_f32 v88, v88, v90
  v_add_f32 v89, v89, v91
  v_add_f32 v92, v92, v94
  v_add_f32 v93, v93, v95
  v_max3_f32 v84, v72, v73, v74
  v_max3_f32 v85, v75, v76, v77
  v_max3_f32 v84, v84, v78, v79
  v_add_f32 v80, v80, v82
  v_add_f32 v81, v81, v83
  v_max3_f32 v84, v84, v85, v80
  v_max_f32 v84, v84, v81
  v_mov_b32 v85, v84
  v_mfma_f32_32x32x8_bf16 v[40:55], v[2:3], v[2:3], 0
  v_cvt_pk_bf16_f32 v88, v88, v89
  v_permlane16_swap_b32 v85, v84
  v_max_f32 v84, v84, v85
  v_mov_b32 v85, v84
  v_cvt_pk_bf16_f32 v89, v92, v93
  v_lshrrev_b32 v90, 2, v1
  v_permlane32_swap_b32 v85, v84
  ds_write2st64_b32 v90, v88, v89 offset0:56 offset1:57
  v_max_f32 v84, v84, v85
  v_mul_f32 v86, s34, v84
  v_pk_fma_f32 v[72:73], v[72:73], s[34:35], v[86:87] op_sel_hi:[1,1,0] neg_lo:[0,0,1] neg_hi:[0,0,1]
  v_pk_fma_f32 v[74:75], v[74:75], s[34:35], v[86:87] op_sel_hi:[1,1,0] neg_lo:[0,0,1] neg_hi:[0,0,1]
  v_pk_fma_f32 v[76:77], v[76:77], s[34:35], v[86:87] op_sel_hi:[1,1,0] neg_lo:[0,0,1] neg_hi:[0,0,1]
  v_pk_fma_f32 v[78:79], v[78:79], s[34:35], v[86:87] op_sel_hi:[1,1,0] neg_lo:[0,0,1] neg_hi:[0,0,1]
  v_pk_fma_f32 v[80:81], v[80:81], s[34:35], v[86:87] op_sel_hi:[1,1,0] neg_lo:[0,0,1] neg_hi:[0,0,1]
  v_exp_f32 v72, v72
  v_exp_f32 v73, v73
  v_exp_f32 v74, v74
  v_exp_f32 v75, v75
  v_exp_f32 v76, v76
  v_exp_f32 v77, v77
  v_exp_f32 v78, v78
  v_exp_f32 v79, v79
  v_exp_f32 v80, v80
  v_exp_f32 v81, v81
  v_pk_add_f32 v[84:85], v[72:73], v[74:75]
  v_pk_add_f32 v[86:87], v[76:77], v[78:79]
  v_cvt_pk_bf16_f32 v72, v72, v73
  v_cvt_pk_bf16_f32 v73, v74, v75
  v_cvt_pk_bf16_f32 v74, v76, v77
  v_cvt_pk_bf16_f32 v75, v78, v79
  v_pk_add_f32 v[84:85], v[84:85], v[80:81]
  v_cvt_pk_bf16_f32 v76, v80, v81
  v_pk_add_f32 v[84:85], v[84:85], v[86:87]
  s_waitcnt lgkmcnt(1)
  v_mfma_f32_16x16x32_bf16 v[16:19], v[56:59], v[72:75], 0
  v_mov_b32 v77, 0
  v_mov_b32 v78, 0
  v_mfma_f32_16x16x32_bf16 v[20:23], v[60:63], v[72:75], 0
  v_mov_b32 v79, v76
  v_add_f32 v84, v84, v85
  v_mfma_f32_16x16x16_bf16 v[16:19], v[88:89], v[76:77], v[16:19]
  v_mov_b32 v85, v84
  v_mfma_f32_16x16x16_bf16 v[20:23], v[88:89], v[78:79], v[20:23]
  s_nop 0
  v_permlane16_swap_b32 v85, v84
  v_add_f32 v84, v84, v85
  v_mov_b32 v85, v84
  s_nop 1
  v_permlane32_swap_b32 v85, v84
  v_add_f32 v84, v84, v85
  v_rcp_f32 v84, v84
  s_nop 0
  v_pk_mul_f32 v[16:17], v[16:17], v[84:85] op_sel_hi:[1,0]
  v_pk_mul_f32 v[18:19], v[18:19], v[84:85] op_sel_hi:[1,0]
  v_pk_mul_f32 v[20:21], v[20:21], v[84:85] op_sel_hi:[1,0]
  v_pk_mul_f32 v[22:23], v[22:23], v[84:85] op_sel_hi:[1,0]
  v_cvt_pk_bf16_f32 v80, v16, v17
  v_cvt_pk_bf16_f32 v81, v18, v19
  v_cvt_pk_bf16_f32 v82, v20, v21
  v_cvt_pk_bf16_f32 v83, v22, v23
  s_mov_b64 exec, s[30:31]
  ds_write_b128 v14, v[80:83] offset:0
  s_mov_b64 exec, -1
  s_waitcnt lgkmcnt(0)
  s_barrier
  ds_read_b128 v[16:19], v0 offset:0
  ds_read_b128 v[20:23], v0 offset:1024
  ds_read_b128 v[56:59], v4 offset:16384
  ds_read_b128 v[60:63], v4 offset:17408
  s_waitcnt lgkmcnt(3)
  v_smfmac_f32_16x16x64_bf16 v[28:31], v[16:19], v[64:71], v15
  v_smfmac_f32_16x16x64_bf16 v[32:35], v[16:19], a[160:167], v15
  ds_read_b128 v[64:67], v4 offset:22528
  v_smfmac_f32_16x16x64_bf16 v[36:39], v[16:19], a[176:183], v15
  ds_read_b128 v[68:71], v4 offset:23552
  s_waitcnt lgkmcnt(2)
  v_smfmac_f32_16x16x64_bf16 v[24:27], v[16:19], v[56:63], v15
  v_smfmac_f32_16x16x64_bf16 v[24:27], v[20:23], a[136:143], v15
  ds_read_b128 v[56:59], v4 offset:20480
  v_smfmac_f32_16x16x64_bf16 v[28:31], v[20:23], a[152:159], v15
  ds_read_b128 v[60:63], v4 offset:21504
  v_smfmac_f32_16x16x64_bf16 v[32:35], v[20:23], a[168:175], v15
  v_smfmac_f32_16x16x64_bf16 v[36:39], v[20:23], a[184:191], v15
  v_smfmac_f32_16x16x64_bf16 v[40:43], v[16:19], a[192:199], v15
  v_smfmac_f32_16x16x64_bf16 v[40:43], v[20:23], a[200:207], v15
  s_nop 0
  v_smfmac_f32_16x16x64_bf16 v[44:47], v[16:19], a[208:215], v15
  v_add_f32 v24, v24, v26
  v_add_f32 v25, v25, v27
  v_cvt_pk_bf16_f32 v24, v24, v25
  v_smfmac_f32_16x16x64_bf16 v[44:47], v[20:23], a[216:223], v15
  v_add_f32 v28, v28, v30
  v_add_f32 v29, v29, v31
  v_cvt_pk_bf16_f32 v25, v28, v29
  v_smfmac_f32_16x16x64_bf16 v[48:51], v[16:19], a[224:231], v15
  v_add_f32 v32, v32, v34
  v_add_f32 v33, v33, v35
  v_cvt_pk_bf16_f32 v26, v32, v33
  v_smfmac_f32_16x16x64_bf16 v[52:55], v[16:19], a[240:247], v15
  v_add_f32 v36, v36, v38
  v_add_f32 v37, v37, v39
  v_cvt_pk_bf16_f32 v27, v36, v37
  v_and_b32 v24, -2, v24
  s_waitcnt lgkmcnt(0)
  v_smfmac_f32_16x16x64_bf16 v[48:51], v[20:23], v[56:63], v15
  buffer_store_dwordx4 v[24:27], v12, s[4:7], s18 offen
  v_smfmac_f32_16x16x64_bf16 v[52:55], v[20:23], v[64:71], v15
  v_add_f32 v40, v40, v42
  v_add_f32 v41, v41, v43
  v_cvt_pk_bf16_f32 v40, v40, v41
  v_and_b32 v40, -2, v40
  v_add_f32 v44, v44, v46
  v_add_f32 v45, v45, v47
  v_cvt_pk_bf16_f32 v41, v44, v45
  v_pk_add_f32 v[48:49], v[48:49], v[50:51]
  v_cvt_pk_bf16_f32 v42, v48, v49
  v_pk_add_f32 v[52:53], v[52:53], v[54:55]
  v_cvt_pk_bf16_f32 v43, v52, v53
  buffer_store_dwordx4 v[40:43], v12, s[4:7], s19 offen
L_C_offpv0:
  v_lshrrev_b32 v51, 2, v1
  v_xor_b32 v48, 0x800, v1
  v_xor_b32 v49, 0x1000, v1
  v_xor_b32 v50, 0x1800, v1
  ds_read_b128 v[24:27], v48 offset:32768
  ds_read_b128 v[28:31], v48 offset:33792
  v_xor_b32 v52, 0x200, v51
  ds_read2st64_b32 v[52:53], v52 offset0:56 offset1:57
  ds_read_b128 v[32:35], v49 offset:32768
  ds_read_b128 v[36:39], v49 offset:33792
  v_xor_b32 v54, 0x400, v51
  ds_read2st64_b32 v[54:55], v54 offset0:56 offset1:57
  v_mov_b32 v92, 0x3f80
  v_mov_b32 v93, 0x3f800000
  v_cndmask_b32 v92, 0, v92, s[44:45]
  v_cndmask_b32 v92, v92, v93, s[46:47]
  v_cndmask_b32 v88, 0, v92, s[36:37]
  v_cndmask_b32 v89, 0, v92, s[38:39]
  v_cndmask_b32 v90, 0, v92, s[40:41]
  v_cndmask_b32 v91, 0, v92, s[42:43]
  s_waitcnt lgkmcnt(3)
  v_mfma_f32_16x16x32_bf16 v[40:43], v[24:27], v[72:75], 0
  v_mfma_f32_16x16x32_bf16 v[44:47], v[28:31], v[72:75], 0
  v_mfma_f32_16x16x16_bf16 v[40:43], v[52:53], v[76:77], v[40:43]
  v_mfma_f32_16x16x16_bf16 v[44:47], v[52:53], v[78:79], v[44:47]
  ds_read_b128 v[24:27], v50 offset:32768
  ds_read_b128 v[28:31], v50 offset:33792
  v_xor_b32 v52, 0x600, v51
  ds_read2st64_b32 v[52:53], v52 offset0:56 offset1:57
  s_waitcnt lgkmcnt(3)
  v_mfma_f32_16x16x32_bf16 v[16:19], v[32:35], v[72:75], 0
  v_mfma_f32_16x16x32_bf16 v[20:23], v[36:39], v[72:75], 0
  v_mfma_f32_16x16x16_bf16 v[16:19], v[54:55], v[76:77], v[16:19]
  v_mfma_f32_16x16x16_bf16 v[20:23], v[54:55], v[78:79], v[20:23]
  buffer_load_dwordx4 v[56:59], v0, s[4:7], s20 offen sc1
  buffer_load_dwordx4 v[60:63], v0, s[4:7], s21 offen sc1
  v_cndmask_b32 v51, -1, -2, s[2:3]
  s_waitcnt lgkmcnt(0)
  v_mfma_f32_16x16x32_bf16 v[32:35], v[24:27], v[72:75], 0
  v_mfma_f32_16x16x32_bf16 v[36:39], v[28:31], v[72:75], 0
  v_mfma_f32_16x16x16_bf16 v[32:35], v[52:53], v[76:77], v[32:35]
  v_mfma_f32_16x16x16_bf16 v[36:39], v[52:53], v[78:79], v[36:39]
  buffer_load_dwordx4 v[64:67], v0, s[4:7], s20 offen sc1
  buffer_load_dwordx4 v[68:71], v0, s[4:7], s21 offen sc1
  s_cmp_eq_u32 s14, 0
  s_cselect_b32 s27, 0x4000, 0
  s_sub_u32 s17, s17, s27
L_C_red0:
  s_waitcnt vmcnt(2)
  v_mfma_f32_16x16x32_bf16 v[92:95], v[88:91], v[56:59], 0
  v_mfma_f32_16x16x32_bf16 v[92:95], v[88:91], v[60:63], v[92:95]
  v_bitop3_b32 v6, v56, v60, 1 bitop3:0xa8
  v_cmp_ne_u32 vcc, 0, v6
  s_cbranch_vccnz L_C_f1x0
L_C_tail0:
  s_nop 4
  v_add_f32_dpp v92, v92, v92 row_ror:4 row_mask:0xf bank_mask:0xf
  v_add_f32_dpp v93, v93, v93 row_ror:4 row_mask:0xf bank_mask:0xf
  v_add_f32_dpp v94, v94, v94 row_ror:4 row_mask:0xf bank_mask:0xf
  v_add_f32_dpp v95, v95, v95 row_ror:4 row_mask:0xf bank_mask:0xf
  v_add_f32_dpp v92, v92, v92 row_ror:8 row_mask:0xf bank_mask:0xf
  v_add_f32_dpp v93, v93, v93 row_ror:8 row_mask:0xf bank_mask:0xf
  v_add_f32_dpp v94, v94, v94 row_ror:8 row_mask:0xf bank_mask:0xf
  v_add_f32_dpp v95, v95, v95 row_ror:8 row_mask:0xf bank_mask:0xf
  v_cvt_pk_bf16_f32 v92, v92, v93
  v_cvt_pk_bf16_f32 v93, v94, v95
  v_and_b32 v92, v51, v92
  buffer_store_dwordx2 v[92:93], v13, s[4:7], s17 offen sc1
L_C_w20:
  v_pk_mul_f32 v[40:41], v[40:41], v[84:85] op_sel_hi:[1,0]
  v_pk_mul_f32 v[42:43], v[42:43], v[84:85] op_sel_hi:[1,0]
  v_pk_mul_f32 v[44:45], v[44:45], v[84:85] op_sel_hi:[1,0]
  v_pk_mul_f32 v[46:47], v[46:47], v[84:85] op_sel_hi:[1,0]
  v_cvt_pk_bf16_f32 v40, v40, v41
  v_cvt_pk_bf16_f32 v41, v42, v43
  v_cvt_pk_bf16_f32 v42, v44, v45
  v_cvt_pk_bf16_f32 v43, v46, v47
  v_pk_mul_f32 v[16:17], v[16:17], v[84:85] op_sel_hi:[1,0]
  v_pk_mul_f32 v[18:19], v[18:19], v[84:85] op_sel_hi:[1,0]
  v_pk_mul_f32 v[20:21], v[20:21], v[84:85] op_sel_hi:[1,0]
  v_pk_mul_f32 v[22:23], v[22:23], v[84:85] op_sel_hi:[1,0]
  v_cvt_pk_bf16_f32 v16, v16, v17
  v_cvt_pk_bf16_f32 v17, v18, v19
  v_cvt_pk_bf16_f32 v18, v20, v21
  v_cvt_pk_bf16_f32 v19, v22, v23
  v_mov_b32_dpp v80, v40 row_ror:8 row_mask:0xf bank_mask:0x3
  v_mov_b32_dpp v81, v41 row_ror:8 row_mask:0xf bank_mask:0x3
  v_mov_b32_dpp v82, v42 row_ror:8 row_mask:0xf bank_mask:0x3
  v_mov_b32_dpp v83, v43 row_ror:8 row_mask:0xf bank_mask:0x3
  v_pk_mul_f32 v[32:33], v[32:33], v[84:85] op_sel_hi:[1,0]
  v_pk_mul_f32 v[34:35], v[34:35], v[84:85] op_sel_hi:[1,0]
  v_pk_mul_f32 v[36:37], v[36:37], v[84:85] op_sel_hi:[1,0]
  v_pk_mul_f32 v[38:39], v[38:39], v[84:85] op_sel_hi:[1,0]
  v_cvt_pk_bf16_f32 v32, v32, v33
  v_cvt_pk_bf16_f32 v33, v34, v35
  v_cvt_pk_bf16_f32 v34, v36, v37
  v_cvt_pk_bf16_f32 v35, v38, v39
  v_mov_b32 v88, 0
  v_mov_b32 v89, 0
  v_mov_b32 v90, 0
  v_mov_b32 v91, 0
  v_mov_b32 v92, 0
  v_mov_b32 v93, 0
  v_mov_b32 v94, 0
  v_mov_b32 v95, 0
  s_mov_b64 exec, s[32:33]
  v_xor_b32 v5, 0xe000, v5
  s_mov_b64 exec, -1
  s_cmp_eq_u32 s14, 0
  s_cbranch_scc1 L_C_nx20
  buffer_load_dwordx4 v[24:27], v0, s[4:7], s16 offen sc1
  buffer_load_dwordx4 v[28:31], v0, s[4:7], s16 offen offset:1024 sc1
L_C_nx20:
  v_mov_b32 v20, v80
  v_mov_b32 v21, v81
  v_mov_b32 v22, v82
  v_mov_b32 v23, v83
  v_mov_b32_dpp v16, v32 row_ror:8 row_mask:0xf bank_mask:0x3
  v_mov_b32_dpp v17, v33 row_ror:8 row_mask:0xf bank_mask:0x3
  v_mov_b32_dpp v18, v34 row_ror:8 row_mask:0xf bank_mask:0x3
  v_mov_b32_dpp v19, v35 row_ror:8 row_mask:0xf bank_mask:0x3
  s_cmp_eq_u32 s14, 0
  s_cbranch_scc1 L_C_last
  v_mov_b32 v72, 0
  v_mov_b32 v73, 0
  v_mov_b32 v74, 0
  v_mov_b32 v75, 0
  v_mov_b32 v76, 0
  v_mov_b32 v77, 0
  v_mov_b32 v78, 0
  v_mov_b32 v79, 0
  v_mov_b32 v80, 0
  v_mov_b32 v81, 0
  v_mov_b32 v82, 0
  v_mov_b32 v83, 0
  v_mov_b32 v84, 0
  v_mov_b32 v85, 0
  v_mov_b32 v86, 0
  v_mov_b32 v87, 0
  ds_read_b128 v[32:35], v4 offset:0
  ds_read_b128 v[36:39], v4 offset:1024
  ds_read_b128 v[40:43], v4 offset:2048
  ds_read_b128 v[44:47], v4 offset:3072
  ds_read_b128 v[48:51], v4 offset:4096
  ds_read_b128 v[52:55], v4 offset:5120
  buffer_load_dwordx4 v[64:67], v0, s[4:7], s16 offen sc1
  buffer_load_dwordx4 v[68:71], v0, s[4:7], s16 offen offset:1024 sc1
  s_add_u32 s14, s14, 1
  s_waitcnt vmcnt(2)
L_C_fpd0:
  ds_read_b128 v[56:59], v4 offset:6144
  ds_read_b128 v[60:63], v4 offset:7168
L_C_last:
  buffer_store_dwordx4 v[20:23], v14, s[4:7], s24 offen sc1
  v_xor_b32 v6, 1024, v14
  buffer_store_dwordx4 v[16:19], v6, s[4:7], s24 offen sc1
  s_mov_b32 s24, s79
  s_add_u32 s79, s79, 8192
  s_waitcnt vmcnt(0)
  s_barrier
  s_branch L_tbdone
  s_cmp_lg_u32 s13, 0
  s_cbranch_scc1 L_tbdone
  v_mov_b32 v11, 64
  s_mov_b64 exec, 1
  buffer_store_dword v11, off, s[4:7], s59 sc1
  s_branch L_tbdone
L_tbdone:
  v_lshrrev_b32 v0, 4, v0
  s_lshl_b32 s84, s13, 6
  v_add_u32 v0, s84, v0
  s_lshl_b32 s84, s12, 2
  s_add_u32 s84, s84, 0x111500
  v_mov_b32 v1, 1
  s_mov_b64 exec, 1
  buffer_store_dword v1, off, s[4:7], s84 sc1
  s_mov_b64 exec, -1
  s_branch L_op
L_recend:
  s_endpgm
L_worker:
  s_lshr_b32 s30, s85, 5
  s_and_b32 s32, s85, 31
  s_mov_b32 s31, 0
  s_cmp_eq_u32 s30, 3
  s_cbranch_scc1 L_end
  s_cmp_lt_u32 s30, 3
  s_cbranch_scc1 L_proj
  s_sub_u32 s12, s85, 128
  s_cmp_lg_u32 s13, 0
  s_cbranch_scc1 L_cd1_ok
  s_mov_b32 s15, 0
L_cd0_w:
  buffer_load_dword v1, off, s[48:51], 0 offset:16 sc1
  s_waitcnt vmcnt(0)
  v_cmp_gt_u32 vcc, 32, v1
  s_cbranch_vccz L_cd0_ok
  s_add_u32 s15, s15, 1
  s_sleep 8
  s_cmp_lt_u32 s15, 0x20000
  s_cbranch_scc1 L_cd0_w
  s_branch L_end
L_cd0_ok:
  v_and_b32 v2, 31, v0
  v_lshlrev_b32 v2, 2, v2
  s_mov_b32 s84, 0x111500
  s_mov_b32 s15, 0
L_cd1_w:
  buffer_load_dword v1, v2, s[4:7], s84 offen sc1
  s_waitcnt vmcnt(0)
  v_cmp_gt_u32 vcc, 1, v1
  s_cbranch_vccz L_cd1_ok
  s_add_u32 s15, s15, 1
  s_sleep 16
  s_cmp_lt_u32 s15, 0x20000
  s_cbranch_scc1 L_cd1_w
  s_branch L_end
L_cd1_ok:
  s_barrier
  s_branch L_conv
L_idle:
  s_mov_b32 s15, 0
L_id_w:
  buffer_load_dword v1, off, s[48:51], 0 offset:16 sc1
  s_waitcnt vmcnt(0)
  v_cmp_gt_u32 vcc, 32, v1
  s_cbranch_vccz L_id_ok
  s_add_u32 s15, s15, 1
  s_sleep 8
  s_cmp_lt_u32 s15, 0x20000
  s_cbranch_scc1 L_id_w
  s_branch L_end
L_id_ok:
  s_branch L_op
L_proj:
  v_and_b32 v1, 63, v0
  v_lshrrev_b32 v2, 4, v1
  v_and_b32 v3, 15, v1
  v_and_b32 v4, 3, v1
  v_bfe_u32 v5, v1, 2, 2
  s_lshl_b32 s26, s30, 3
  s_add_u32 s26, s26, 64
  s_load_dwordx2 s[8:9], s[0:1], s26
  s_mov_b32 s10, 0x400000
  s_mov_b32 s11, 0x20000
  s_load_dwordx2 s[16:17], s[0:1], 0
  s_mov_b32 s18, 0x200000
  s_mov_b32 s19, 0x20000
  s_lshr_b32 s27, s13, 1
  s_lshl_b32 s27, s27, 3
  v_lshlrev_b32 v6, 1, v2
  v_xor_b32 v6, s27, v6
  v_xor_b32 v6, v6, v3
  v_lshlrev_b32 v6, 4, v6
  v_lshl_add_u32 v8, v2, 13, v6
  s_lshl_b32 s28, s32, 8
  s_lshl_b32 s29, s13, 15
  s_add_u32 s28, s28, s29
  s_lshl_b32 s29, s13, 10
  s_waitcnt lgkmcnt(0)
  s_mov_b32 s26, 0
L_pj_wl:
  s_mov_b32 m0, s29
  s_add_u32 s29, s29, 4096
  buffer_load_dwordx4 v8, s[8:11], s28 offen lds
  s_add_u32 s28, s28, 0x20000
  s_add_u32 s26, s26, 1
  s_cmp_lt_u32 s26, 32
  s_cbranch_scc1 L_pj_wl
  v_lshl_add_u32 v6, v2, 3, v5
  v_lshlrev_b32 v9, 8, v6
  v_and_b32 v6, 1, v2
  v_lshl_add_u32 v6, v6, 2, v5
  v_lshlrev_b32 v6, 5, v6
  s_cmp_eq_u32 s30, 1
  s_cselect_b32 s26, 4, 3
  s_cselect_b32 s27, 8, 32
  v_lshlrev_b32 v7, s26, v4
  s_lshl_b32 s28, s13, 6
  v_add_u32 v7, s28, v7
  v_xor_b32 v7, v7, v6
  v_add_u32 v9, v9, v7
  s_lshl_b32 s28, s13, 2
  s_add_u32 s29, s28, 0
  v_xor_b32 v6, s29, v1
  v_lshlrev_b32 v10, 4, v6
  s_add_u32 s29, s28, 1
  v_xor_b32 v6, s29, v1
  v_lshlrev_b32 v11, 4, v6
  s_add_u32 s29, s28, 2
  v_xor_b32 v6, s29, v1
  v_lshlrev_b32 v12, 4, v6
  s_add_u32 s29, s28, 3
  v_xor_b32 v6, s29, v1
  v_lshlrev_b32 v13, 4, v6
  v_lshl_add_u32 v6, v5, 3, v4
  v_lshlrev_b32 v6, 10, v6
  v_xor_b32 v7, v2, v3
  v_lshl_add_u32 v6, v7, 4, v6
  v_xor_b32 v14, 0, v6
  v_xor_b32 v15, 64, v6
  v_xor_b32 v16, 128, v6
  v_xor_b32 v17, 192, v6
  v_lshlrev_b32 v6, 4, v1
  s_lshl_b32 s28, s13, 11
  v_add_u32 v18, s28, v6
  s_cmp_lg_u32 s30, 0
  s_cselect_b32 s39, 4, 1
  s_cbranch_scc1 L_pj_nq
  v_lshlrev_b32 v6, 11, v2
  v_lshl_add_u32 v6, v3, 4, v6
  s_lshl_b32 s28, s13, 9
  v_add_u32 v18, s28, v6
L_pj_nq:
  s_lshl_b32 s39, s39, 8
  s_mul_i32 s36, s32, 1572864
  s_mul_i32 s28, s31, 24576
  s_add_u32 s36, s36, s28
  s_lshl_b32 s28, s30, 13
  s_add_u32 s36, s36, s28
  s_add_u32 s36, s36, 0x1000000
  s_lshl_b32 s37, s32, 7
  s_lshl_b32 s28, s30, 5
  s_add_u32 s37, s37, s28
  s_lshl_b32 s28, s31, 4
  s_add_u32 s37, s37, s28
  s_add_u32 s37, s37, 0x110000
  v_cmp_eq_u32 vcc, 0, v0
  v_mov_b32 v6, 0x80000000
  s_nop 0
  v_cndmask_b32 v19, v6, 0, vcc
  s_lshl_b32 s34, s31, 15
  s_lshl_b32 s28, s13, 13
  s_add_u32 s34, s34, s28
  s_add_u32 s35, s28, 0x20000
  s_add_u32 m0, s35, 0
  s_add_u32 s29, s34, 0
  buffer_load_dwordx4 v10, s[16:19], s29 offen offset:0 lds
  buffer_load_dwordx4 v11, s[16:19], s29 offen offset:1024 lds
  buffer_load_dwordx4 v12, s[16:19], s29 offen offset:2048 lds
  buffer_load_dwordx4 v13, s[16:19], s29 offen offset:3072 lds
  s_add_u32 m0, s35, 4096
  s_add_u32 s29, s34, 4096
  buffer_load_dwordx4 v10, s[16:19], s29 offen offset:0 lds
  buffer_load_dwordx4 v11, s[16:19], s29 offen offset:1024 lds
  buffer_load_dwordx4 v12, s[16:19], s29 offen offset:2048 lds
  buffer_load_dwordx4 v13, s[16:19], s29 offen offset:3072 lds
  s_add_u32 s34, s34, 0x8000
  s_add_u32 s35, s35, 0x8000
  s_bitset0_b32 s35, 17
  s_load_dwordx2 s[20:21], s[0:1], 56
  s_mov_b32 s22, 0x2000
  s_mov_b32 s23, 0x20000
  s_waitcnt lgkmcnt(0)
  s_lshl_b32 s26, s13, 1
  s_lshl_b32 s28, s13, 11
  s_add_u32 s29, s26, 0
  s_and_b32 s29, s29, 3
  v_xor_b32 v6, s29, v1
  v_lshlrev_b32 v6, 4, v6
  buffer_load_dwordx4 v[84:87], v6, s[20:23], s28 offen offset:0
  s_add_u32 s29, s26, 1
  s_and_b32 s29, s29, 3
  v_xor_b32 v6, s29, v1
  v_lshlrev_b32 v6, 4, v6
  buffer_load_dwordx4 v[88:91], v6, s[20:23], s28 offen offset:1024
  v_add_u32 v80, 0x18000, v14
  v_add_u32 v14, 0x20000, v14
  v_add_u32 v81, 0x18000, v15
  v_add_u32 v15, 0x20000, v15
  v_add_u32 v82, 0x18000, v16
  v_add_u32 v16, 0x20000, v16
  v_add_u32 v83, 0x18000, v17
  v_add_u32 v17, 0x20000, v17
  v_lshlrev_b32 v22, 4, v1
  s_add_u32 s28, s28, 0x18000
  v_add_u32 v22, s28, v22
  s_waitcnt vmcnt(0)
  s_barrier
  buffer_load_dword v20, off, s[48:51], 0 offset:16 sc1
  v_xor_b32 v6, s27, v9
  v_add_u32 v7, 0x10000, v9
  v_add_u32 v21, 0x10000, v6
  ds_read_b64_tr_b16 v[128:129], v9 offset:0
  ds_read_b64_tr_b16 v[130:131], v9 offset:1024
  ds_read_b64_tr_b16 v[132:133], v6 offset:0
  ds_read_b64_tr_b16 v[134:135], v6 offset:1024
  ds_read_b64_tr_b16 v[136:137], v9 offset:8192
  ds_read_b64_tr_b16 v[138:139], v9 offset:9216
  ds_read_b64_tr_b16 v[140:141], v6 offset:8192
  ds_read_b64_tr_b16 v[142:143], v6 offset:9216
  ds_read_b64_tr_b16 v[144:145], v9 offset:16384
  ds_read_b64_tr_b16 v[146:147], v9 offset:17408
  ds_read_b64_tr_b16 v[148:149], v6 offset:16384
  ds_read_b64_tr_b16 v[150:151], v6 offset:17408
  ds_read_b64_tr_b16 v[152:153], v9 offset:24576
  ds_read_b64_tr_b16 v[154:155], v9 offset:25600
  ds_read_b64_tr_b16 v[156:157], v6 offset:24576
  ds_read_b64_tr_b16 v[158:159], v6 offset:25600
  ds_read_b64_tr_b16 v[160:161], v9 offset:32768
  ds_read_b64_tr_b16 v[162:163], v9 offset:33792
  ds_read_b64_tr_b16 v[164:165], v6 offset:32768
  ds_read_b64_tr_b16 v[166:167], v6 offset:33792
  ds_read_b64_tr_b16 v[168:169], v9 offset:40960
  ds_read_b64_tr_b16 v[170:171], v9 offset:41984
  ds_read_b64_tr_b16 v[172:173], v6 offset:40960
  ds_read_b64_tr_b16 v[174:175], v6 offset:41984
  ds_read_b64_tr_b16 v[176:177], v9 offset:49152
  ds_read_b64_tr_b16 v[178:179], v9 offset:50176
  ds_read_b64_tr_b16 v[180:181], v6 offset:49152
  ds_read_b64_tr_b16 v[182:183], v6 offset:50176
  ds_read_b64_tr_b16 v[184:185], v9 offset:57344
  ds_read_b64_tr_b16 v[186:187], v9 offset:58368
  ds_read_b64_tr_b16 v[188:189], v6 offset:57344
  ds_read_b64_tr_b16 v[190:191], v6 offset:58368
  ds_read_b64_tr_b16 v[192:193], v7 offset:0
  ds_read_b64_tr_b16 v[194:195], v7 offset:1024
  ds_read_b64_tr_b16 v[196:197], v21 offset:0
  ds_read_b64_tr_b16 v[198:199], v21 offset:1024
  ds_read_b64_tr_b16 v[200:201], v7 offset:8192
  ds_read_b64_tr_b16 v[202:203], v7 offset:9216
  ds_read_b64_tr_b16 v[204:205], v21 offset:8192
  ds_read_b64_tr_b16 v[206:207], v21 offset:9216
  ds_read_b64_tr_b16 v[208:209], v7 offset:16384
  ds_read_b64_tr_b16 v[210:211], v7 offset:17408
  ds_read_b64_tr_b16 v[212:213], v21 offset:16384
  ds_read_b64_tr_b16 v[214:215], v21 offset:17408
  ds_read_b64_tr_b16 v[216:217], v7 offset:24576
  ds_read_b64_tr_b16 v[218:219], v7 offset:25600
  ds_read_b64_tr_b16 v[220:221], v21 offset:24576
  ds_read_b64_tr_b16 v[222:223], v21 offset:25600
  ds_read_b64_tr_b16 v[224:225], v7 offset:32768
  ds_read_b64_tr_b16 v[226:227], v7 offset:33792
  ds_read_b64_tr_b16 v[228:229], v21 offset:32768
  ds_read_b64_tr_b16 v[230:231], v21 offset:33792
  ds_read_b64_tr_b16 v[232:233], v7 offset:40960
  ds_read_b64_tr_b16 v[234:235], v7 offset:41984
  ds_read_b64_tr_b16 v[236:237], v21 offset:40960
  ds_read_b64_tr_b16 v[238:239], v21 offset:41984
  ds_read_b64_tr_b16 v[240:241], v7 offset:49152
  ds_read_b64_tr_b16 v[242:243], v7 offset:50176
  ds_read_b64_tr_b16 v[244:245], v21 offset:49152
  ds_read_b64_tr_b16 v[246:247], v21 offset:50176
  ds_read_b64_tr_b16 v[248:249], v7 offset:57344
  ds_read_b64_tr_b16 v[250:251], v7 offset:58368
  ds_read_b64_tr_b16 v[252:253], v21 offset:57344
  ds_read_b64_tr_b16 v[254:255], v21 offset:58368
  s_waitcnt lgkmcnt(0)
  s_barrier
  ds_write_b128 v22, v[84:87]
  ds_write_b128 v22, v[88:91] offset:1024
  s_waitcnt vmcnt(0)
  v_cmp_gt_u32 vcc, 32, v20
  s_cbranch_vccz L_pj_ok0
  s_mov_b32 s15, 0
L_pj_w:
  buffer_load_dword v20, off, s[48:51], 0 offset:16 sc1
  s_waitcnt vmcnt(0)
  v_cmp_gt_u32 vcc, 32, v20
  s_cbranch_vccz L_pj_ok
  s_add_u32 s15, s15, 1
  s_sleep 8
  s_cmp_lt_u32 s15, 0x20000
  s_cbranch_scc1 L_pj_w
  s_branch L_end
L_pj_ok:
L_pj_ok0:
  s_add_u32 m0, s35, 0
  s_add_u32 s29, s34, 0
  buffer_load_dwordx4 v10, s[16:19], s29 offen offset:0 lds
  buffer_load_dwordx4 v11, s[16:19], s29 offen offset:1024 lds
  buffer_load_dwordx4 v12, s[16:19], s29 offen offset:2048 lds
  buffer_load_dwordx4 v13, s[16:19], s29 offen offset:3072 lds
  s_add_u32 m0, s35, 4096
  s_add_u32 s29, s34, 4096
  buffer_load_dwordx4 v10, s[16:19], s29 offen offset:0 lds
  buffer_load_dwordx4 v11, s[16:19], s29 offen offset:1024 lds
  buffer_load_dwordx4 v12, s[16:19], s29 offen offset:2048 lds
  buffer_load_dwordx4 v13, s[16:19], s29 offen offset:3072 lds
  s_add_u32 s34, s34, 0x8000
  s_add_u32 s35, s35, 0x8000
  s_bitset0_b32 s35, 17
  s_add_u32 m0, s35, 0
  s_add_u32 s29, s34, 0
  buffer_load_dwordx4 v10, s[16:19], s29 offen offset:0 lds
  buffer_load_dwordx4 v11, s[16:19], s29 offen offset:1024 lds
  buffer_load_dwordx4 v12, s[16:19], s29 offen offset:2048 lds
  buffer_load_dwordx4 v13, s[16:19], s29 offen offset:3072 lds
  s_add_u32 m0, s35, 4096
  s_add_u32 s29, s34, 4096
  buffer_load_dwordx4 v10, s[16:19], s29 offen offset:0 lds
  buffer_load_dwordx4 v11, s[16:19], s29 offen offset:1024 lds
  buffer_load_dwordx4 v12, s[16:19], s29 offen offset:2048 lds
  buffer_load_dwordx4 v13, s[16:19], s29 offen offset:3072 lds
  s_add_u32 s34, s34, 0x8000
  s_add_u32 s35, s35, 0x8000
  s_bitset0_b32 s35, 17
  s_waitcnt lgkmcnt(0)
  s_cmp_lg_u32 s31, 0
  s_cbranch_scc1 L_pj_ne1
  s_barrier
  ds_read_b128 v[48:51], v80 offset:0
  ds_read_b128 v[52:55], v80 offset:4096
  ds_read_b128 v[56:59], v81 offset:0
  ds_read_b128 v[60:63], v81 offset:4096
  ds_read_b128 v[64:67], v82 offset:0
  ds_read_b128 v[68:71], v82 offset:4096
  ds_read_b128 v[72:75], v83 offset:0
  ds_read_b128 v[76:79], v83 offset:4096
  s_waitcnt lgkmcnt(7)
  v_mfma_f32_16x16x32_bf16 v[24:27], v[48:51], v[128:131], 0
  v_mfma_f32_16x16x32_bf16 v[32:35], v[48:51], v[132:135], 0
  s_waitcnt lgkmcnt(6)
  v_mfma_f32_16x16x32_bf16 v[28:31], v[52:55], v[128:131], 0
  v_mfma_f32_16x16x32_bf16 v[36:39], v[52:55], v[132:135], 0
  s_waitcnt lgkmcnt(5)
  v_mfma_f32_16x16x32_bf16 v[24:27], v[56:59], v[136:139], v[24:27]
  v_mfma_f32_16x16x32_bf16 v[32:35], v[56:59], v[140:143], v[32:35]
  s_waitcnt lgkmcnt(4)
  v_mfma_f32_16x16x32_bf16 v[28:31], v[60:63], v[136:139], v[28:31]
  v_mfma_f32_16x16x32_bf16 v[36:39], v[60:63], v[140:143], v[36:39]
  s_waitcnt lgkmcnt(3)
  v_mfma_f32_16x16x32_bf16 v[24:27], v[64:67], v[144:147], v[24:27]
  v_mfma_f32_16x16x32_bf16 v[32:35], v[64:67], v[148:151], v[32:35]
  s_waitcnt lgkmcnt(2)
  v_mfma_f32_16x16x32_bf16 v[28:31], v[68:71], v[144:147], v[28:31]
  v_mfma_f32_16x16x32_bf16 v[36:39], v[68:71], v[148:151], v[36:39]
  s_waitcnt lgkmcnt(1)
  v_mfma_f32_16x16x32_bf16 v[24:27], v[72:75], v[152:155], v[24:27]
  v_mfma_f32_16x16x32_bf16 v[32:35], v[72:75], v[156:159], v[32:35]
  s_waitcnt lgkmcnt(0)
  v_mfma_f32_16x16x32_bf16 v[28:31], v[76:79], v[152:155], v[28:31]
  v_mfma_f32_16x16x32_bf16 v[36:39], v[76:79], v[156:159], v[36:39]
  ds_read_b128 v[48:51], v80 offset:256
  ds_read_b128 v[52:55], v80 offset:4352
  ds_read_b128 v[56:59], v81 offset:256
  ds_read_b128 v[60:63], v81 offset:4352
  ds_read_b128 v[64:67], v82 offset:256
  ds_read_b128 v[68:71], v82 offset:4352
  ds_read_b128 v[72:75], v83 offset:256
  ds_read_b128 v[76:79], v83 offset:4352
  s_waitcnt lgkmcnt(7)
  v_mfma_f32_16x16x32_bf16 v[24:27], v[48:51], v[160:163], v[24:27]
  v_mfma_f32_16x16x32_bf16 v[32:35], v[48:51], v[164:167], v[32:35]
  s_waitcnt lgkmcnt(6)
  v_mfma_f32_16x16x32_bf16 v[28:31], v[52:55], v[160:163], v[28:31]
  v_mfma_f32_16x16x32_bf16 v[36:39], v[52:55], v[164:167], v[36:39]
  s_waitcnt lgkmcnt(5)
  v_mfma_f32_16x16x32_bf16 v[24:27], v[56:59], v[168:171], v[24:27]
  v_mfma_f32_16x16x32_bf16 v[32:35], v[56:59], v[172:175], v[32:35]
  s_waitcnt lgkmcnt(4)
  v_mfma_f32_16x16x32_bf16 v[28:31], v[60:63], v[168:171], v[28:31]
  v_mfma_f32_16x16x32_bf16 v[36:39], v[60:63], v[172:175], v[36:39]
  s_waitcnt lgkmcnt(3)
  v_mfma_f32_16x16x32_bf16 v[24:27], v[64:67], v[176:179], v[24:27]
  v_mfma_f32_16x16x32_bf16 v[32:35], v[64:67], v[180:183], v[32:35]
  s_waitcnt lgkmcnt(2)
  v_mfma_f32_16x16x32_bf16 v[28:31], v[68:71], v[176:179], v[28:31]
  v_mfma_f32_16x16x32_bf16 v[36:39], v[68:71], v[180:183], v[36:39]
  s_waitcnt lgkmcnt(1)
  v_mfma_f32_16x16x32_bf16 v[24:27], v[72:75], v[184:187], v[24:27]
  v_mfma_f32_16x16x32_bf16 v[32:35], v[72:75], v[188:191], v[32:35]
  s_waitcnt lgkmcnt(0)
  v_mfma_f32_16x16x32_bf16 v[28:31], v[76:79], v[184:187], v[28:31]
  v_mfma_f32_16x16x32_bf16 v[36:39], v[76:79], v[188:191], v[36:39]
  ds_read_b128 v[48:51], v80 offset:512
  ds_read_b128 v[52:55], v80 offset:4608
  ds_read_b128 v[56:59], v81 offset:512
  ds_read_b128 v[60:63], v81 offset:4608
  ds_read_b128 v[64:67], v82 offset:512
  ds_read_b128 v[68:71], v82 offset:4608
  ds_read_b128 v[72:75], v83 offset:512
  ds_read_b128 v[76:79], v83 offset:4608
  s_waitcnt lgkmcnt(7)
  v_mfma_f32_16x16x32_bf16 v[24:27], v[48:51], v[192:195], v[24:27]
  v_mfma_f32_16x16x32_bf16 v[32:35], v[48:51], v[196:199], v[32:35]
  s_waitcnt lgkmcnt(6)
  v_mfma_f32_16x16x32_bf16 v[28:31], v[52:55], v[192:195], v[28:31]
  v_mfma_f32_16x16x32_bf16 v[36:39], v[52:55], v[196:199], v[36:39]
  s_waitcnt lgkmcnt(5)
  v_mfma_f32_16x16x32_bf16 v[24:27], v[56:59], v[200:203], v[24:27]
  v_mfma_f32_16x16x32_bf16 v[32:35], v[56:59], v[204:207], v[32:35]
  s_waitcnt lgkmcnt(4)
  v_mfma_f32_16x16x32_bf16 v[28:31], v[60:63], v[200:203], v[28:31]
  v_mfma_f32_16x16x32_bf16 v[36:39], v[60:63], v[204:207], v[36:39]
  s_waitcnt lgkmcnt(3)
  v_mfma_f32_16x16x32_bf16 v[24:27], v[64:67], v[208:211], v[24:27]
  v_mfma_f32_16x16x32_bf16 v[32:35], v[64:67], v[212:215], v[32:35]
  s_waitcnt lgkmcnt(2)
  v_mfma_f32_16x16x32_bf16 v[28:31], v[68:71], v[208:211], v[28:31]
  v_mfma_f32_16x16x32_bf16 v[36:39], v[68:71], v[212:215], v[36:39]
  s_waitcnt lgkmcnt(1)
  v_mfma_f32_16x16x32_bf16 v[24:27], v[72:75], v[216:219], v[24:27]
  v_mfma_f32_16x16x32_bf16 v[32:35], v[72:75], v[220:223], v[32:35]
  s_waitcnt lgkmcnt(0)
  v_mfma_f32_16x16x32_bf16 v[28:31], v[76:79], v[216:219], v[28:31]
  v_mfma_f32_16x16x32_bf16 v[36:39], v[76:79], v[220:223], v[36:39]
  ds_read_b128 v[48:51], v80 offset:768
  ds_read_b128 v[52:55], v80 offset:4864
  ds_read_b128 v[56:59], v81 offset:768
  ds_read_b128 v[60:63], v81 offset:4864
  ds_read_b128 v[64:67], v82 offset:768
  ds_read_b128 v[68:71], v82 offset:4864
  ds_read_b128 v[72:75], v83 offset:768
  ds_read_b128 v[76:79], v83 offset:4864
  s_waitcnt lgkmcnt(7)
  v_mfma_f32_16x16x32_bf16 v[24:27], v[48:51], v[224:227], v[24:27]
  v_mfma_f32_16x16x32_bf16 v[32:35], v[48:51], v[228:231], v[32:35]
  s_waitcnt lgkmcnt(6)
  v_mfma_f32_16x16x32_bf16 v[28:31], v[52:55], v[224:227], v[28:31]
  v_mfma_f32_16x16x32_bf16 v[36:39], v[52:55], v[228:231], v[36:39]
  s_waitcnt lgkmcnt(5)
  v_mfma_f32_16x16x32_bf16 v[24:27], v[56:59], v[232:235], v[24:27]
  v_mfma_f32_16x16x32_bf16 v[32:35], v[56:59], v[236:239], v[32:35]
  s_waitcnt lgkmcnt(4)
  v_mfma_f32_16x16x32_bf16 v[28:31], v[60:63], v[232:235], v[28:31]
  v_mfma_f32_16x16x32_bf16 v[36:39], v[60:63], v[236:239], v[36:39]
  s_waitcnt lgkmcnt(3)
  v_mfma_f32_16x16x32_bf16 v[24:27], v[64:67], v[240:243], v[24:27]
  v_mfma_f32_16x16x32_bf16 v[32:35], v[64:67], v[244:247], v[32:35]
  s_waitcnt lgkmcnt(2)
  v_mfma_f32_16x16x32_bf16 v[28:31], v[68:71], v[240:243], v[28:31]
  v_mfma_f32_16x16x32_bf16 v[36:39], v[68:71], v[244:247], v[36:39]
  s_waitcnt lgkmcnt(1)
  v_mfma_f32_16x16x32_bf16 v[24:27], v[72:75], v[248:251], v[24:27]
  v_mfma_f32_16x16x32_bf16 v[32:35], v[72:75], v[252:255], v[32:35]
  s_waitcnt lgkmcnt(0)
  v_mfma_f32_16x16x32_bf16 v[28:31], v[76:79], v[248:251], v[28:31]
  v_mfma_f32_16x16x32_bf16 v[36:39], v[76:79], v[252:255], v[36:39]
  v_lshl_add_u32 v6, v5, 3, v4
  s_cmp_eq_u32 s30, 1
  s_cselect_b64 vcc, -1, 0
  s_cselect_b32 s28, 64, 256
  v_cndmask_b32 v6, v3, v6, vcc
  v_lshlrev_b32 v6, 4, v6
  v_cmp_gt_u32 vcc, 16, v1
  v_mov_b32 v7, 0x80000000
  s_mul_i32 s26, s32, 3
  s_add_u32 s26, s26, s30
  s_lshl_b32 s26, s26, 11
  v_cndmask_b32 v6, v7, v6, vcc
  s_lshl_b32 s29, s13, 9
  s_add_u32 s26, s26, s29
  s_add_u32 s26, s26, 0x140000
  s_add_u32 s28, s28, s26
  v_cvt_pk_bf16_f32 v40, v24, v25
  v_cvt_pk_bf16_f32 v41, v26, v27
  v_cvt_pk_bf16_f32 v42, v28, v29
  v_cvt_pk_bf16_f32 v43, v30, v31
  v_cvt_pk_bf16_f32 v44, v32, v33
  v_cvt_pk_bf16_f32 v45, v34, v35
  v_cvt_pk_bf16_f32 v46, v36, v37
  v_cvt_pk_bf16_f32 v47, v38, v39
  buffer_store_dwordx4 v[40:43], v6, s[4:7], s26 offen sc1
  buffer_store_dwordx4 v[44:47], v6, s[4:7], s28 offen sc1
L_pj_ne1:
  s_mov_b32 s38, 0
  s_cmp_eq_u32 s30, 1
  s_cbranch_scc1 L_pj_loop1
L_pj_loop0:
  s_waitcnt vmcnt(22)
  s_barrier
  s_max_i32 s26, s38, 2
  s_sub_u32 s26, s26, 2
  s_min_u32 s28, s38, 1
  s_max_u32 s26, s26, s28
  v_mov_b32 v20, s26
  ds_read_b128 v[48:51], v14 offset:0
  ds_read_b128 v[52:55], v14 offset:4096
  ds_read_b128 v[56:59], v15 offset:0
  ds_read_b128 v[60:63], v15 offset:4096
  ds_read_b128 v[64:67], v16 offset:0
  ds_read_b128 v[68:71], v16 offset:4096
  ds_read_b128 v[72:75], v17 offset:0
  ds_read_b128 v[76:79], v17 offset:4096
  s_waitcnt lgkmcnt(7)
  v_mfma_f32_16x16x32_bf16 v[24:27], v[48:51], v[128:131], 0
  v_mfma_f32_16x16x32_bf16 v[32:35], v[48:51], v[132:135], 0
  buffer_store_dword v20, v19, s[4:7], s37 offen sc1
  ds_read_b128 v[48:51], v14 offset:256
  s_waitcnt lgkmcnt(7)
  v_mfma_f32_16x16x32_bf16 v[28:31], v[52:55], v[128:131], 0
  v_mfma_f32_16x16x32_bf16 v[36:39], v[52:55], v[132:135], 0
  ds_read_b128 v[52:55], v14 offset:4352
  s_waitcnt lgkmcnt(7)
  v_mfma_f32_16x16x32_bf16 v[24:27], v[56:59], v[136:139], v[24:27]
  v_mfma_f32_16x16x32_bf16 v[32:35], v[56:59], v[140:143], v[32:35]
  s_add_u32 m0, s35, 0
  s_add_u32 s29, s34, 0
  buffer_load_dwordx4 v10, s[16:19], s29 offen offset:0 lds
  ds_read_b128 v[56:59], v15 offset:256
  s_waitcnt lgkmcnt(7)
  v_mfma_f32_16x16x32_bf16 v[28:31], v[60:63], v[136:139], v[28:31]
  v_mfma_f32_16x16x32_bf16 v[36:39], v[60:63], v[140:143], v[36:39]
  ds_read_b128 v[60:63], v15 offset:4352
  s_waitcnt lgkmcnt(7)
  v_mfma_f32_16x16x32_bf16 v[24:27], v[64:67], v[144:147], v[24:27]
  v_mfma_f32_16x16x32_bf16 v[32:35], v[64:67], v[148:151], v[32:35]
  ds_read_b128 v[64:67], v16 offset:256
  s_waitcnt lgkmcnt(7)
  v_mfma_f32_16x16x32_bf16 v[28:31], v[68:71], v[144:147], v[28:31]
  v_mfma_f32_16x16x32_bf16 v[36:39], v[68:71], v[148:151], v[36:39]
  buffer_load_dwordx4 v11, s[16:19], s29 offen offset:1024 lds
  ds_read_b128 v[68:71], v16 offset:4352
  s_waitcnt lgkmcnt(7)
  v_mfma_f32_16x16x32_bf16 v[24:27], v[72:75], v[152:155], v[24:27]
  v_mfma_f32_16x16x32_bf16 v[32:35], v[72:75], v[156:159], v[32:35]
  ds_read_b128 v[72:75], v17 offset:256
  s_waitcnt lgkmcnt(7)
  v_mfma_f32_16x16x32_bf16 v[28:31], v[76:79], v[152:155], v[28:31]
  v_mfma_f32_16x16x32_bf16 v[36:39], v[76:79], v[156:159], v[36:39]
  ds_read_b128 v[76:79], v17 offset:4352
  s_waitcnt lgkmcnt(7)
  v_mfma_f32_16x16x32_bf16 v[24:27], v[48:51], v[160:163], v[24:27]
  v_mfma_f32_16x16x32_bf16 v[32:35], v[48:51], v[164:167], v[32:35]
  buffer_load_dwordx4 v12, s[16:19], s29 offen offset:2048 lds
  ds_read_b128 v[48:51], v14 offset:512
  s_waitcnt lgkmcnt(7)
  v_mfma_f32_16x16x32_bf16 v[28:31], v[52:55], v[160:163], v[28:31]
  v_mfma_f32_16x16x32_bf16 v[36:39], v[52:55], v[164:167], v[36:39]
  ds_read_b128 v[52:55], v14 offset:4608
  s_waitcnt lgkmcnt(7)
  v_mfma_f32_16x16x32_bf16 v[24:27], v[56:59], v[168:171], v[24:27]
  v_mfma_f32_16x16x32_bf16 v[32:35], v[56:59], v[172:175], v[32:35]
  ds_read_b128 v[56:59], v15 offset:512
  s_waitcnt lgkmcnt(7)
  v_mfma_f32_16x16x32_bf16 v[28:31], v[60:63], v[168:171], v[28:31]
  v_mfma_f32_16x16x32_bf16 v[36:39], v[60:63], v[172:175], v[36:39]
  buffer_load_dwordx4 v13, s[16:19], s29 offen offset:3072 lds
  ds_read_b128 v[60:63], v15 offset:4608
  s_waitcnt lgkmcnt(7)
  v_mfma_f32_16x16x32_bf16 v[24:27], v[64:67], v[176:179], v[24:27]
  v_mfma_f32_16x16x32_bf16 v[32:35], v[64:67], v[180:183], v[32:35]
  ds_read_b128 v[64:67], v16 offset:512
  s_waitcnt lgkmcnt(7)
  v_mfma_f32_16x16x32_bf16 v[28:31], v[68:71], v[176:179], v[28:31]
  v_mfma_f32_16x16x32_bf16 v[36:39], v[68:71], v[180:183], v[36:39]
  ds_read_b128 v[68:71], v16 offset:4608
  s_waitcnt lgkmcnt(7)
  v_mfma_f32_16x16x32_bf16 v[24:27], v[72:75], v[184:187], v[24:27]
  v_mfma_f32_16x16x32_bf16 v[32:35], v[72:75], v[188:191], v[32:35]
  s_add_u32 m0, s35, 4096
  s_add_u32 s29, s34, 4096
  buffer_load_dwordx4 v10, s[16:19], s29 offen offset:0 lds
  ds_read_b128 v[72:75], v17 offset:512
  s_waitcnt lgkmcnt(7)
  v_mfma_f32_16x16x32_bf16 v[28:31], v[76:79], v[184:187], v[28:31]
  v_mfma_f32_16x16x32_bf16 v[36:39], v[76:79], v[188:191], v[36:39]
  ds_read_b128 v[76:79], v17 offset:4608
  s_waitcnt lgkmcnt(7)
  v_mfma_f32_16x16x32_bf16 v[24:27], v[48:51], v[192:195], v[24:27]
  v_mfma_f32_16x16x32_bf16 v[32:35], v[48:51], v[196:199], v[32:35]
  ds_read_b128 v[48:51], v14 offset:768
  s_waitcnt lgkmcnt(7)
  v_mfma_f32_16x16x32_bf16 v[28:31], v[52:55], v[192:195], v[28:31]
  v_mfma_f32_16x16x32_bf16 v[36:39], v[52:55], v[196:199], v[36:39]
  buffer_load_dwordx4 v11, s[16:19], s29 offen offset:1024 lds
  ds_read_b128 v[52:55], v14 offset:4864
  s_waitcnt lgkmcnt(7)
  v_mfma_f32_16x16x32_bf16 v[24:27], v[56:59], v[200:203], v[24:27]
  v_mfma_f32_16x16x32_bf16 v[32:35], v[56:59], v[204:207], v[32:35]
  ds_read_b128 v[56:59], v15 offset:768
  s_waitcnt lgkmcnt(7)
  v_mfma_f32_16x16x32_bf16 v[28:31], v[60:63], v[200:203], v[28:31]
  v_mfma_f32_16x16x32_bf16 v[36:39], v[60:63], v[204:207], v[36:39]
  ds_read_b128 v[60:63], v15 offset:4864
  s_waitcnt lgkmcnt(7)
  v_mfma_f32_16x16x32_bf16 v[24:27], v[64:67], v[208:211], v[24:27]
  v_mfma_f32_16x16x32_bf16 v[32:35], v[64:67], v[212:215], v[32:35]
  buffer_load_dwordx4 v12, s[16:19], s29 offen offset:2048 lds
  ds_read_b128 v[64:67], v16 offset:768
  s_waitcnt lgkmcnt(7)
  v_mfma_f32_16x16x32_bf16 v[28:31], v[68:71], v[208:211], v[28:31]
  v_mfma_f32_16x16x32_bf16 v[36:39], v[68:71], v[212:215], v[36:39]
  ds_read_b128 v[68:71], v16 offset:4864
  s_waitcnt lgkmcnt(7)
  v_mfma_f32_16x16x32_bf16 v[24:27], v[72:75], v[216:219], v[24:27]
  v_mfma_f32_16x16x32_bf16 v[32:35], v[72:75], v[220:223], v[32:35]
  ds_read_b128 v[72:75], v17 offset:768
  s_waitcnt lgkmcnt(7)
  v_mfma_f32_16x16x32_bf16 v[28:31], v[76:79], v[216:219], v[28:31]
  v_mfma_f32_16x16x32_bf16 v[36:39], v[76:79], v[220:223], v[36:39]
  buffer_load_dwordx4 v13, s[16:19], s29 offen offset:3072 lds
  s_add_u32 s34, s34, 0x8000
  s_add_u32 s35, s35, 0x8000
  s_bitset0_b32 s35, 17
  ds_read_b128 v[76:79], v17 offset:4864
  s_waitcnt lgkmcnt(7)
  v_mfma_f32_16x16x32_bf16 v[24:27], v[48:51], v[224:227], v[24:27]
  v_mfma_f32_16x16x32_bf16 v[32:35], v[48:51], v[228:231], v[32:35]
  s_waitcnt lgkmcnt(6)
  v_mfma_f32_16x16x32_bf16 v[28:31], v[52:55], v[224:227], v[28:31]
  v_mfma_f32_16x16x32_bf16 v[36:39], v[52:55], v[228:231], v[36:39]
  s_waitcnt lgkmcnt(5)
  v_mfma_f32_16x16x32_bf16 v[24:27], v[56:59], v[232:235], v[24:27]
  v_mfma_f32_16x16x32_bf16 v[32:35], v[56:59], v[236:239], v[32:35]
  s_waitcnt lgkmcnt(4)
  v_mfma_f32_16x16x32_bf16 v[28:31], v[60:63], v[232:235], v[28:31]
  v_mfma_f32_16x16x32_bf16 v[36:39], v[60:63], v[236:239], v[36:39]
  s_waitcnt lgkmcnt(3)
  v_mfma_f32_16x16x32_bf16 v[24:27], v[64:67], v[240:243], v[24:27]
  v_mfma_f32_16x16x32_bf16 v[32:35], v[64:67], v[244:247], v[32:35]
  s_waitcnt lgkmcnt(2)
  v_mfma_f32_16x16x32_bf16 v[28:31], v[68:71], v[240:243], v[28:31]
  v_mfma_f32_16x16x32_bf16 v[36:39], v[68:71], v[244:247], v[36:39]
  s_waitcnt lgkmcnt(1)
  v_mfma_f32_16x16x32_bf16 v[24:27], v[72:75], v[248:251], v[24:27]
  v_mfma_f32_16x16x32_bf16 v[32:35], v[72:75], v[252:255], v[32:35]
  s_waitcnt lgkmcnt(0)
  v_mfma_f32_16x16x32_bf16 v[28:31], v[76:79], v[248:251], v[28:31]
  v_mfma_f32_16x16x32_bf16 v[36:39], v[76:79], v[252:255], v[36:39]
  v_add_u32 v14, 0x8000, v14
  v_and_b32 v14, 0x1ffff, v14
  v_add_u32 v15, 0x8000, v15
  v_and_b32 v15, 0x1ffff, v15
  v_add_u32 v16, 0x8000, v16
  v_and_b32 v16, 0x1ffff, v16
  v_add_u32 v17, 0x8000, v17
  v_and_b32 v17, 0x1ffff, v17
  v_cvt_pk_bf16_f32 v40, v24, v25
  v_cvt_pk_bf16_f32 v41, v26, v27
  v_cvt_pk_bf16_f32 v42, v28, v29
  v_cvt_pk_bf16_f32 v43, v30, v31
  v_cvt_pk_bf16_f32 v44, v32, v33
  v_cvt_pk_bf16_f32 v45, v34, v35
  v_cvt_pk_bf16_f32 v46, v36, v37
  v_cvt_pk_bf16_f32 v47, v38, v39
  s_add_u32 s28, s36, s39
  buffer_store_dwordx4 v[40:43], v18, s[4:7], s36 offen sc1
  buffer_store_dwordx4 v[44:47], v18, s[4:7], s28 offen sc1
  s_add_u32 s36, s36, 24576
  s_cmp_ge_u32 s38, 1
  s_cbranch_scc1 L_pj_nf0
  s_add_u32 s26, s38, 1
  s_waitcnt vmcnt(0)
  s_barrier
  v_mov_b32 v20, s26
  buffer_store_dword v20, v19, s[4:7], s37 offen sc1
L_pj_nf0:
  s_add_u32 s38, s38, 1
  s_cmp_lt_u32 s38, 64
  s_cbranch_scc1 L_pj_loop0
  s_branch L_pj_end
L_pj_loop1:
  s_waitcnt vmcnt(22)
  s_barrier
  s_max_i32 s26, s38, 2
  s_sub_u32 s26, s26, 2
  s_min_u32 s28, s38, 1
  s_max_u32 s26, s26, s28
  v_mov_b32 v20, s26
  ds_read_b128 v[48:51], v14 offset:0
  ds_read_b128 v[52:55], v14 offset:4096
  ds_read_b128 v[56:59], v15 offset:0
  ds_read_b128 v[60:63], v15 offset:4096
  ds_read_b128 v[64:67], v16 offset:0
  ds_read_b128 v[68:71], v16 offset:4096
  ds_read_b128 v[72:75], v17 offset:0
  ds_read_b128 v[76:79], v17 offset:4096
  s_waitcnt lgkmcnt(7)
  v_mfma_f32_16x16x32_bf16 v[24:27], v[128:131], v[48:51], 0
  v_mfma_f32_16x16x32_bf16 v[32:35], v[132:135], v[48:51], 0
  buffer_store_dword v20, v19, s[4:7], s37 offen sc1
  ds_read_b128 v[48:51], v14 offset:256
  s_waitcnt lgkmcnt(7)
  v_mfma_f32_16x16x32_bf16 v[28:31], v[128:131], v[52:55], 0
  v_mfma_f32_16x16x32_bf16 v[36:39], v[132:135], v[52:55], 0
  ds_read_b128 v[52:55], v14 offset:4352
  s_waitcnt lgkmcnt(7)
  v_mfma_f32_16x16x32_bf16 v[24:27], v[136:139], v[56:59], v[24:27]
  v_mfma_f32_16x16x32_bf16 v[32:35], v[140:143], v[56:59], v[32:35]
  s_add_u32 m0, s35, 0
  s_add_u32 s29, s34, 0
  buffer_load_dwordx4 v10, s[16:19], s29 offen offset:0 lds
  ds_read_b128 v[56:59], v15 offset:256
  s_waitcnt lgkmcnt(7)
  v_mfma_f32_16x16x32_bf16 v[28:31], v[136:139], v[60:63], v[28:31]
  v_mfma_f32_16x16x32_bf16 v[36:39], v[140:143], v[60:63], v[36:39]
  ds_read_b128 v[60:63], v15 offset:4352
  s_waitcnt lgkmcnt(7)
  v_mfma_f32_16x16x32_bf16 v[24:27], v[144:147], v[64:67], v[24:27]
  v_mfma_f32_16x16x32_bf16 v[32:35], v[148:151], v[64:67], v[32:35]
  ds_read_b128 v[64:67], v16 offset:256
  s_waitcnt lgkmcnt(7)
  v_mfma_f32_16x16x32_bf16 v[28:31], v[144:147], v[68:71], v[28:31]
  v_mfma_f32_16x16x32_bf16 v[36:39], v[148:151], v[68:71], v[36:39]
  buffer_load_dwordx4 v11, s[16:19], s29 offen offset:1024 lds
  ds_read_b128 v[68:71], v16 offset:4352
  s_waitcnt lgkmcnt(7)
  v_mfma_f32_16x16x32_bf16 v[24:27], v[152:155], v[72:75], v[24:27]
  v_mfma_f32_16x16x32_bf16 v[32:35], v[156:159], v[72:75], v[32:35]
  ds_read_b128 v[72:75], v17 offset:256
  s_waitcnt lgkmcnt(7)
  v_mfma_f32_16x16x32_bf16 v[28:31], v[152:155], v[76:79], v[28:31]
  v_mfma_f32_16x16x32_bf16 v[36:39], v[156:159], v[76:79], v[36:39]
  ds_read_b128 v[76:79], v17 offset:4352
  s_waitcnt lgkmcnt(7)
  v_mfma_f32_16x16x32_bf16 v[24:27], v[160:163], v[48:51], v[24:27]
  v_mfma_f32_16x16x32_bf16 v[32:35], v[164:167], v[48:51], v[32:35]
  buffer_load_dwordx4 v12, s[16:19], s29 offen offset:2048 lds
  ds_read_b128 v[48:51], v14 offset:512
  s_waitcnt lgkmcnt(7)
  v_mfma_f32_16x16x32_bf16 v[28:31], v[160:163], v[52:55], v[28:31]
  v_mfma_f32_16x16x32_bf16 v[36:39], v[164:167], v[52:55], v[36:39]
  ds_read_b128 v[52:55], v14 offset:4608
  s_waitcnt lgkmcnt(7)
  v_mfma_f32_16x16x32_bf16 v[24:27], v[168:171], v[56:59], v[24:27]
  v_mfma_f32_16x16x32_bf16 v[32:35], v[172:175], v[56:59], v[32:35]
  ds_read_b128 v[56:59], v15 offset:512
  s_waitcnt lgkmcnt(7)
  v_mfma_f32_16x16x32_bf16 v[28:31], v[168:171], v[60:63], v[28:31]
  v_mfma_f32_16x16x32_bf16 v[36:39], v[172:175], v[60:63], v[36:39]
  buffer_load_dwordx4 v13, s[16:19], s29 offen offset:3072 lds
  ds_read_b128 v[60:63], v15 offset:4608
  s_waitcnt lgkmcnt(7)
  v_mfma_f32_16x16x32_bf16 v[24:27], v[176:179], v[64:67], v[24:27]
  v_mfma_f32_16x16x32_bf16 v[32:35], v[180:183], v[64:67], v[32:35]
  ds_read_b128 v[64:67], v16 offset:512
  s_waitcnt lgkmcnt(7)
  v_mfma_f32_16x16x32_bf16 v[28:31], v[176:179], v[68:71], v[28:31]
  v_mfma_f32_16x16x32_bf16 v[36:39], v[180:183], v[68:71], v[36:39]
  ds_read_b128 v[68:71], v16 offset:4608
  s_waitcnt lgkmcnt(7)
  v_mfma_f32_16x16x32_bf16 v[24:27], v[184:187], v[72:75], v[24:27]
  v_mfma_f32_16x16x32_bf16 v[32:35], v[188:191], v[72:75], v[32:35]
  s_add_u32 m0, s35, 4096
  s_add_u32 s29, s34, 4096
  buffer_load_dwordx4 v10, s[16:19], s29 offen offset:0 lds
  ds_read_b128 v[72:75], v17 offset:512
  s_waitcnt lgkmcnt(7)
  v_mfma_f32_16x16x32_bf16 v[28:31], v[184:187], v[76:79], v[28:31]
  v_mfma_f32_16x16x32_bf16 v[36:39], v[188:191], v[76:79], v[36:39]
  ds_read_b128 v[76:79], v17 offset:4608
  s_waitcnt lgkmcnt(7)
  v_mfma_f32_16x16x32_bf16 v[24:27], v[192:195], v[48:51], v[24:27]
  v_mfma_f32_16x16x32_bf16 v[32:35], v[196:199], v[48:51], v[32:35]
  ds_read_b128 v[48:51], v14 offset:768
  s_waitcnt lgkmcnt(7)
  v_mfma_f32_16x16x32_bf16 v[28:31], v[192:195], v[52:55], v[28:31]
  v_mfma_f32_16x16x32_bf16 v[36:39], v[196:199], v[52:55], v[36:39]
  buffer_load_dwordx4 v11, s[16:19], s29 offen offset:1024 lds
  ds_read_b128 v[52:55], v14 offset:4864
  s_waitcnt lgkmcnt(7)
  v_mfma_f32_16x16x32_bf16 v[24:27], v[200:203], v[56:59], v[24:27]
  v_mfma_f32_16x16x32_bf16 v[32:35], v[204:207], v[56:59], v[32:35]
  ds_read_b128 v[56:59], v15 offset:768
  s_waitcnt lgkmcnt(7)
  v_mfma_f32_16x16x32_bf16 v[28:31], v[200:203], v[60:63], v[28:31]
  v_mfma_f32_16x16x32_bf16 v[36:39], v[204:207], v[60:63], v[36:39]
  ds_read_b128 v[60:63], v15 offset:4864
  s_waitcnt lgkmcnt(7)
  v_mfma_f32_16x16x32_bf16 v[24:27], v[208:211], v[64:67], v[24:27]
  v_mfma_f32_16x16x32_bf16 v[32:35], v[212:215], v[64:67], v[32:35]
  buffer_load_dwordx4 v12, s[16:19], s29 offen offset:2048 lds
  ds_read_b128 v[64:67], v16 offset:768
  s_waitcnt lgkmcnt(7)
  v_mfma_f32_16x16x32_bf16 v[28:31], v[208:211], v[68:71], v[28:31]
  v_mfma_f32_16x16x32_bf16 v[36:39], v[212:215], v[68:71], v[36:39]
  ds_read_b128 v[68:71], v16 offset:4864
  s_waitcnt lgkmcnt(7)
  v_mfma_f32_16x16x32_bf16 v[24:27], v[216:219], v[72:75], v[24:27]
  v_mfma_f32_16x16x32_bf16 v[32:35], v[220:223], v[72:75], v[32:35]
  ds_read_b128 v[72:75], v17 offset:768
  s_waitcnt lgkmcnt(7)
  v_mfma_f32_16x16x32_bf16 v[28:31], v[216:219], v[76:79], v[28:31]
  v_mfma_f32_16x16x32_bf16 v[36:39], v[220:223], v[76:79], v[36:39]
  buffer_load_dwordx4 v13, s[16:19], s29 offen offset:3072 lds
  s_add_u32 s34, s34, 0x8000
  s_add_u32 s35, s35, 0x8000
  s_bitset0_b32 s35, 17
  ds_read_b128 v[76:79], v17 offset:4864
  s_waitcnt lgkmcnt(7)
  v_mfma_f32_16x16x32_bf16 v[24:27], v[224:227], v[48:51], v[24:27]
  v_mfma_f32_16x16x32_bf16 v[32:35], v[228:231], v[48:51], v[32:35]
  s_waitcnt lgkmcnt(6)
  v_mfma_f32_16x16x32_bf16 v[28:31], v[224:227], v[52:55], v[28:31]
  v_mfma_f32_16x16x32_bf16 v[36:39], v[228:231], v[52:55], v[36:39]
  s_waitcnt lgkmcnt(5)
  v_mfma_f32_16x16x32_bf16 v[24:27], v[232:235], v[56:59], v[24:27]
  v_mfma_f32_16x16x32_bf16 v[32:35], v[236:239], v[56:59], v[32:35]
  s_waitcnt lgkmcnt(4)
  v_mfma_f32_16x16x32_bf16 v[28:31], v[232:235], v[60:63], v[28:31]
  v_mfma_f32_16x16x32_bf16 v[36:39], v[236:239], v[60:63], v[36:39]
  s_waitcnt lgkmcnt(3)
  v_mfma_f32_16x16x32_bf16 v[24:27], v[240:243], v[64:67], v[24:27]
  v_mfma_f32_16x16x32_bf16 v[32:35], v[244:247], v[64:67], v[32:35]
  s_waitcnt lgkmcnt(2)
  v_mfma_f32_16x16x32_bf16 v[28:31], v[240:243], v[68:71], v[28:31]
  v_mfma_f32_16x16x32_bf16 v[36:39], v[244:247], v[68:71], v[36:39]
  s_waitcnt lgkmcnt(1)
  v_mfma_f32_16x16x32_bf16 v[24:27], v[248:251], v[72:75], v[24:27]
  v_mfma_f32_16x16x32_bf16 v[32:35], v[252:255], v[72:75], v[32:35]
  s_waitcnt lgkmcnt(0)
  v_mfma_f32_16x16x32_bf16 v[28:31], v[248:251], v[76:79], v[28:31]
  v_mfma_f32_16x16x32_bf16 v[36:39], v[252:255], v[76:79], v[36:39]
  v_add_u32 v14, 0x8000, v14
  v_and_b32 v14, 0x1ffff, v14
  v_add_u32 v15, 0x8000, v15
  v_and_b32 v15, 0x1ffff, v15
  v_add_u32 v16, 0x8000, v16
  v_and_b32 v16, 0x1ffff, v16
  v_add_u32 v17, 0x8000, v17
  v_and_b32 v17, 0x1ffff, v17
  v_cvt_pk_bf16_f32 v40, v24, v25
  v_cvt_pk_bf16_f32 v41, v26, v27
  v_cvt_pk_bf16_f32 v42, v32, v33
  v_cvt_pk_bf16_f32 v43, v34, v35
  v_cvt_pk_bf16_f32 v44, v28, v29
  v_cvt_pk_bf16_f32 v45, v30, v31
  v_cvt_pk_bf16_f32 v46, v36, v37
  v_cvt_pk_bf16_f32 v47, v38, v39
  s_add_u32 s28, s36, s39
  buffer_store_dwordx4 v[40:43], v18, s[4:7], s36 offen sc1
  buffer_store_dwordx4 v[44:47], v18, s[4:7], s28 offen sc1
  s_add_u32 s36, s36, 24576
  s_cmp_ge_u32 s38, 1
  s_cbranch_scc1 L_pj_nf1
  s_add_u32 s26, s38, 1
  s_waitcnt vmcnt(0)
  s_barrier
  v_mov_b32 v20, s26
  buffer_store_dword v20, v19, s[4:7], s37 offen sc1
L_pj_nf1:
  s_add_u32 s38, s38, 1
  s_cmp_lt_u32 s38, 64
  s_cbranch_scc1 L_pj_loop1
L_pj_end:
  s_waitcnt vmcnt(0)
  s_barrier
  v_mov_b32 v20, 64
  buffer_store_dword v20, v19, s[4:7], s37 offen sc1
  s_branch L_op
L_conv:
  s_mov_b32 s30, s12
  s_and_b32 s36, s30, 1
  s_lshr_b32 s37, s30, 1
  v_and_b32 v1, 63, v0
  v_lshrrev_b32 v2, 4, v1
  v_and_b32 v3, 15, v1
  s_load_dwordx2 s[8:9], s[0:1], 8
  s_mov_b32 s10, 0x200000
  s_mov_b32 s11, 0x20000
  s_waitcnt lgkmcnt(0)
  s_load_dwordx2 s[16:17], s[0:1], 16
  s_mov_b32 s18, 0x200000
  s_mov_b32 s19, 0x20000
  s_waitcnt lgkmcnt(0)
  s_load_dwordx2 s[20:21], s[0:1], 24
  s_mov_b32 s22, 0x1000
  s_mov_b32 s23, 0x20000
  s_waitcnt lgkmcnt(0)
  v_mov_b32 v6, s36
  s_lshl_b32 s26, s37, 7
  v_lshlrev_b32 v7, 6, v6
  buffer_load_dwordx4 v[48:51], v7, s[20:23], s26 offen offset:0
  buffer_load_dwordx4 v[52:55], v7, s[20:23], s26 offen offset:16
  buffer_load_dwordx4 v[56:59], v7, s[20:23], s26 offen offset:32
  buffer_load_dwordx4 v[60:63], v7, s[20:23], s26 offen offset:48
  v_lshrrev_b32 v7, 0, v0
  v_lshlrev_b32 v8, 11, v7
  v_lshl_add_u32 v8, v6, 4, v8
  s_lshl_b32 s27, s37, 5
  v_add_u32 v8, s27, v8
  v_mul_u32_u24 v9, 0, v6
  v_lshrrev_b32 v6, 4, v7
  v_lshl_add_u32 v9, v6, 6, v9
  v_and_b32 v6, 15, v7
  v_lshlrev_b32 v6, 2, v6
  v_sub_u32 v9, v9, v6
  v_add_u32 v9, 1084, v9
  v_lshrrev_b32 v6, 4, v0
  v_mul_u32_u24 v6, 5120, v6
  v_and_b32 v7, 15, v0
  v_lshl_add_u32 v6, v7, 6, v6
  v_mov_b32 v88, 0
  v_mov_b32 v89, 0
  v_mov_b32 v90, 0
  v_mov_b32 v91, 0
  ds_write_b128 v6, v[88:91] offset:0
  ds_write_b128 v6, v[88:91] offset:16
  ds_write_b128 v6, v[88:91] offset:32
  ds_write_b128 v6, v[88:91] offset:48
  s_waitcnt vmcnt(0)
  v_lshlrev_b32 v16, 16, v48
  v_and_b32 v17, 0xffff0000, v48
  v_lshlrev_b32 v18, 16, v49
  v_and_b32 v19, 0xffff0000, v49
  v_lshlrev_b32 v20, 16, v50
  v_and_b32 v21, 0xffff0000, v50
  v_lshlrev_b32 v22, 16, v51
  v_and_b32 v23, 0xffff0000, v51
  v_lshlrev_b32 v24, 16, v52
  v_and_b32 v25, 0xffff0000, v52
  v_lshlrev_b32 v26, 16, v53
  v_and_b32 v27, 0xffff0000, v53
  v_lshlrev_b32 v28, 16, v54
  v_and_b32 v29, 0xffff0000, v54
  v_lshlrev_b32 v30, 16, v55
  v_and_b32 v31, 0xffff0000, v55
  v_lshlrev_b32 v32, 16, v56
  v_and_b32 v33, 0xffff0000, v56
  v_lshlrev_b32 v34, 16, v57
  v_and_b32 v35, 0xffff0000, v57
  v_lshlrev_b32 v36, 16, v58
  v_and_b32 v37, 0xffff0000, v58
  v_lshlrev_b32 v38, 16, v59
  v_and_b32 v39, 0xffff0000, v59
  v_lshlrev_b32 v40, 16, v60
  v_and_b32 v41, 0xffff0000, v60
  v_lshlrev_b32 v42, 16, v61
  v_and_b32 v43, 0xffff0000, v61
  v_lshlrev_b32 v44, 16, v62
  v_and_b32 v45, 0xffff0000, v62
  v_lshlrev_b32 v46, 16, v63
  v_and_b32 v47, 0xffff0000, v63
  s_mov_b32 s31, 0
L_cv_kv:
  v_add_u32 v10, -3072, v8
  buffer_load_dwordx4 v[48:51], v10, s[8:11], 0 offen
  v_add_u32 v11, -2048, v8
  buffer_load_dwordx4 v[52:55], v11, s[8:11], 0 offen
  v_add_u32 v12, -1024, v8
  buffer_load_dwordx4 v[56:59], v12, s[8:11], 0 offen
  v_add_u32 v13, 0, v8
  buffer_load_dwordx4 v[60:63], v13, s[8:11], 0 offen
  v_add_u32 v14, 1024, v8
  buffer_load_dwordx4 v[64:67], v14, s[8:11], 0 offen
  buffer_load_dwordx4 v[68:71], v13, s[16:19], 0 offen
  buffer_load_dwordx4 v[72:75], v14, s[16:19], 0 offen
  s_waitcnt vmcnt(0)
  v_lshlrev_b32 v76, 16, v48
  v_lshlrev_b32 v77, 16, v52
  v_lshlrev_b32 v78, 16, v56
  v_lshlrev_b32 v79, 16, v60
  v_lshlrev_b32 v80, 16, v64
  v_lshlrev_b32 v82, 16, v68
  v_lshlrev_b32 v83, 16, v72
  v_mul_f32 v84, v76, v19
  v_mul_f32 v85, v77, v19
  v_cvt_pk_bf16_f32 v88, v84, v85
  v_lshlrev_b32 v86, 16, v88
  v_and_b32 v87, 0xffff0000, v88
  v_mul_f32 v84, v77, v18
  v_mul_f32 v85, v78, v18
  v_cvt_pk_bf16_f32 v88, v84, v85
  v_lshlrev_b32 v84, 16, v88
  v_and_b32 v85, 0xffff0000, v88
  v_add_f32 v86, v86, v84
  v_add_f32 v87, v87, v85
  v_cvt_pk_bf16_f32 v88, v86, v87
  v_lshlrev_b32 v86, 16, v88
  v_and_b32 v87, 0xffff0000, v88
  v_mul_f32 v84, v78, v17
  v_mul_f32 v85, v79, v17
  v_cvt_pk_bf16_f32 v88, v84, v85
  v_lshlrev_b32 v84, 16, v88
  v_and_b32 v85, 0xffff0000, v88
  v_add_f32 v86, v86, v84
  v_add_f32 v87, v87, v85
  v_cvt_pk_bf16_f32 v88, v86, v87
  v_lshlrev_b32 v86, 16, v88
  v_and_b32 v87, 0xffff0000, v88
  v_mul_f32 v84, v79, v16
  v_mul_f32 v85, v80, v16
  v_cvt_pk_bf16_f32 v88, v84, v85
  v_lshlrev_b32 v84, 16, v88
  v_and_b32 v85, 0xffff0000, v88
  v_add_f32 v86, v86, v84
  v_add_f32 v87, v87, v85
  v_cvt_pk_bf16_f32 v88, v86, v87
  v_lshlrev_b32 v86, 16, v88
  v_and_b32 v87, 0xffff0000, v88
  v_mul_f32 v84, v86, v82
  v_mul_f32 v85, v87, v83
  v_cvt_pk_bf16_f32 v89, v85, v84
  ds_write_b32 v9, v89 offset:0
  v_and_b32 v76, 0xffff0000, v48
  v_and_b32 v77, 0xffff0000, v52
  v_and_b32 v78, 0xffff0000, v56
  v_and_b32 v79, 0xffff0000, v60
  v_and_b32 v80, 0xffff0000, v64
  v_and_b32 v82, 0xffff0000, v68
  v_and_b32 v83, 0xffff0000, v72
  v_mul_f32 v84, v76, v23
  v_mul_f32 v85, v77, v23
  v_cvt_pk_bf16_f32 v88, v84, v85
  v_lshlrev_b32 v86, 16, v88
  v_and_b32 v87, 0xffff0000, v88
  v_mul_f32 v84, v77, v22
  v_mul_f32 v85, v78, v22
  v_cvt_pk_bf16_f32 v88, v84, v85
  v_lshlrev_b32 v84, 16, v88
  v_and_b32 v85, 0xffff0000, v88
  v_add_f32 v86, v86, v84
  v_add_f32 v87, v87, v85
  v_cvt_pk_bf16_f32 v88, v86, v87
  v_lshlrev_b32 v86, 16, v88
  v_and_b32 v87, 0xffff0000, v88
  v_mul_f32 v84, v78, v21
  v_mul_f32 v85, v79, v21
  v_cvt_pk_bf16_f32 v88, v84, v85
  v_lshlrev_b32 v84, 16, v88
  v_and_b32 v85, 0xffff0000, v88
  v_add_f32 v86, v86, v84
  v_add_f32 v87, v87, v85
  v_cvt_pk_bf16_f32 v88, v86, v87
  v_lshlrev_b32 v86, 16, v88
  v_and_b32 v87, 0xffff0000, v88
  v_mul_f32 v84, v79, v20
  v_mul_f32 v85, v80, v20
  v_cvt_pk_bf16_f32 v88, v84, v85
  v_lshlrev_b32 v84, 16, v88
  v_and_b32 v85, 0xffff0000, v88
  v_add_f32 v86, v86, v84
  v_add_f32 v87, v87, v85
  v_cvt_pk_bf16_f32 v88, v86, v87
  v_lshlrev_b32 v86, 16, v88
  v_and_b32 v87, 0xffff0000, v88
  v_mul_f32 v84, v86, v82
  v_mul_f32 v85, v87, v83
  v_cvt_pk_bf16_f32 v90, v85, v84
  ds_write_b32 v9, v90 offset:5120
  v_lshlrev_b32 v76, 16, v49
  v_lshlrev_b32 v77, 16, v53
  v_lshlrev_b32 v78, 16, v57
  v_lshlrev_b32 v79, 16, v61
  v_lshlrev_b32 v80, 16, v65
  v_lshlrev_b32 v82, 16, v69
  v_lshlrev_b32 v83, 16, v73
  v_mul_f32 v84, v76, v27
  v_mul_f32 v85, v77, v27
  v_cvt_pk_bf16_f32 v88, v84, v85
  v_lshlrev_b32 v86, 16, v88
  v_and_b32 v87, 0xffff0000, v88
  v_mul_f32 v84, v77, v26
  v_mul_f32 v85, v78, v26
  v_cvt_pk_bf16_f32 v88, v84, v85
  v_lshlrev_b32 v84, 16, v88
  v_and_b32 v85, 0xffff0000, v88
  v_add_f32 v86, v86, v84
  v_add_f32 v87, v87, v85
  v_cvt_pk_bf16_f32 v88, v86, v87
  v_lshlrev_b32 v86, 16, v88
  v_and_b32 v87, 0xffff0000, v88
  v_mul_f32 v84, v78, v25
  v_mul_f32 v85, v79, v25
  v_cvt_pk_bf16_f32 v88, v84, v85
  v_lshlrev_b32 v84, 16, v88
  v_and_b32 v85, 0xffff0000, v88
  v_add_f32 v86, v86, v84
  v_add_f32 v87, v87, v85
  v_cvt_pk_bf16_f32 v88, v86, v87
  v_lshlrev_b32 v86, 16, v88
  v_and_b32 v87, 0xffff0000, v88
  v_mul_f32 v84, v79, v24
  v_mul_f32 v85, v80, v24
  v_cvt_pk_bf16_f32 v88, v84, v85
  v_lshlrev_b32 v84, 16, v88
  v_and_b32 v85, 0xffff0000, v88
  v_add_f32 v86, v86, v84
  v_add_f32 v87, v87, v85
  v_cvt_pk_bf16_f32 v88, v86, v87
  v_lshlrev_b32 v86, 16, v88
  v_and_b32 v87, 0xffff0000, v88
  v_mul_f32 v84, v86, v82
  v_mul_f32 v85, v87, v83
  v_cvt_pk_bf16_f32 v89, v85, v84
  ds_write_b32 v9, v89 offset:10240
  v_and_b32 v76, 0xffff0000, v49
  v_and_b32 v77, 0xffff0000, v53
  v_and_b32 v78, 0xffff0000, v57
  v_and_b32 v79, 0xffff0000, v61
  v_and_b32 v80, 0xffff0000, v65
  v_and_b32 v82, 0xffff0000, v69
  v_and_b32 v83, 0xffff0000, v73
  v_mul_f32 v84, v76, v31
  v_mul_f32 v85, v77, v31
  v_cvt_pk_bf16_f32 v88, v84, v85
  v_lshlrev_b32 v86, 16, v88
  v_and_b32 v87, 0xffff0000, v88
  v_mul_f32 v84, v77, v30
  v_mul_f32 v85, v78, v30
  v_cvt_pk_bf16_f32 v88, v84, v85
  v_lshlrev_b32 v84, 16, v88
  v_and_b32 v85, 0xffff0000, v88
  v_add_f32 v86, v86, v84
  v_add_f32 v87, v87, v85
  v_cvt_pk_bf16_f32 v88, v86, v87
  v_lshlrev_b32 v86, 16, v88
  v_and_b32 v87, 0xffff0000, v88
  v_mul_f32 v84, v78, v29
  v_mul_f32 v85, v79, v29
  v_cvt_pk_bf16_f32 v88, v84, v85
  v_lshlrev_b32 v84, 16, v88
  v_and_b32 v85, 0xffff0000, v88
  v_add_f32 v86, v86, v84
  v_add_f32 v87, v87, v85
  v_cvt_pk_bf16_f32 v88, v86, v87
  v_lshlrev_b32 v86, 16, v88
  v_and_b32 v87, 0xffff0000, v88
  v_mul_f32 v84, v79, v28
  v_mul_f32 v85, v80, v28
  v_cvt_pk_bf16_f32 v88, v84, v85
  v_lshlrev_b32 v84, 16, v88
  v_and_b32 v85, 0xffff0000, v88
  v_add_f32 v86, v86, v84
  v_add_f32 v87, v87, v85
  v_cvt_pk_bf16_f32 v88, v86, v87
  v_lshlrev_b32 v86, 16, v88
  v_and_b32 v87, 0xffff0000, v88
  v_mul_f32 v84, v86, v82
  v_mul_f32 v85, v87, v83
  v_cvt_pk_bf16_f32 v90, v85, v84
  ds_write_b32 v9, v90 offset:15360
  v_lshlrev_b32 v76, 16, v50
  v_lshlrev_b32 v77, 16, v54
  v_lshlrev_b32 v78, 16, v58
  v_lshlrev_b32 v79, 16, v62
  v_lshlrev_b32 v80, 16, v66
  v_lshlrev_b32 v82, 16, v70
  v_lshlrev_b32 v83, 16, v74
  v_mul_f32 v84, v76, v35
  v_mul_f32 v85, v77, v35
  v_cvt_pk_bf16_f32 v88, v84, v85
  v_lshlrev_b32 v86, 16, v88
  v_and_b32 v87, 0xffff0000, v88
  v_mul_f32 v84, v77, v34
  v_mul_f32 v85, v78, v34
  v_cvt_pk_bf16_f32 v88, v84, v85
  v_lshlrev_b32 v84, 16, v88
  v_and_b32 v85, 0xffff0000, v88
  v_add_f32 v86, v86, v84
  v_add_f32 v87, v87, v85
  v_cvt_pk_bf16_f32 v88, v86, v87
  v_lshlrev_b32 v86, 16, v88
  v_and_b32 v87, 0xffff0000, v88
  v_mul_f32 v84, v78, v33
  v_mul_f32 v85, v79, v33
  v_cvt_pk_bf16_f32 v88, v84, v85
  v_lshlrev_b32 v84, 16, v88
  v_and_b32 v85, 0xffff0000, v88
  v_add_f32 v86, v86, v84
  v_add_f32 v87, v87, v85
  v_cvt_pk_bf16_f32 v88, v86, v87
  v_lshlrev_b32 v86, 16, v88
  v_and_b32 v87, 0xffff0000, v88
  v_mul_f32 v84, v79, v32
  v_mul_f32 v85, v80, v32
  v_cvt_pk_bf16_f32 v88, v84, v85
  v_lshlrev_b32 v84, 16, v88
  v_and_b32 v85, 0xffff0000, v88
  v_add_f32 v86, v86, v84
  v_add_f32 v87, v87, v85
  v_cvt_pk_bf16_f32 v88, v86, v87
  v_lshlrev_b32 v86, 16, v88
  v_and_b32 v87, 0xffff0000, v88
  v_mul_f32 v84, v86, v82
  v_mul_f32 v85, v87, v83
  v_cvt_pk_bf16_f32 v89, v85, v84
  ds_write_b32 v9, v89 offset:20480
  v_and_b32 v76, 0xffff0000, v50
  v_and_b32 v77, 0xffff0000, v54
  v_and_b32 v78, 0xffff0000, v58
  v_and_b32 v79, 0xffff0000, v62
  v_and_b32 v80, 0xffff0000, v66
  v_and_b32 v82, 0xffff0000, v70
  v_and_b32 v83, 0xffff0000, v74
  v_mul_f32 v84, v76, v39
  v_mul_f32 v85, v77, v39
  v_cvt_pk_bf16_f32 v88, v84, v85
  v_lshlrev_b32 v86, 16, v88
  v_and_b32 v87, 0xffff0000, v88
  v_mul_f32 v84, v77, v38
  v_mul_f32 v85, v78, v38
  v_cvt_pk_bf16_f32 v88, v84, v85
  v_lshlrev_b32 v84, 16, v88
  v_and_b32 v85, 0xffff0000, v88
  v_add_f32 v86, v86, v84
  v_add_f32 v87, v87, v85
  v_cvt_pk_bf16_f32 v88, v86, v87
  v_lshlrev_b32 v86, 16, v88
  v_and_b32 v87, 0xffff0000, v88
  v_mul_f32 v84, v78, v37
  v_mul_f32 v85, v79, v37
  v_cvt_pk_bf16_f32 v88, v84, v85
  v_lshlrev_b32 v84, 16, v88
  v_and_b32 v85, 0xffff0000, v88
  v_add_f32 v86, v86, v84
  v_add_f32 v87, v87, v85
  v_cvt_pk_bf16_f32 v88, v86, v87
  v_lshlrev_b32 v86, 16, v88
  v_and_b32 v87, 0xffff0000, v88
  v_mul_f32 v84, v79, v36
  v_mul_f32 v85, v80, v36
  v_cvt_pk_bf16_f32 v88, v84, v85
  v_lshlrev_b32 v84, 16, v88
  v_and_b32 v85, 0xffff0000, v88
  v_add_f32 v86, v86, v84
  v_add_f32 v87, v87, v85
  v_cvt_pk_bf16_f32 v88, v86, v87
  v_lshlrev_b32 v86, 16, v88
  v_and_b32 v87, 0xffff0000, v88
  v_mul_f32 v84, v86, v82
  v_mul_f32 v85, v87, v83
  v_cvt_pk_bf16_f32 v90, v85, v84
  ds_write_b32 v9, v90 offset:25600
  v_lshlrev_b32 v76, 16, v51
  v_lshlrev_b32 v77, 16, v55
  v_lshlrev_b32 v78, 16, v59
  v_lshlrev_b32 v79, 16, v63
  v_lshlrev_b32 v80, 16, v67
  v_lshlrev_b32 v82, 16, v71
  v_lshlrev_b32 v83, 16, v75
  v_mul_f32 v84, v76, v43
  v_mul_f32 v85, v77, v43
  v_cvt_pk_bf16_f32 v88, v84, v85
  v_lshlrev_b32 v86, 16, v88
  v_and_b32 v87, 0xffff0000, v88
  v_mul_f32 v84, v77, v42
  v_mul_f32 v85, v78, v42
  v_cvt_pk_bf16_f32 v88, v84, v85
  v_lshlrev_b32 v84, 16, v88
  v_and_b32 v85, 0xffff0000, v88
  v_add_f32 v86, v86, v84
  v_add_f32 v87, v87, v85
  v_cvt_pk_bf16_f32 v88, v86, v87
  v_lshlrev_b32 v86, 16, v88
  v_and_b32 v87, 0xffff0000, v88
  v_mul_f32 v84, v78, v41
  v_mul_f32 v85, v79, v41
  v_cvt_pk_bf16_f32 v88, v84, v85
  v_lshlrev_b32 v84, 16, v88
  v_and_b32 v85, 0xffff0000, v88
  v_add_f32 v86, v86, v84
  v_add_f32 v87, v87, v85
  v_cvt_pk_bf16_f32 v88, v86, v87
  v_lshlrev_b32 v86, 16, v88
  v_and_b32 v87, 0xffff0000, v88
  v_mul_f32 v84, v79, v40
  v_mul_f32 v85, v80, v40
  v_cvt_pk_bf16_f32 v88, v84, v85
  v_lshlrev_b32 v84, 16, v88
  v_and_b32 v85, 0xffff0000, v88
  v_add_f32 v86, v86, v84
  v_add_f32 v87, v87, v85
  v_cvt_pk_bf16_f32 v88, v86, v87
  v_lshlrev_b32 v86, 16, v88
  v_and_b32 v87, 0xffff0000, v88
  v_mul_f32 v84, v86, v82
  v_mul_f32 v85, v87, v83
  v_cvt_pk_bf16_f32 v89, v85, v84
  ds_write_b32 v9, v89 offset:30720
  v_and_b32 v76, 0xffff0000, v51
  v_and_b32 v77, 0xffff0000, v55
  v_and_b32 v78, 0xffff0000, v59
  v_and_b32 v79, 0xffff0000, v63
  v_and_b32 v80, 0xffff0000, v67
  v_and_b32 v82, 0xffff0000, v71
  v_and_b32 v83, 0xffff0000, v75
  v_mul_f32 v84, v76, v47
  v_mul_f32 v85, v77, v47
  v_cvt_pk_bf16_f32 v88, v84, v85
  v_lshlrev_b32 v86, 16, v88
  v_and_b32 v87, 0xffff0000, v88
  v_mul_f32 v84, v77, v46
  v_mul_f32 v85, v78, v46
  v_cvt_pk_bf16_f32 v88, v84, v85
  v_lshlrev_b32 v84, 16, v88
  v_and_b32 v85, 0xffff0000, v88
  v_add_f32 v86, v86, v84
  v_add_f32 v87, v87, v85
  v_cvt_pk_bf16_f32 v88, v86, v87
  v_lshlrev_b32 v86, 16, v88
  v_and_b32 v87, 0xffff0000, v88
  v_mul_f32 v84, v78, v45
  v_mul_f32 v85, v79, v45
  v_cvt_pk_bf16_f32 v88, v84, v85
  v_lshlrev_b32 v84, 16, v88
  v_and_b32 v85, 0xffff0000, v88
  v_add_f32 v86, v86, v84
  v_add_f32 v87, v87, v85
  v_cvt_pk_bf16_f32 v88, v86, v87
  v_lshlrev_b32 v86, 16, v88
  v_and_b32 v87, 0xffff0000, v88
  v_mul_f32 v84, v79, v44
  v_mul_f32 v85, v80, v44
  v_cvt_pk_bf16_f32 v88, v84, v85
  v_lshlrev_b32 v84, 16, v88
  v_and_b32 v85, 0xffff0000, v88
  v_add_f32 v86, v86, v84
  v_add_f32 v87, v87, v85
  v_cvt_pk_bf16_f32 v88, v86, v87
  v_lshlrev_b32 v86, 16, v88
  v_and_b32 v87, 0xffff0000, v88
  v_mul_f32 v84, v86, v82
  v_mul_f32 v85, v87, v83
  v_cvt_pk_bf16_f32 v90, v85, v84
  ds_write_b32 v9, v90 offset:35840
  v_add_u32 v8, 0x80000, v8
  v_add_u32 v9, 1024, v9
  s_add_u32 s31, s31, 1
  s_cmp_lt_u32 s31, 4
  s_cbranch_scc1 L_cv_kv
  v_subrev_u32 v8, 0x200000, v8
  v_subrev_u32 v9, 4096, v9
  s_waitcnt lgkmcnt(0)
  s_barrier
  s_load_dwordx2 s[34:35], s[0:1], 32
  s_load_dwordx2 s[20:21], s[0:1], 40
  s_mov_b32 s22, 0x400
  s_mov_b32 s23, 0x20000
  s_waitcnt lgkmcnt(0)
  s_mul_i32 s26, s13, 17664
  s_add_u32 s26, s26, 0x14000
  v_add_u32 v6, 1, v3
  v_and_b32 v7, 3, v6
  v_mul_u32_u24 v7, 4416, v7
  v_lshrrev_b32 v6, 2, v6
  v_lshl_add_u32 v7, v6, 3, v7
  v_lshl_add_u32 v7, v2, 4, v7
  v_add_u32 v10, s26, v7
  v_lshlrev_b32 v6, 4, v1
  v_add_u32 v13, s26, v6
  v_subrev_u32 v14, 64, v6
  s_mul_i32 s26, s13, 10240
  s_add_u32 s26, s26, 1024
  v_lshlrev_b32 v6, 6, v3
  v_add_u32 v6, s26, v6
  v_lshl_add_u32 v11, v2, 4, v6
  v_lshlrev_b32 v7, 3, v2
  v_sub_u32 v12, v6, v7
  v_add_u32 v12, 24, v12
  s_lshl_b32 s32, s30, 3
  s_lshl_b32 s26, s13, 1
  s_add_u32 s32, s32, s26
  s_mov_b32 s31, 0
L_cv_ch:
  s_lshl_b32 s26, s32, 12
  s_add_u32 s8, s34, s26
  s_addc_u32 s9, s35, 0
  s_mov_b32 s10, 4096
  s_mov_b32 s11, 0x20000
  s_lshl_b32 s26, s32, 1
  buffer_load_ushort v18, off, s[20:23], s26
  v_add_u32 v6, 0, v14
  v_add_u32 v7, 16, v14
  buffer_load_dwordx4 v[104:107], v6, s[8:11], 0 offen
  buffer_load_dwordx2 v[108:109], v7, s[8:11], 0 offen
  v_add_u32 v6, 1024, v14
  v_add_u32 v7, 1040, v14
  buffer_load_dwordx4 v[112:115], v6, s[8:11], 0 offen
  buffer_load_dwordx2 v[116:117], v7, s[8:11], 0 offen
  v_add_u32 v6, 2048, v14
  v_add_u32 v7, 2064, v14
  buffer_load_dwordx4 v[120:123], v6, s[8:11], 0 offen
  buffer_load_dwordx2 v[124:125], v7, s[8:11], 0 offen
  v_add_u32 v6, 3072, v14
  v_add_u32 v7, 3088, v14
  buffer_load_dwordx4 v[128:131], v6, s[8:11], 0 offen
  buffer_load_dwordx2 v[132:133], v7, s[8:11], 0 offen
  v_add_u32 v6, 4096, v14
  v_add_u32 v7, 4112, v14
  buffer_load_dwordx4 v[136:139], v6, s[8:11], 0 offen
  buffer_load_dwordx2 v[140:141], v7, s[8:11], 0 offen
  v_mov_b32 v24, 0
  v_mov_b32 v25, 0
  v_mov_b32 v26, 0
  v_mov_b32 v27, 0
  v_mov_b32 v28, 0
  v_mov_b32 v29, 0
  v_mov_b32 v30, 0
  v_mov_b32 v31, 0
  v_mov_b32 v32, 0
  v_mov_b32 v33, 0
  v_mov_b32 v34, 0
  v_mov_b32 v35, 0
  v_mov_b32 v36, 0
  v_mov_b32 v37, 0
  v_mov_b32 v38, 0
  v_mov_b32 v39, 0
  v_mov_b32 v40, 0
  v_mov_b32 v41, 0
  v_mov_b32 v42, 0
  v_mov_b32 v43, 0
  v_mov_b32 v44, 0
  v_mov_b32 v45, 0
  v_mov_b32 v46, 0
  v_mov_b32 v47, 0
  v_mov_b32 v48, 0
  v_mov_b32 v49, 0
  v_mov_b32 v50, 0
  v_mov_b32 v51, 0
  v_mov_b32 v52, 0
  v_mov_b32 v53, 0
  v_mov_b32 v54, 0
  v_mov_b32 v55, 0
  s_waitcnt vmcnt(8)
  ds_write_b128 v13, v[104:107] offset:0
  v_alignbit_b32 v56, v105, v104, 16
  v_alignbit_b32 v57, v106, v105, 16
  v_alignbit_b32 v58, v107, v106, 16
  v_alignbit_b32 v59, v108, v107, 16
  v_alignbit_b32 v60, v109, v108, 16
  ds_write_b128 v13, v[56:59] offset:4416
  v_mov_b32 v64, v105
  v_mov_b32 v68, v57
  v_mov_b32 v65, v106
  v_mov_b32 v69, v58
  v_mov_b32 v66, v107
  v_mov_b32 v70, v59
  v_mov_b32 v67, v108
  v_mov_b32 v71, v60
  ds_write_b128 v13, v[64:67] offset:8832
  ds_write_b128 v13, v[68:71] offset:13248
  s_waitcnt vmcnt(6)
  ds_write_b128 v13, v[112:115] offset:1024
  v_alignbit_b32 v56, v113, v112, 16
  v_alignbit_b32 v57, v114, v113, 16
  v_alignbit_b32 v58, v115, v114, 16
  v_alignbit_b32 v59, v116, v115, 16
  v_alignbit_b32 v60, v117, v116, 16
  ds_write_b128 v13, v[56:59] offset:5440
  v_mov_b32 v64, v113
  v_mov_b32 v68, v57
  v_mov_b32 v65, v114
  v_mov_b32 v69, v58
  v_mov_b32 v66, v115
  v_mov_b32 v70, v59
  v_mov_b32 v67, v116
  v_mov_b32 v71, v60
  ds_write_b128 v13, v[64:67] offset:9856
  ds_write_b128 v13, v[68:71] offset:14272
  s_waitcnt vmcnt(4)
  ds_write_b128 v13, v[120:123] offset:2048
  v_alignbit_b32 v56, v121, v120, 16
  v_alignbit_b32 v57, v122, v121, 16
  v_alignbit_b32 v58, v123, v122, 16
  v_alignbit_b32 v59, v124, v123, 16
  v_alignbit_b32 v60, v125, v124, 16
  ds_write_b128 v13, v[56:59] offset:6464
  v_mov_b32 v64, v121
  v_mov_b32 v68, v57
  v_mov_b32 v65, v122
  v_mov_b32 v69, v58
  v_mov_b32 v66, v123
  v_mov_b32 v70, v59
  v_mov_b32 v67, v124
  v_mov_b32 v71, v60
  ds_write_b128 v13, v[64:67] offset:10880
  ds_write_b128 v13, v[68:71] offset:15296
  s_waitcnt vmcnt(2)
  ds_write_b128 v13, v[128:131] offset:3072
  v_alignbit_b32 v56, v129, v128, 16
  v_alignbit_b32 v57, v130, v129, 16
  v_alignbit_b32 v58, v131, v130, 16
  v_alignbit_b32 v59, v132, v131, 16
  v_alignbit_b32 v60, v133, v132, 16
  ds_write_b128 v13, v[56:59] offset:7488
  v_mov_b32 v64, v129
  v_mov_b32 v68, v57
  v_mov_b32 v65, v130
  v_mov_b32 v69, v58
  v_mov_b32 v66, v131
  v_mov_b32 v70, v59
  v_mov_b32 v67, v132
  v_mov_b32 v71, v60
  ds_write_b128 v13, v[64:67] offset:11904
  ds_write_b128 v13, v[68:71] offset:16320
  s_waitcnt vmcnt(0)
  s_mov_b64 exec, 0xff
  ds_write_b128 v13, v[136:139] offset:4096
  v_alignbit_b32 v56, v137, v136, 16
  v_alignbit_b32 v57, v138, v137, 16
  v_alignbit_b32 v58, v139, v138, 16
  v_alignbit_b32 v59, v140, v139, 16
  v_alignbit_b32 v60, v141, v140, 16
  ds_write_b128 v13, v[56:59] offset:8512
  v_mov_b32 v64, v137
  v_mov_b32 v68, v57
  v_mov_b32 v65, v138
  v_mov_b32 v69, v58
  v_mov_b32 v66, v139
  v_mov_b32 v70, v59
  v_mov_b32 v67, v140
  v_mov_b32 v71, v60
  ds_write_b128 v13, v[64:67] offset:12928
  ds_write_b128 v13, v[68:71] offset:17344
  s_mov_b64 exec, -1
  v_mov_b32 v15, v10
  v_mov_b32 v16, v11
  v_lshlrev_b32 v18, 16, v18
  s_waitcnt lgkmcnt(0)
  v_subrev_u32 v16, 64, v16
  s_mov_b32 s26, 0
L_cv_c0:
  ds_read_b64 v[56:57], v15 offset:0
  ds_read_b64 v[58:59], v15 offset:8
  ds_read_b64 v[60:61], v15 offset:32
  ds_read_b64 v[62:63], v15 offset:40
  ds_read_b128 v[72:75], v16 offset:64
  ds_read_b128 v[76:79], v16 offset:1088
  ds_read_b128 v[80:83], v16 offset:2112
  ds_read_b128 v[84:87], v16 offset:3136
  ds_read_b64 v[64:65], v15 offset:64
  ds_read_b64 v[66:67], v15 offset:72
  ds_read_b64 v[68:69], v15 offset:96
  ds_read_b64 v[70:71], v15 offset:104
  ds_read_b128 v[88:91], v16 offset:0
  ds_read_b128 v[92:95], v16 offset:1024
  ds_read_b128 v[96:99], v16 offset:2048
  ds_read_b128 v[100:103], v16 offset:3072
  s_waitcnt lgkmcnt(8)
  v_mfma_f32_16x16x32_bf16 v[24:27], v[56:59], v[72:75], v[24:27]
  v_mfma_f32_16x16x32_bf16 v[40:43], v[60:63], v[72:75], v[40:43]
  v_mfma_f32_16x16x32_bf16 v[28:31], v[56:59], v[76:79], v[28:31]
  v_mfma_f32_16x16x32_bf16 v[44:47], v[60:63], v[76:79], v[44:47]
  v_mfma_f32_16x16x32_bf16 v[32:35], v[56:59], v[80:83], v[32:35]
  v_mfma_f32_16x16x32_bf16 v[48:51], v[60:63], v[80:83], v[48:51]
  v_mfma_f32_16x16x32_bf16 v[36:39], v[56:59], v[84:87], v[36:39]
  v_mfma_f32_16x16x32_bf16 v[52:55], v[60:63], v[84:87], v[52:55]
  v_add_u32 v15, 128, v15
  v_subrev_u32 v16, 128, v16
  s_waitcnt lgkmcnt(0)
  v_mfma_f32_16x16x32_bf16 v[24:27], v[64:67], v[88:91], v[24:27]
  v_mfma_f32_16x16x32_bf16 v[40:43], v[68:71], v[88:91], v[40:43]
  v_mfma_f32_16x16x32_bf16 v[28:31], v[64:67], v[92:95], v[28:31]
  v_mfma_f32_16x16x32_bf16 v[44:47], v[68:71], v[92:95], v[44:47]
  v_mfma_f32_16x16x32_bf16 v[32:35], v[64:67], v[96:99], v[32:35]
  v_mfma_f32_16x16x32_bf16 v[48:51], v[68:71], v[96:99], v[48:51]
  v_mfma_f32_16x16x32_bf16 v[36:39], v[64:67], v[100:103], v[36:39]
  v_mfma_f32_16x16x32_bf16 v[52:55], v[68:71], v[100:103], v[52:55]
  s_add_u32 s26, s26, 1
  s_cmp_lt_u32 s26, 8
  s_cbranch_scc1 L_cv_c0
  s_mov_b32 s26, 0
  v_add_u32 v16, 1024, v16
L_cv_c1:
  ds_read_b64 v[56:57], v15 offset:0
  ds_read_b64 v[58:59], v15 offset:8
  ds_read_b64 v[60:61], v15 offset:32
  ds_read_b64 v[62:63], v15 offset:40
  ds_read_b128 v[76:79], v16 offset:64
  ds_read_b128 v[80:83], v16 offset:1088
  ds_read_b128 v[84:87], v16 offset:2112
  ds_read_b64 v[64:65], v15 offset:64
  ds_read_b64 v[66:67], v15 offset:72
  ds_read_b64 v[68:69], v15 offset:96
  ds_read_b64 v[70:71], v15 offset:104
  ds_read_b128 v[92:95], v16 offset:0
  ds_read_b128 v[96:99], v16 offset:1024
  ds_read_b128 v[100:103], v16 offset:2048
  s_waitcnt lgkmcnt(7)
  v_mfma_f32_16x16x32_bf16 v[28:31], v[56:59], v[76:79], v[28:31]
  v_mfma_f32_16x16x32_bf16 v[44:47], v[60:63], v[76:79], v[44:47]
  v_mfma_f32_16x16x32_bf16 v[32:35], v[56:59], v[80:83], v[32:35]
  v_mfma_f32_16x16x32_bf16 v[48:51], v[60:63], v[80:83], v[48:51]
  v_mfma_f32_16x16x32_bf16 v[36:39], v[56:59], v[84:87], v[36:39]
  v_mfma_f32_16x16x32_bf16 v[52:55], v[60:63], v[84:87], v[52:55]
  v_add_u32 v15, 128, v15
  v_subrev_u32 v16, 128, v16
  s_waitcnt lgkmcnt(0)
  v_mfma_f32_16x16x32_bf16 v[28:31], v[64:67], v[92:95], v[28:31]
  v_mfma_f32_16x16x32_bf16 v[44:47], v[68:71], v[92:95], v[44:47]
  v_mfma_f32_16x16x32_bf16 v[32:35], v[64:67], v[96:99], v[32:35]
  v_mfma_f32_16x16x32_bf16 v[48:51], v[68:71], v[96:99], v[48:51]
  v_mfma_f32_16x16x32_bf16 v[36:39], v[64:67], v[100:103], v[36:39]
  v_mfma_f32_16x16x32_bf16 v[52:55], v[68:71], v[100:103], v[52:55]
  s_add_u32 s26, s26, 1
  s_cmp_lt_u32 s26, 8
  s_cbranch_scc1 L_cv_c1
  s_mov_b32 s26, 0
  v_add_u32 v16, 1024, v16
L_cv_c2:
  ds_read_b64 v[56:57], v15 offset:0
  ds_read_b64 v[58:59], v15 offset:8
  ds_read_b64 v[60:61], v15 offset:32
  ds_read_b64 v[62:63], v15 offset:40
  ds_read_b128 v[80:83], v16 offset:64
  ds_read_b128 v[84:87], v16 offset:1088
  ds_read_b64 v[64:65], v15 offset:64
  ds_read_b64 v[66:67], v15 offset:72
  ds_read_b64 v[68:69], v15 offset:96
  ds_read_b64 v[70:71], v15 offset:104
  ds_read_b128 v[96:99], v16 offset:0
  ds_read_b128 v[100:103], v16 offset:1024
  s_waitcnt lgkmcnt(6)
  v_mfma_f32_16x16x32_bf16 v[32:35], v[56:59], v[80:83], v[32:35]
  v_mfma_f32_16x16x32_bf16 v[48:51], v[60:63], v[80:83], v[48:51]
  v_mfma_f32_16x16x32_bf16 v[36:39], v[56:59], v[84:87], v[36:39]
  v_mfma_f32_16x16x32_bf16 v[52:55], v[60:63], v[84:87], v[52:55]
  v_add_u32 v15, 128, v15
  v_subrev_u32 v16, 128, v16
  s_waitcnt lgkmcnt(0)
  v_mfma_f32_16x16x32_bf16 v[32:35], v[64:67], v[96:99], v[32:35]
  v_mfma_f32_16x16x32_bf16 v[48:51], v[68:71], v[96:99], v[48:51]
  v_mfma_f32_16x16x32_bf16 v[36:39], v[64:67], v[100:103], v[36:39]
  v_mfma_f32_16x16x32_bf16 v[52:55], v[68:71], v[100:103], v[52:55]
  s_add_u32 s26, s26, 1
  s_cmp_lt_u32 s26, 8
  s_cbranch_scc1 L_cv_c2
  s_mov_b32 s26, 0
  v_add_u32 v16, 1024, v16
L_cv_c3:
  ds_read_b64 v[56:57], v15 offset:0
  ds_read_b64 v[58:59], v15 offset:8
  ds_read_b64 v[60:61], v15 offset:32
  ds_read_b64 v[62:63], v15 offset:40
  ds_read_b128 v[84:87], v16 offset:64
  ds_read_b64 v[64:65], v15 offset:64
  ds_read_b64 v[66:67], v15 offset:72
  ds_read_b64 v[68:69], v15 offset:96
  ds_read_b64 v[70:71], v15 offset:104
  ds_read_b128 v[100:103], v16 offset:0
  s_waitcnt lgkmcnt(5)
  v_mfma_f32_16x16x32_bf16 v[36:39], v[56:59], v[84:87], v[36:39]
  v_mfma_f32_16x16x32_bf16 v[52:55], v[60:63], v[84:87], v[52:55]
  v_add_u32 v15, 128, v15
  v_subrev_u32 v16, 128, v16
  s_waitcnt lgkmcnt(0)
  v_mfma_f32_16x16x32_bf16 v[36:39], v[64:67], v[100:103], v[36:39]
  v_mfma_f32_16x16x32_bf16 v[52:55], v[68:71], v[100:103], v[52:55]
  s_add_u32 s26, s26, 1
  s_cmp_lt_u32 s26, 8
  s_cbranch_scc1 L_cv_c3
  ds_read_b64 v[56:57], v12 offset:32
  ds_read_b64 v[58:59], v12 offset:1056
  ds_read_b64 v[60:61], v12 offset:2080
  ds_read_b64 v[62:63], v12 offset:3104
  ds_read_b64 v[64:65], v12 offset:0
  ds_read_b64 v[66:67], v12 offset:1024
  ds_read_b64 v[68:69], v12 offset:2048
  ds_read_b64 v[70:71], v12 offset:3072
  s_waitcnt lgkmcnt(0)
  v_lshlrev_b32 v72, 16, v56
  v_and_b32 v73, 0xffff0000, v56
  v_mul_f32 v72, v72, v18
  v_mul_f32 v73, v73, v18
  v_cvt_pk_bf16_f32 v72, v72, v73
  v_cvt_pk_bf16_f32 v74, v27, v26
  v_lshlrev_b32 v76, 16, v72
  v_and_b32 v77, 0xffff0000, v72
  v_lshlrev_b32 v78, 16, v74
  v_and_b32 v79, 0xffff0000, v74
  v_add_f32 v76, v76, v78
  v_add_f32 v77, v77, v79
  v_cvt_pk_bf16_f32 v56, v76, v77
  v_lshlrev_b32 v72, 16, v57
  v_and_b32 v73, 0xffff0000, v57
  v_mul_f32 v72, v72, v18
  v_mul_f32 v73, v73, v18
  v_cvt_pk_bf16_f32 v72, v72, v73
  v_cvt_pk_bf16_f32 v74, v25, v24
  v_lshlrev_b32 v76, 16, v72
  v_and_b32 v77, 0xffff0000, v72
  v_lshlrev_b32 v78, 16, v74
  v_and_b32 v79, 0xffff0000, v74
  v_add_f32 v76, v76, v78
  v_add_f32 v77, v77, v79
  v_cvt_pk_bf16_f32 v57, v76, v77
  ds_write_b64 v12, v[56:57] offset:32
  v_lshlrev_b32 v72, 16, v58
  v_and_b32 v73, 0xffff0000, v58
  v_mul_f32 v72, v72, v18
  v_mul_f32 v73, v73, v18
  v_cvt_pk_bf16_f32 v72, v72, v73
  v_cvt_pk_bf16_f32 v74, v31, v30
  v_lshlrev_b32 v76, 16, v72
  v_and_b32 v77, 0xffff0000, v72
  v_lshlrev_b32 v78, 16, v74
  v_and_b32 v79, 0xffff0000, v74
  v_add_f32 v76, v76, v78
  v_add_f32 v77, v77, v79
  v_cvt_pk_bf16_f32 v58, v76, v77
  v_lshlrev_b32 v72, 16, v59
  v_and_b32 v73, 0xffff0000, v59
  v_mul_f32 v72, v72, v18
  v_mul_f32 v73, v73, v18
  v_cvt_pk_bf16_f32 v72, v72, v73
  v_cvt_pk_bf16_f32 v74, v29, v28
  v_lshlrev_b32 v76, 16, v72
  v_and_b32 v77, 0xffff0000, v72
  v_lshlrev_b32 v78, 16, v74
  v_and_b32 v79, 0xffff0000, v74
  v_add_f32 v76, v76, v78
  v_add_f32 v77, v77, v79
  v_cvt_pk_bf16_f32 v59, v76, v77
  ds_write_b64 v12, v[58:59] offset:1056
  v_lshlrev_b32 v72, 16, v60
  v_and_b32 v73, 0xffff0000, v60
  v_mul_f32 v72, v72, v18
  v_mul_f32 v73, v73, v18
  v_cvt_pk_bf16_f32 v72, v72, v73
  v_cvt_pk_bf16_f32 v74, v35, v34
  v_lshlrev_b32 v76, 16, v72
  v_and_b32 v77, 0xffff0000, v72
  v_lshlrev_b32 v78, 16, v74
  v_and_b32 v79, 0xffff0000, v74
  v_add_f32 v76, v76, v78
  v_add_f32 v77, v77, v79
  v_cvt_pk_bf16_f32 v60, v76, v77
  v_lshlrev_b32 v72, 16, v61
  v_and_b32 v73, 0xffff0000, v61
  v_mul_f32 v72, v72, v18
  v_mul_f32 v73, v73, v18
  v_cvt_pk_bf16_f32 v72, v72, v73
  v_cvt_pk_bf16_f32 v74, v33, v32
  v_lshlrev_b32 v76, 16, v72
  v_and_b32 v77, 0xffff0000, v72
  v_lshlrev_b32 v78, 16, v74
  v_and_b32 v79, 0xffff0000, v74
  v_add_f32 v76, v76, v78
  v_add_f32 v77, v77, v79
  v_cvt_pk_bf16_f32 v61, v76, v77
  ds_write_b64 v12, v[60:61] offset:2080
  v_lshlrev_b32 v72, 16, v62
  v_and_b32 v73, 0xffff0000, v62
  v_mul_f32 v72, v72, v18
  v_mul_f32 v73, v73, v18
  v_cvt_pk_bf16_f32 v72, v72, v73
  v_cvt_pk_bf16_f32 v74, v39, v38
  v_lshlrev_b32 v76, 16, v72
  v_and_b32 v77, 0xffff0000, v72
  v_lshlrev_b32 v78, 16, v74
  v_and_b32 v79, 0xffff0000, v74
  v_add_f32 v76, v76, v78
  v_add_f32 v77, v77, v79
  v_cvt_pk_bf16_f32 v62, v76, v77
  v_lshlrev_b32 v72, 16, v63
  v_and_b32 v73, 0xffff0000, v63
  v_mul_f32 v72, v72, v18
  v_mul_f32 v73, v73, v18
  v_cvt_pk_bf16_f32 v72, v72, v73
  v_cvt_pk_bf16_f32 v74, v37, v36
  v_lshlrev_b32 v76, 16, v72
  v_and_b32 v77, 0xffff0000, v72
  v_lshlrev_b32 v78, 16, v74
  v_and_b32 v79, 0xffff0000, v74
  v_add_f32 v76, v76, v78
  v_add_f32 v77, v77, v79
  v_cvt_pk_bf16_f32 v63, v76, v77
  ds_write_b64 v12, v[62:63] offset:3104
  v_lshlrev_b32 v72, 16, v64
  v_and_b32 v73, 0xffff0000, v64
  v_mul_f32 v72, v72, v18
  v_mul_f32 v73, v73, v18
  v_cvt_pk_bf16_f32 v72, v72, v73
  v_cvt_pk_bf16_f32 v74, v43, v42
  v_lshlrev_b32 v76, 16, v72
  v_and_b32 v77, 0xffff0000, v72
  v_lshlrev_b32 v78, 16, v74
  v_and_b32 v79, 0xffff0000, v74
  v_add_f32 v76, v76, v78
  v_add_f32 v77, v77, v79
  v_cvt_pk_bf16_f32 v64, v76, v77
  v_lshlrev_b32 v72, 16, v65
  v_and_b32 v73, 0xffff0000, v65
  v_mul_f32 v72, v72, v18
  v_mul_f32 v73, v73, v18
  v_cvt_pk_bf16_f32 v72, v72, v73
  v_cvt_pk_bf16_f32 v74, v41, v40
  v_lshlrev_b32 v76, 16, v72
  v_and_b32 v77, 0xffff0000, v72
  v_lshlrev_b32 v78, 16, v74
  v_and_b32 v79, 0xffff0000, v74
  v_add_f32 v76, v76, v78
  v_add_f32 v77, v77, v79
  v_cvt_pk_bf16_f32 v65, v76, v77
  ds_write_b64 v12, v[64:65] offset:0
  v_lshlrev_b32 v72, 16, v66
  v_and_b32 v73, 0xffff0000, v66
  v_mul_f32 v72, v72, v18
  v_mul_f32 v73, v73, v18
  v_cvt_pk_bf16_f32 v72, v72, v73
  v_cvt_pk_bf16_f32 v74, v47, v46
  v_lshlrev_b32 v76, 16, v72
  v_and_b32 v77, 0xffff0000, v72
  v_lshlrev_b32 v78, 16, v74
  v_and_b32 v79, 0xffff0000, v74
  v_add_f32 v76, v76, v78
  v_add_f32 v77, v77, v79
  v_cvt_pk_bf16_f32 v66, v76, v77
  v_lshlrev_b32 v72, 16, v67
  v_and_b32 v73, 0xffff0000, v67
  v_mul_f32 v72, v72, v18
  v_mul_f32 v73, v73, v18
  v_cvt_pk_bf16_f32 v72, v72, v73
  v_cvt_pk_bf16_f32 v74, v45, v44
  v_lshlrev_b32 v76, 16, v72
  v_and_b32 v77, 0xffff0000, v72
  v_lshlrev_b32 v78, 16, v74
  v_and_b32 v79, 0xffff0000, v74
  v_add_f32 v76, v76, v78
  v_add_f32 v77, v77, v79
  v_cvt_pk_bf16_f32 v67, v76, v77
  ds_write_b64 v12, v[66:67] offset:1024
  v_lshlrev_b32 v72, 16, v68
  v_and_b32 v73, 0xffff0000, v68
  v_mul_f32 v72, v72, v18
  v_mul_f32 v73, v73, v18
  v_cvt_pk_bf16_f32 v72, v72, v73
  v_cvt_pk_bf16_f32 v74, v51, v50
  v_lshlrev_b32 v76, 16, v72
  v_and_b32 v77, 0xffff0000, v72
  v_lshlrev_b32 v78, 16, v74
  v_and_b32 v79, 0xffff0000, v74
  v_add_f32 v76, v76, v78
  v_add_f32 v77, v77, v79
  v_cvt_pk_bf16_f32 v68, v76, v77
  v_lshlrev_b32 v72, 16, v69
  v_and_b32 v73, 0xffff0000, v69
  v_mul_f32 v72, v72, v18
  v_mul_f32 v73, v73, v18
  v_cvt_pk_bf16_f32 v72, v72, v73
  v_cvt_pk_bf16_f32 v74, v49, v48
  v_lshlrev_b32 v76, 16, v72
  v_and_b32 v77, 0xffff0000, v72
  v_lshlrev_b32 v78, 16, v74
  v_and_b32 v79, 0xffff0000, v74
  v_add_f32 v76, v76, v78
  v_add_f32 v77, v77, v79
  v_cvt_pk_bf16_f32 v69, v76, v77
  ds_write_b64 v12, v[68:69] offset:2048
  v_lshlrev_b32 v72, 16, v70
  v_and_b32 v73, 0xffff0000, v70
  v_mul_f32 v72, v72, v18
  v_mul_f32 v73, v73, v18
  v_cvt_pk_bf16_f32 v72, v72, v73
  v_cvt_pk_bf16_f32 v74, v55, v54
  v_lshlrev_b32 v76, 16, v72
  v_and_b32 v77, 0xffff0000, v72
  v_lshlrev_b32 v78, 16, v74
  v_and_b32 v79, 0xffff0000, v74
  v_add_f32 v76, v76, v78
  v_add_f32 v77, v77, v79
  v_cvt_pk_bf16_f32 v70, v76, v77
  v_lshlrev_b32 v72, 16, v71
  v_and_b32 v73, 0xffff0000, v71
  v_mul_f32 v72, v72, v18
  v_mul_f32 v73, v73, v18
  v_cvt_pk_bf16_f32 v72, v72, v73
  v_cvt_pk_bf16_f32 v74, v53, v52
  v_lshlrev_b32 v76, 16, v72
  v_and_b32 v77, 0xffff0000, v72
  v_lshlrev_b32 v78, 16, v74
  v_and_b32 v79, 0xffff0000, v74
  v_add_f32 v76, v76, v78
  v_add_f32 v77, v77, v79
  v_cvt_pk_bf16_f32 v71, v76, v77
  ds_write_b64 v12, v[70:71] offset:3072
  v_add_u32 v11, 5120, v11
  v_add_u32 v12, 5120, v12
  s_add_u32 s32, s32, 1
  s_add_u32 s31, s31, 1
  s_cmp_lt_u32 s31, 2
  s_cbranch_scc1 L_cv_ch
  s_waitcnt lgkmcnt(0)
  s_barrier
  s_load_dwordx2 s[16:17], s[0:1], 0
  s_mov_b32 s18, 0x200000
  s_mov_b32 s19, 0x20000
  s_waitcnt lgkmcnt(0)
  s_mov_b32 s31, 0
  s_mov_b32 s27, 0x7000000
L_cv_out:
  buffer_load_dwordx4 v[32:35], v8, s[16:19], 0 offen
  buffer_load_dwordx4 v[36:39], v8, s[16:19], 0 offen offset:1024
  ds_read_b32 v24, v9 offset:0
  ds_read_b32 v25, v9 offset:5120
  ds_read_b32 v26, v9 offset:10240
  ds_read_b32 v27, v9 offset:15360
  ds_read_b32 v28, v9 offset:20480
  ds_read_b32 v29, v9 offset:25600
  ds_read_b32 v30, v9 offset:30720
  ds_read_b32 v31, v9 offset:35840
  s_waitcnt vmcnt(0) lgkmcnt(0)
  v_lshlrev_b32 v48, 16, v32
  v_and_b32 v49, 0xffff0000, v32
  v_and_b32 v50, 0xffff0000, v24
  v_and_b32 v51, 0xffff0000, v25
  v_mul_f32 v48, v48, v50
  v_mul_f32 v49, v49, v51
  v_cvt_pk_bf16_f32 v40, v48, v49
  v_lshlrev_b32 v48, 16, v33
  v_and_b32 v49, 0xffff0000, v33
  v_and_b32 v50, 0xffff0000, v26
  v_and_b32 v51, 0xffff0000, v27
  v_mul_f32 v48, v48, v50
  v_mul_f32 v49, v49, v51
  v_cvt_pk_bf16_f32 v41, v48, v49
  v_lshlrev_b32 v48, 16, v34
  v_and_b32 v49, 0xffff0000, v34
  v_and_b32 v50, 0xffff0000, v28
  v_and_b32 v51, 0xffff0000, v29
  v_mul_f32 v48, v48, v50
  v_mul_f32 v49, v49, v51
  v_cvt_pk_bf16_f32 v42, v48, v49
  v_lshlrev_b32 v48, 16, v35
  v_and_b32 v49, 0xffff0000, v35
  v_and_b32 v50, 0xffff0000, v30
  v_and_b32 v51, 0xffff0000, v31
  v_mul_f32 v48, v48, v50
  v_mul_f32 v49, v49, v51
  v_cvt_pk_bf16_f32 v43, v48, v49
  v_lshlrev_b32 v48, 16, v36
  v_and_b32 v49, 0xffff0000, v36
  v_lshlrev_b32 v50, 16, v24
  v_lshlrev_b32 v51, 16, v25
  v_mul_f32 v48, v48, v50
  v_mul_f32 v49, v49, v51
  v_cvt_pk_bf16_f32 v44, v48, v49
  v_lshlrev_b32 v48, 16, v37
  v_and_b32 v49, 0xffff0000, v37
  v_lshlrev_b32 v50, 16, v26
  v_lshlrev_b32 v51, 16, v27
  v_mul_f32 v48, v48, v50
  v_mul_f32 v49, v49, v51
  v_cvt_pk_bf16_f32 v45, v48, v49
  v_lshlrev_b32 v48, 16, v38
  v_and_b32 v49, 0xffff0000, v38
  v_lshlrev_b32 v50, 16, v28
  v_lshlrev_b32 v51, 16, v29
  v_mul_f32 v48, v48, v50
  v_mul_f32 v49, v49, v51
  v_cvt_pk_bf16_f32 v46, v48, v49
  v_lshlrev_b32 v48, 16, v39
  v_and_b32 v49, 0xffff0000, v39
  v_lshlrev_b32 v50, 16, v30
  v_lshlrev_b32 v51, 16, v31
  v_mul_f32 v48, v48, v50
  v_mul_f32 v49, v49, v51
  v_cvt_pk_bf16_f32 v47, v48, v49
  buffer_store_dwordx4 v[40:43], v8, s[4:7], s27 offen sc1
  buffer_store_dwordx4 v[44:47], v8, s[4:7], s27 offen offset:1024 sc1
  v_add_u32 v8, 0x80000, v8
  v_add_u32 v9, 1024, v9
  s_add_u32 s31, s31, 1
  s_cmp_lt_u32 s31, 4
  s_cbranch_scc1 L_cv_out
  s_mov_b32 s15, 0
L_cv_w:
  buffer_load_dword v48, off, s[48:51], 0 offset:16 sc1
  s_waitcnt vmcnt(0)
  v_cmp_gt_u32 vcc, 32, v48
  s_cbranch_vccz L_cv_ok
  s_add_u32 s15, s15, 1
  s_sleep 8
  s_cmp_lt_u32 s15, 0x20000
  s_cbranch_scc1 L_cv_w
  s_branch L_end
L_cv_ok:
  s_barrier
  s_lshl_b32 s26, s30, 2
  s_add_u32 s26, s26, 0x111400
  v_cmp_eq_u32 vcc, 0, v0
  v_mov_b32 v6, 0x80000000
  v_mov_b32 v7, 1
  v_cndmask_b32 v6, v6, 0, vcc
  buffer_store_dword v7, v6, s[4:7], s26 offen sc1
L_op:
  s_mov_b32 s12, s81
  s_lshr_b32 s84, s12, 5
  s_cmp_eq_u32 s84, 3
  s_cbranch_scc1 L_end
  s_cmp_gt_u32 s84, 3
  s_cselect_b32 s84, 32, 0
  s_sub_u32 s12, s12, s84
  s_barrier
  v_and_b32 v1, 63, v0
  v_lshrrev_b32 v2, 4, v1
  v_and_b32 v3, 15, v1
  v_and_b32 v4, 3, v1
  v_bfe_u32 v5, v1, 2, 2
  v_lshlrev_b32 v8, 4, v1
  s_and_b32 s30, s12, 15
  s_lshr_b32 s31, s12, 4
  s_load_dwordx2 s[8:9], s[0:1], 88
  s_mov_b32 s10, 0x400000
  s_mov_b32 s11, 0x20000
  s_waitcnt lgkmcnt(0)
  s_load_dwordx2 s[16:17], s[0:1], 0
  s_mov_b32 s18, 0x200000
  s_mov_b32 s19, 0x20000
  s_waitcnt lgkmcnt(0)
  s_load_dwordx2 s[20:21], s[0:1], 104
  s_mov_b32 s22, 0x400
  s_mov_b32 s23, 0x20000
  s_waitcnt lgkmcnt(0)
  buffer_load_dwordx4 v[32:35], v8, s[20:23], 0 offen
  v_and_b32 v6, 2, v1
  v_cmp_eq_u32 vcc, 0, v6
  v_mov_b32 v6, 0xeeee
  v_mov_b32 v7, 0x4444
  v_cndmask_b32 v9, v6, v7, vcc
  v_lshrrev_b32 v6, 2, v1
  v_lshlrev_b32 v6, 10, v6
  v_lshl_add_u32 v11, v4, 4, v6
  v_and_b32 v6, 1, v2
  v_lshlrev_b32 v6, 4, v6
  v_lshrrev_b32 v7, 1, v2
  v_lshl_add_u32 v6, v7, 3, v6
  v_lshrrev_b32 v7, 1, v5
  v_lshl_add_u32 v6, v7, 2, v6
  v_and_b32 v7, 1, v5
  v_add_u32 v6, v6, v7
  v_lshlrev_b32 v6, 6, v6
  v_lshl_add_u32 v6, v4, 3, v6
  s_lshl_b32 s29, s13, 15
  v_add_u32 v10, s29, v6
  s_lshl_b32 s28, s13, 20
  s_lshl_b32 s26, s30, 6
  s_add_u32 s28, s28, s26
  s_waitcnt vmcnt(0)
  v_lshlrev_b32 v24, 16, v32
  v_and_b32 v25, 0xffff0000, v32
  v_lshlrev_b32 v26, 16, v33
  v_and_b32 v27, 0xffff0000, v33
  v_lshlrev_b32 v28, 16, v34
  v_and_b32 v29, 0xffff0000, v34
  v_lshlrev_b32 v30, 16, v35
  v_and_b32 v31, 0xffff0000, v35
  s_mov_b32 s27, s29
  s_mov_b32 s26, 0
L_op_wl0:
  s_mov_b32 m0, s27
  s_add_u32 s27, s27, 1024
  buffer_load_dwordx4 v11, s[8:11], s28 offen lds
  s_add_u32 s28, s28, 0x4000
  s_add_u32 s26, s26, 1
  s_cmp_lt_u32 s26, 32
  s_cbranch_scc1 L_op_wl0
  s_waitcnt vmcnt(0)
  ds_read_b64_tr_b16 a[0:1], v10 offset:0
  ds_read_b64_tr_b16 a[2:3], v10 offset:128
  ds_read_b64_tr_b16 a[4:5], v10 offset:2048
  ds_read_b64_tr_b16 a[6:7], v10 offset:2176
  ds_read_b64_tr_b16 a[8:9], v10 offset:32
  ds_read_b64_tr_b16 a[10:11], v10 offset:160
  ds_read_b64_tr_b16 a[12:13], v10 offset:2080
  ds_read_b64_tr_b16 a[14:15], v10 offset:2208
  ds_read_b64_tr_b16 a[16:17], v10 offset:4096
  ds_read_b64_tr_b16 a[18:19], v10 offset:4224
  ds_read_b64_tr_b16 a[20:21], v10 offset:6144
  ds_read_b64_tr_b16 a[22:23], v10 offset:6272
  ds_read_b64_tr_b16 a[24:25], v10 offset:4128
  ds_read_b64_tr_b16 a[26:27], v10 offset:4256
  ds_read_b64_tr_b16 a[28:29], v10 offset:6176
  ds_read_b64_tr_b16 a[30:31], v10 offset:6304
  ds_read_b64_tr_b16 a[32:33], v10 offset:8192
  ds_read_b64_tr_b16 a[34:35], v10 offset:8320
  ds_read_b64_tr_b16 a[36:37], v10 offset:10240
  ds_read_b64_tr_b16 a[38:39], v10 offset:10368
  ds_read_b64_tr_b16 a[40:41], v10 offset:8224
  ds_read_b64_tr_b16 a[42:43], v10 offset:8352
  ds_read_b64_tr_b16 a[44:45], v10 offset:10272
  ds_read_b64_tr_b16 a[46:47], v10 offset:10400
  ds_read_b64_tr_b16 a[48:49], v10 offset:12288
  ds_read_b64_tr_b16 a[50:51], v10 offset:12416
  ds_read_b64_tr_b16 a[52:53], v10 offset:14336
  ds_read_b64_tr_b16 a[54:55], v10 offset:14464
  ds_read_b64_tr_b16 a[56:57], v10 offset:12320
  ds_read_b64_tr_b16 a[58:59], v10 offset:12448
  ds_read_b64_tr_b16 a[60:61], v10 offset:14368
  ds_read_b64_tr_b16 a[62:63], v10 offset:14496
  ds_read_b64_tr_b16 a[64:65], v10 offset:16384
  ds_read_b64_tr_b16 a[66:67], v10 offset:16512
  ds_read_b64_tr_b16 a[68:69], v10 offset:18432
  ds_read_b64_tr_b16 a[70:71], v10 offset:18560
  ds_read_b64_tr_b16 a[72:73], v10 offset:16416
  ds_read_b64_tr_b16 a[74:75], v10 offset:16544
  ds_read_b64_tr_b16 a[76:77], v10 offset:18464
  ds_read_b64_tr_b16 a[78:79], v10 offset:18592
  ds_read_b64_tr_b16 a[80:81], v10 offset:20480
  ds_read_b64_tr_b16 a[82:83], v10 offset:20608
  ds_read_b64_tr_b16 a[84:85], v10 offset:22528
  ds_read_b64_tr_b16 a[86:87], v10 offset:22656
  ds_read_b64_tr_b16 a[88:89], v10 offset:20512
  ds_read_b64_tr_b16 a[90:91], v10 offset:20640
  ds_read_b64_tr_b16 a[92:93], v10 offset:22560
  ds_read_b64_tr_b16 a[94:95], v10 offset:22688
  ds_read_b64_tr_b16 a[96:97], v10 offset:24576
  ds_read_b64_tr_b16 a[98:99], v10 offset:24704
  ds_read_b64_tr_b16 a[100:101], v10 offset:26624
  ds_read_b64_tr_b16 a[102:103], v10 offset:26752
  ds_read_b64_tr_b16 a[104:105], v10 offset:24608
  ds_read_b64_tr_b16 a[106:107], v10 offset:24736
  ds_read_b64_tr_b16 a[108:109], v10 offset:26656
  ds_read_b64_tr_b16 a[110:111], v10 offset:26784
  ds_read_b64_tr_b16 a[112:113], v10 offset:28672
  ds_read_b64_tr_b16 a[114:115], v10 offset:28800
  ds_read_b64_tr_b16 a[116:117], v10 offset:30720
  ds_read_b64_tr_b16 a[118:119], v10 offset:30848
  ds_read_b64_tr_b16 a[120:121], v10 offset:28704
  ds_read_b64_tr_b16 a[122:123], v10 offset:28832
  ds_read_b64_tr_b16 a[124:125], v10 offset:30752
  ds_read_b64_tr_b16 a[126:127], v10 offset:30880
  s_waitcnt lgkmcnt(0)
  s_mov_b32 s27, s29
  s_mov_b32 s26, 0
L_op_wl1:
  s_mov_b32 m0, s27
  s_add_u32 s27, s27, 1024
  buffer_load_dwordx4 v11, s[8:11], s28 offen lds
  s_add_u32 s28, s28, 0x4000
  s_add_u32 s26, s26, 1
  s_cmp_lt_u32 s26, 32
  s_cbranch_scc1 L_op_wl1
  s_waitcnt vmcnt(0)
  ds_read_b64_tr_b16 a[128:129], v10 offset:0
  ds_read_b64_tr_b16 a[130:131], v10 offset:128
  ds_read_b64_tr_b16 a[132:133], v10 offset:2048
  ds_read_b64_tr_b16 a[134:135], v10 offset:2176
  ds_read_b64_tr_b16 a[136:137], v10 offset:32
  ds_read_b64_tr_b16 a[138:139], v10 offset:160
  ds_read_b64_tr_b16 a[140:141], v10 offset:2080
  ds_read_b64_tr_b16 a[142:143], v10 offset:2208
  ds_read_b64_tr_b16 a[144:145], v10 offset:4096
  ds_read_b64_tr_b16 a[146:147], v10 offset:4224
  ds_read_b64_tr_b16 a[148:149], v10 offset:6144
  ds_read_b64_tr_b16 a[150:151], v10 offset:6272
  ds_read_b64_tr_b16 a[152:153], v10 offset:4128
  ds_read_b64_tr_b16 a[154:155], v10 offset:4256
  ds_read_b64_tr_b16 a[156:157], v10 offset:6176
  ds_read_b64_tr_b16 a[158:159], v10 offset:6304
  ds_read_b64_tr_b16 a[160:161], v10 offset:8192
  ds_read_b64_tr_b16 a[162:163], v10 offset:8320
  ds_read_b64_tr_b16 a[164:165], v10 offset:10240
  ds_read_b64_tr_b16 a[166:167], v10 offset:10368
  ds_read_b64_tr_b16 a[168:169], v10 offset:8224
  ds_read_b64_tr_b16 a[170:171], v10 offset:8352
  ds_read_b64_tr_b16 a[172:173], v10 offset:10272
  ds_read_b64_tr_b16 a[174:175], v10 offset:10400
  ds_read_b64_tr_b16 a[176:177], v10 offset:12288
  ds_read_b64_tr_b16 a[178:179], v10 offset:12416
  ds_read_b64_tr_b16 a[180:181], v10 offset:14336
  ds_read_b64_tr_b16 a[182:183], v10 offset:14464
  ds_read_b64_tr_b16 a[184:185], v10 offset:12320
  ds_read_b64_tr_b16 a[186:187], v10 offset:12448
  ds_read_b64_tr_b16 a[188:189], v10 offset:14368
  ds_read_b64_tr_b16 a[190:191], v10 offset:14496
  ds_read_b64_tr_b16 a[192:193], v10 offset:16384
  ds_read_b64_tr_b16 a[194:195], v10 offset:16512
  ds_read_b64_tr_b16 a[196:197], v10 offset:18432
  ds_read_b64_tr_b16 a[198:199], v10 offset:18560
  ds_read_b64_tr_b16 a[200:201], v10 offset:16416
  ds_read_b64_tr_b16 a[202:203], v10 offset:16544
  ds_read_b64_tr_b16 a[204:205], v10 offset:18464
  ds_read_b64_tr_b16 a[206:207], v10 offset:18592
  ds_read_b64_tr_b16 a[208:209], v10 offset:20480
  ds_read_b64_tr_b16 a[210:211], v10 offset:20608
  ds_read_b64_tr_b16 a[212:213], v10 offset:22528
  ds_read_b64_tr_b16 a[214:215], v10 offset:22656
  ds_read_b64_tr_b16 a[216:217], v10 offset:20512
  ds_read_b64_tr_b16 a[218:219], v10 offset:20640
  ds_read_b64_tr_b16 a[220:221], v10 offset:22560
  ds_read_b64_tr_b16 a[222:223], v10 offset:22688
  ds_read_b64_tr_b16 a[224:225], v10 offset:24576
  ds_read_b64_tr_b16 a[226:227], v10 offset:24704
  ds_read_b64_tr_b16 a[228:229], v10 offset:26624
  ds_read_b64_tr_b16 a[230:231], v10 offset:26752
  ds_read_b64_tr_b16 a[232:233], v10 offset:24608
  ds_read_b64_tr_b16 a[234:235], v10 offset:24736
  ds_read_b64_tr_b16 a[236:237], v10 offset:26656
  ds_read_b64_tr_b16 a[238:239], v10 offset:26784
  ds_read_b64_tr_b16 a[240:241], v10 offset:28672
  ds_read_b64_tr_b16 a[242:243], v10 offset:28800
  ds_read_b64_tr_b16 a[244:245], v10 offset:30720
  ds_read_b64_tr_b16 a[246:247], v10 offset:30848
  ds_read_b64_tr_b16 a[248:249], v10 offset:28704
  ds_read_b64_tr_b16 a[250:251], v10 offset:28832
  ds_read_b64_tr_b16 a[252:253], v10 offset:30752
  ds_read_b64_tr_b16 a[254:255], v10 offset:30880
  s_waitcnt lgkmcnt(0)
  s_load_dwordx2 s[8:9], s[0:1], 112
  s_mov_b32 s10, 0x200000
  s_mov_b32 s11, 0x20000
  s_waitcnt lgkmcnt(0)
  s_and_b32 s26, s13, 1
  v_lshlrev_b32 v6, 1, v2
  v_add_u32 v6, s26, v6
  v_lshlrev_b32 v14, 2, v6
  v_add_u32 v14, 0x1000, v14
  v_lshlrev_b32 v6, 10, v6
  v_lshl_add_u32 v6, v3, 1, v6
  s_lshr_b32 s26, s13, 1
  s_lshl_b32 s26, s26, 5
  s_lshl_b32 s27, s30, 6
  s_add_u32 s26, s26, s27
  v_add_u32 v12, s26, v6
  s_lshl_b32 s26, s13, 2
  v_add_u32 v15, s26, v8
  v_and_b32 v6, 31, v1
  v_lshlrev_b32 v13, 2, v6
  s_barrier
  s_mov_b32 s26, 0x111400
  s_cmp_lg_u32 s13, 0
  s_cbranch_scc1 L_opc_ok
  v_lshlrev_b32 v19, 2, v1
  s_mov_b32 s15, 0
L_opd_w:
  buffer_load_dword v18, v19, s[4:7], s26 offen sc1
  s_waitcnt vmcnt(0)
  v_cmp_gt_u32 vcc, 1, v18
  s_cbranch_vccz L_opd_ok
  s_add_u32 s15, s15, 1
  s_sleep 32
  s_cmp_lt_u32 s15, 0x20000
  s_cbranch_scc1 L_opd_w
  s_branch L_end
L_opd_ok:
  s_mov_b32 s26, 0x111500
  s_mov_b32 s15, 0
L_opc_w:
  buffer_load_dword v18, v13, s[4:7], s26 offen sc1
  s_waitcnt vmcnt(0)
  v_cmp_gt_u32 vcc, 1, v18
  s_cbranch_vccz L_opc_ok
  s_add_u32 s15, s15, 1
  s_sleep 32
  s_cmp_lt_u32 s15, 0x20000
  s_cbranch_scc1 L_opc_w
  s_branch L_end
L_opc_ok:
  s_barrier
  v_lshlrev_b32 v13, 2, v13
L_op_task:
  s_lshl_b32 s33, s31, 13
  s_lshl_b32 s26, s13, 11
  s_add_u32 s26, s26, s33
  buffer_load_dwordx4 v[32:35], v8, s[16:19], s26 offen
  buffer_load_dwordx4 v[36:39], v8, s[16:19], s26 offen offset:1024
  s_add_u32 s27, s33, 0x7000000
  buffer_load_ushort v16, v12, s[4:7], s27 offen sc1
  v_mov_b32 v40, 0
  v_mov_b32 v41, 0
  v_mov_b32 v42, 0
  v_mov_b32 v43, 0
  v_mov_b32 v44, 0
  v_mov_b32 v45, 0
  v_mov_b32 v46, 0
  v_mov_b32 v47, 0
  s_waitcnt vmcnt(1)
  v_lshlrev_b32 v20, 16, v32
  v_and_b32 v21, 0xffff0000, v32
  v_mul_f32 v20, v20, v24
  v_mul_f32 v21, v21, v25
  v_cvt_pk_bf16_f32 v20, v20, v21
  v_and_b32 v21, 0xffff0000, v20
  v_lshlrev_b32 v20, 16, v20
  v_add_f32 v18, v20, v21
  v_lshlrev_b32 v20, 16, v33
  v_and_b32 v21, 0xffff0000, v33
  v_mul_f32 v20, v20, v26
  v_mul_f32 v21, v21, v27
  v_cvt_pk_bf16_f32 v20, v20, v21
  v_and_b32 v21, 0xffff0000, v20
  v_lshlrev_b32 v20, 16, v20
  v_add_f32 v18, v18, v20
  v_add_f32 v18, v18, v21
  v_lshlrev_b32 v20, 16, v34
  v_and_b32 v21, 0xffff0000, v34
  v_mul_f32 v20, v20, v28
  v_mul_f32 v21, v21, v29
  v_cvt_pk_bf16_f32 v20, v20, v21
  v_and_b32 v21, 0xffff0000, v20
  v_lshlrev_b32 v20, 16, v20
  v_add_f32 v18, v18, v20
  v_add_f32 v18, v18, v21
  v_lshlrev_b32 v20, 16, v35
  v_and_b32 v21, 0xffff0000, v35
  v_mul_f32 v20, v20, v30
  v_mul_f32 v21, v21, v31
  v_cvt_pk_bf16_f32 v20, v20, v21
  v_and_b32 v21, 0xffff0000, v20
  v_lshlrev_b32 v20, 16, v20
  v_add_f32 v18, v18, v20
  v_add_f32 v18, v18, v21
  v_lshlrev_b32 v20, 16, v36
  v_and_b32 v21, 0xffff0000, v36
  v_mul_f32 v20, v20, v24
  v_mul_f32 v21, v21, v25
  v_cvt_pk_bf16_f32 v20, v20, v21
  v_and_b32 v21, 0xffff0000, v20
  v_lshlrev_b32 v20, 16, v20
  v_add_f32 v19, v20, v21
  v_lshlrev_b32 v20, 16, v37
  v_and_b32 v21, 0xffff0000, v37
  v_mul_f32 v20, v20, v26
  v_mul_f32 v21, v21, v27
  v_cvt_pk_bf16_f32 v20, v20, v21
  v_and_b32 v21, 0xffff0000, v20
  v_lshlrev_b32 v20, 16, v20
  v_add_f32 v19, v19, v20
  v_add_f32 v19, v19, v21
  v_lshlrev_b32 v20, 16, v38
  v_and_b32 v21, 0xffff0000, v38
  v_mul_f32 v20, v20, v28
  v_mul_f32 v21, v21, v29
  v_cvt_pk_bf16_f32 v20, v20, v21
  v_and_b32 v21, 0xffff0000, v20
  v_lshlrev_b32 v20, 16, v20
  v_add_f32 v19, v19, v20
  v_add_f32 v19, v19, v21
  v_lshlrev_b32 v20, 16, v39
  v_and_b32 v21, 0xffff0000, v39
  v_mul_f32 v20, v20, v30
  v_mul_f32 v21, v21, v31
  v_cvt_pk_bf16_f32 v20, v20, v21
  v_and_b32 v21, 0xffff0000, v20
  v_lshlrev_b32 v20, 16, v20
  v_add_f32 v19, v19, v20
  v_add_f32 v19, v19, v21
  s_nop 1
  v_add_f32_dpp v18, v18, v18 row_ror:1 row_mask:0xf bank_mask:0xf
  v_add_f32_dpp v19, v19, v19 row_ror:1 row_mask:0xf bank_mask:0xf
  s_nop 1
  v_add_f32_dpp v18, v18, v18 row_ror:2 row_mask:0xf bank_mask:0xf
  v_add_f32_dpp v19, v19, v19 row_ror:2 row_mask:0xf bank_mask:0xf
  s_nop 1
  v_add_f32_dpp v18, v18, v18 row_ror:4 row_mask:0xf bank_mask:0xf
  v_add_f32_dpp v19, v19, v19 row_ror:4 row_mask:0xf bank_mask:0xf
  s_nop 1
  v_add_f32_dpp v18, v18, v18 row_ror:8 row_mask:0xf bank_mask:0xf
  v_add_f32_dpp v19, v19, v19 row_ror:8 row_mask:0xf bank_mask:0xf
  s_nop 1
  v_permlane16_swap_b32 v18, v19
  v_add_f32 v18, v18, v19
  v_mov_b32 v19, v18
  s_nop 1
  v_permlane32_swap_b32 v18, v19
  v_add_f32 v18, v18, v19
  v_cvt_pk_bf16_f32 v18, v18, v18
  v_and_b32 v18, 0xffff0000, v18
  v_mul_f32 v18, 0xbfb8aa3b, v18
  v_exp_f32 v18, v18
  s_nop 0
  v_add_f32 v18, 1.0, v18
  v_rcp_f32 v18, v18
  s_nop 0
  v_cvt_pk_bf16_f32 v18, v18, v18
  v_and_b32 v18, 0xffff0000, v18
  v_and_b32 v19, 1, v2
  s_lshl_b32 s26, s13, 1
  v_add_u32 v19, s26, v19
  v_lshlrev_b32 v19, 2, v19
  ds_write_b32 v19, v18 offset:4096
  s_mov_b32 s26, 0x111000
  s_lshr_b32 s27, s31, 2
  s_cmp_lg_u32 s13, 0
  s_cbranch_scc1 L_opx_ok
  s_mov_b32 s15, 0
L_opx_w:
  buffer_load_dword v20, v13, s[4:7], s26 offen sc1
  s_waitcnt vmcnt(0)
  v_cmp_ge_u32 vcc, s27, v20
  s_cbranch_vccz L_opx_ok
  s_add_u32 s15, s15, 1
  s_sleep 8
  s_cmp_lt_u32 s15, 0x20000
  s_cbranch_scc1 L_opx_w
  s_branch L_end
L_opx_ok:
  s_barrier
  s_lshl_b32 s32, s31, 11
  s_lshl_b32 s26, s13, 22
  s_add_u32 s32, s32, s26
  s_add_u32 s32, s32, 0x5000000
  buffer_load_dwordx4 v[64:67], v8, s[4:7], s32 offen offset:0 sc1
  buffer_load_dwordx4 v[68:71], v8, s[4:7], s32 offen offset:1024 sc1
  s_add_u32 s32, s32, 0x80000
  buffer_load_dwordx4 v[72:75], v8, s[4:7], s32 offen offset:0 sc1
  buffer_load_dwordx4 v[76:79], v8, s[4:7], s32 offen offset:1024 sc1
  s_add_u32 s32, s32, 0x80000
  buffer_load_dwordx4 v[80:83], v8, s[4:7], s32 offen offset:0 sc1
  buffer_load_dwordx4 v[84:87], v8, s[4:7], s32 offen offset:1024 sc1
  s_add_u32 s32, s32, 0x80000
  buffer_load_dwordx4 v[88:91], v8, s[4:7], s32 offen offset:0 sc1
  buffer_load_dwordx4 v[92:95], v8, s[4:7], s32 offen offset:1024 sc1
  s_add_u32 s32, s32, 0x80000
  buffer_load_dwordx4 v[96:99], v8, s[4:7], s32 offen offset:0 sc1
  buffer_load_dwordx4 v[100:103], v8, s[4:7], s32 offen offset:1024 sc1
  s_add_u32 s32, s32, 0x80000
  buffer_load_dwordx4 v[104:107], v8, s[4:7], s32 offen offset:0 sc1
  buffer_load_dwordx4 v[108:111], v8, s[4:7], s32 offen offset:1024 sc1
  s_add_u32 s32, s32, 0x80000
  buffer_load_dwordx4 v[112:115], v8, s[4:7], s32 offen offset:0 sc1
  buffer_load_dwordx4 v[116:119], v8, s[4:7], s32 offen offset:1024 sc1
  s_add_u32 s32, s32, 0x80000
  buffer_load_dwordx4 v[120:123], v8, s[4:7], s32 offen offset:0 sc1
  buffer_load_dwordx4 v[124:127], v8, s[4:7], s32 offen offset:1024 sc1
  s_waitcnt vmcnt(15)
  v_smfmac_f32_16x16x64_bf16 v[40:43], v[64:67], a[0:7], v9
  v_smfmac_f32_16x16x64_bf16 v[44:47], v[64:67], a[8:15], v9
  s_waitcnt vmcnt(14)
  v_smfmac_f32_16x16x64_bf16 v[40:43], v[68:71], a[16:23], v9
  v_smfmac_f32_16x16x64_bf16 v[44:47], v[68:71], a[24:31], v9
  s_waitcnt vmcnt(13)
  v_smfmac_f32_16x16x64_bf16 v[40:43], v[72:75], a[32:39], v9
  v_smfmac_f32_16x16x64_bf16 v[44:47], v[72:75], a[40:47], v9
  s_waitcnt vmcnt(12)
  v_smfmac_f32_16x16x64_bf16 v[40:43], v[76:79], a[48:55], v9
  v_smfmac_f32_16x16x64_bf16 v[44:47], v[76:79], a[56:63], v9
  s_waitcnt vmcnt(11)
  v_smfmac_f32_16x16x64_bf16 v[40:43], v[80:83], a[64:71], v9
  v_smfmac_f32_16x16x64_bf16 v[44:47], v[80:83], a[72:79], v9
  s_waitcnt vmcnt(10)
  v_smfmac_f32_16x16x64_bf16 v[40:43], v[84:87], a[80:87], v9
  v_smfmac_f32_16x16x64_bf16 v[44:47], v[84:87], a[88:95], v9
  s_waitcnt vmcnt(9)
  v_smfmac_f32_16x16x64_bf16 v[40:43], v[88:91], a[96:103], v9
  v_smfmac_f32_16x16x64_bf16 v[44:47], v[88:91], a[104:111], v9
  s_waitcnt vmcnt(8)
  v_smfmac_f32_16x16x64_bf16 v[40:43], v[92:95], a[112:119], v9
  v_smfmac_f32_16x16x64_bf16 v[44:47], v[92:95], a[120:127], v9
  s_waitcnt vmcnt(7)
  v_smfmac_f32_16x16x64_bf16 v[40:43], v[96:99], a[128:135], v9
  v_smfmac_f32_16x16x64_bf16 v[44:47], v[96:99], a[136:143], v9
  s_waitcnt vmcnt(6)
  v_smfmac_f32_16x16x64_bf16 v[40:43], v[100:103], a[144:151], v9
  v_smfmac_f32_16x16x64_bf16 v[44:47], v[100:103], a[152:159], v9
  s_waitcnt vmcnt(5)
  v_smfmac_f32_16x16x64_bf16 v[40:43], v[104:107], a[160:167], v9
  v_smfmac_f32_16x16x64_bf16 v[44:47], v[104:107], a[168:175], v9
  s_waitcnt vmcnt(4)
  v_smfmac_f32_16x16x64_bf16 v[40:43], v[108:111], a[176:183], v9
  v_smfmac_f32_16x16x64_bf16 v[44:47], v[108:111], a[184:191], v9
  s_waitcnt vmcnt(3)
  v_smfmac_f32_16x16x64_bf16 v[40:43], v[112:115], a[192:199], v9
  v_smfmac_f32_16x16x64_bf16 v[44:47], v[112:115], a[200:207], v9
  s_waitcnt vmcnt(2)
  v_smfmac_f32_16x16x64_bf16 v[40:43], v[116:119], a[208:215], v9
  v_smfmac_f32_16x16x64_bf16 v[44:47], v[116:119], a[216:223], v9
  s_waitcnt vmcnt(1)
  v_smfmac_f32_16x16x64_bf16 v[40:43], v[120:123], a[224:231], v9
  v_smfmac_f32_16x16x64_bf16 v[44:47], v[120:123], a[232:239], v9
  s_waitcnt vmcnt(0)
  v_smfmac_f32_16x16x64_bf16 v[40:43], v[124:127], a[240:247], v9
  v_smfmac_f32_16x16x64_bf16 v[44:47], v[124:127], a[248:255], v9
  s_nop 7
  v_add_f32 v40, v40, v42
  v_add_f32 v41, v41, v43
  v_add_f32 v42, v44, v46
  v_add_f32 v43, v45, v47
  s_lshl_b32 s26, s13, 10
  v_add_u32 v18, s26, v8
  ds_write_b128 v18, v[40:43]
  s_waitcnt lgkmcnt(0)
  s_barrier
  ds_read2st64_b32 v[40:41], v15 offset0:0 offset1:4
  ds_read2st64_b32 v[42:43], v15 offset0:8 offset1:12
  ds_read_b32 v17, v14
  s_waitcnt lgkmcnt(0)
  s_barrier
  v_add_f32 v40, v40, v41
  v_add_f32 v42, v42, v43
  v_add_f32 v40, v40, v42
  v_cvt_pk_bf16_f32 v40, v40, v40
  v_and_b32 v40, 0xffff0000, v40
  v_lshlrev_b32 v16, 16, v16
  v_mul_f32 v16, v16, v17
  v_cvt_pk_bf16_f32 v16, v16, v16
  v_and_b32 v16, 0xffff0000, v16
  v_sub_f32 v17, 1.0, v17
  v_cvt_pk_bf16_f32 v17, v17, v17
  v_and_b32 v17, 0xffff0000, v17
  v_mul_f32 v40, v40, v17
  v_cvt_pk_bf16_f32 v40, v40, v40
  v_and_b32 v40, 0xffff0000, v40
  v_add_f32 v40, v40, v16
  v_cvt_pk_bf16_f32 v40, v40, v40
  buffer_store_short v40, v12, s[8:11], s33 offen
  s_add_u32 s31, s31, 12
  s_cmp_lt_u32 s31, 256
  s_cbranch_scc1 L_op_task
L_end:
  s_endpgm
.section .rodata,"a"
.p2align 6
.amdhsa_kernel gated_mix__ssm_conv_h3__memory_aug_recurrent_mem_tr__prompt_kernel
.amdhsa_next_free_vgpr 512
.amdhsa_next_free_sgpr 102
.amdhsa_accum_offset 256
.amdhsa_group_segment_fixed_size 0
.amdhsa_kernarg_size 136
.amdhsa_user_sgpr_count 2
.amdhsa_user_sgpr_kernarg_segment_ptr 1
.amdhsa_system_sgpr_workgroup_id_x 1
.end_amdhsa_kernel
```
